```python
import torch

def _softmax(x, axis=-1):
    return torch.softmax(x, dim=axis)

def _gelu(x):
    return torch.nn.functional.gelu(x, approximate='tanh')

def _silu(x):
    return torch.nn.functional.silu(x)

def _sigmoid(x):
    return torch.sigmoid(x)

def _layernorm(x, axis=-1, eps=1e-05):
    m = x.mean(dim=axis, keepdim=True)
    v = x.var(dim=axis, keepdim=True, unbiased=False)
    return (x - m) / torch.sqrt(v + eps)

def _scatter_add(tgt, idx, src, axis=0):
    return tgt.clone().index_add_(axis, idx, src)

def _segment_sum(src, seg, n):
    out = torch.zeros((n,) + src.shape[1:], dtype=src.dtype)
    return out.index_add_(0, seg, src)

def _pad(x, pw):
    flat = tuple((v for pair in reversed(pw) for v in pair))
    return torch.nn.functional.pad(x, flat)
kernel_name = 'gated_mix__memory_aug_recurrent_mem_tr__glu_gated_glu__prompt'

def setup_inputs():

    _w = lambda a: (lambda t: t.to(torch.bfloat16) if t.is_floating_point() else t)(torch.as_tensor(a))

    def _A_setup():
        B, S, Dm = (1, 2048, 512)
        H, Dh = (32, 128)
        M, seg = (8, 32)
        seg = min(seg, S)
        S = S // seg * seg
        return {'x': _w((lambda *s: torch.randn(*s, dtype=torch.bfloat16) * 0.05)(B, S, Dm)), 'mem0': _w((lambda *s: torch.randn(*s, dtype=torch.bfloat16) * 0.8)(B, M, Dm)), 'Wq': _w((lambda *s: torch.randn(*s, dtype=torch.bfloat16) * 3.2)(Dm, H, Dh) * Dm ** (-0.5)), 'Wk': _w((lambda *s: torch.randn(*s, dtype=torch.bfloat16) * 3.2)(Dm, H, Dh) * Dm ** (-0.5)), 'Wv': _w((lambda *s: torch.randn(*s, dtype=torch.bfloat16) * 0.8)(Dm, H, Dh) * Dm ** (-0.5)), 'Wo': _w((lambda *s: torch.randn(*s, dtype=torch.bfloat16) * 0.8)(H, Dh, Dm) * (H * Dh) ** (-0.5)), 'seg_len': seg}
    _A_in = _A_setup()

    def _B_setup():
        B, S, D, F = (1, 2048, 512, 1376)
        return {'x': _w((lambda *s: torch.randn(*s, dtype=torch.bfloat16) * 0.05)(B, S, D)), 'w_gate': _w((lambda *s: torch.randn(*s, dtype=torch.bfloat16) * 0.8)(D, F)), 'w_up': _w((lambda *s: torch.randn(*s, dtype=torch.bfloat16) * 0.05)(D, F)), 'w_down': _w((lambda *s: torch.randn(*s, dtype=torch.bfloat16) * 0.05)(F, D))}
    _B_in = _B_setup()
    return {'A_x': _A_in['x'], 'A_mem0': _A_in['mem0'], 'A_Wq': _A_in['Wq'], 'A_Wk': _A_in['Wk'], 'A_Wv': _A_in['Wv'], 'A_Wo': _A_in['Wo'], 'A_seg_len': _A_in['seg_len'], 'B_x': _B_in['x'], 'B_w_gate': _B_in['w_gate'], 'B_w_up': _B_in['w_up'], 'B_w_down': _B_in['w_down'], 'gate_w': _w((lambda *s: torch.randn(*s, dtype=torch.bfloat16) * 0.05)(512) * 16.0)}

def reference(A_x, A_mem0, A_Wq, A_Wk, A_Wv, A_Wo, A_seg_len, B_x, B_w_gate, B_w_up, B_w_down, gate_w):

    def _A_ref(x, mem0, Wq, Wk, Wv, Wo, seg_len):
        B, S, Dm = x.shape
        H, Dh = (Wq.shape[1], Wq.shape[2])
        M = mem0.shape[1]
        scale = Dh ** (-0.5)
        n_seg = S // seg_len
        L = M + seg_len
        idx = torch.arange(L)
        mask = (idx[:, None] < M) | (idx[:, None] >= idx[None, :])
        mem = mem0
        outs = []
        for s in range(n_seg):
            xs = x[:, s * seg_len:(s + 1) * seg_len, :].clone()
            h = torch.concatenate([mem, xs], axis=1)
            q = torch.einsum('btd,dhe->bhte', h, Wq)
            k = torch.einsum('btd,dhe->bhte', h, Wk)
            v = torch.einsum('btd,dhe->bhte', h, Wv)
            scores = torch.einsum('bhqe,bhke->bhqk', q, k) * scale
            scores = torch.where(mask[None, None], scores, -1000000000.0)
            p = _softmax(scores, axis=-1)
            o = torch.einsum('bhqk,bhke->bhqe', p, v)
            o = torch.einsum('bhte,hed->btd', o, Wo)
            mem = o[:, :M, :].clone()
            outs.append(o[:, M:, :])
        return torch.concatenate(outs, axis=1)

    def _B_ref(x, w_gate, w_up, w_down):
        g = torch.einsum('bsd,df->bsf', x, w_gate)
        u = torch.einsum('bsd,df->bsf', x, w_up)
        h = _sigmoid(g) * u
        return torch.einsum('bsf,fd->bsd', h, w_down)
    x = A_x
    g = _sigmoid((x * gate_w).sum(-1, keepdims=True))
    a = _A_ref(x, A_mem0, A_Wq, A_Wk, A_Wv, A_Wo, A_seg_len)
    b = _B_ref(x, B_w_gate, B_w_up, B_w_down)
    return g * a + (1 - g) * b
```

```asm
; @launch grid=(256,1,1) block=(256,1,1) lds=163840
.amdgcn_target "amdgcn-amd-amdhsa--gfx950"
.text
.globl gated_mix__memory_aug_recurrent_mem_tr__glu_gated_glu__prompt_kernel
.p2align 8
.type gated_mix__memory_aug_recurrent_mem_tr__glu_gated_glu__prompt_kernel,@function
gated_mix__memory_aug_recurrent_mem_tr__glu_gated_glu__prompt_kernel:
  s_cmp_ge_u32 s2, 256
  s_cbranch_scc1 L_exit
  s_load_dwordx2 s[4:5], s[0:1], 112
  s_mov_b32 s6, 0x10000000
  s_mov_b32 s7, 0x20000
  s_load_dwordx2 s[8:9], s[0:1], 104
  s_mov_b32 s10, 0x100
  s_mov_b32 s11, 0x20000
  s_load_dwordx2 s[46:47], s[0:1], 40
  s_getreg_b32 s12, hwreg(HW_REG_XCC_ID)
  s_and_b32 s12, s12, 7
  s_lshl_b32 s12, s12, 2
  s_lshr_b32 s12, 0x63524170, s12
  s_and_b32 s12, s12, 7
  v_lshrrev_b32 v1, 6, v0
  s_nop 0
  v_readfirstlane_b32 s14, v1
  v_mov_b32 v2, -1
  v_mov_b32 v3, -1
  v_mov_b32 v4, 0
  v_lshlrev_b32 v1, 3, v0
  s_lshl_b32 s15, s2, 11
  s_add_u32 s16, s15, 0x3f00000
  s_add_u32 s17, s15, 0x3f80000
  s_lshl_b32 s18, s2, 7
  s_add_u32 s18, s18, 0x4000000
  v_lshlrev_b32 v5, 2, v0
  v_mov_b32 v6, 0x40000000
  v_cmp_gt_u32 vcc, 32, v0
  s_nop 1
  v_cndmask_b32 v5, v6, v5, vcc
  v_mov_b32 v7, 0x40000000
  v_cmp_eq_u32 vcc, 0, v0
  s_nop 1
  v_cndmask_b32 v7, v7, v4, vcc
  v_mov_b32 v6, 1
  s_lshl_b32 s19, s12, 2
  s_add_u32 s19, s19, 128
  s_cmp_eq_u32 s12, 0
  s_cselect_b32 s19, 0, s19
  s_waitcnt lgkmcnt(0)
  s_cmp_ge_u32 s12, 4
  s_cbranch_scc1 L_en_late_1
  s_mov_b32 s22, 1
  s_cmp_lg_u32 s14, 0
  s_cbranch_scc1 L_en_s0_4
  buffer_atomic_add v6, v7, s[8:11], s19 offen sc0 sc1
L_en_s0_4:
  buffer_store_dwordx2 v[2:3], v1, s[4:7], s16 offen sc1
  buffer_store_dwordx2 v[2:3], v1, s[4:7], s17 offen sc1
  buffer_store_dword v4, v5, s[4:7], s18 offen sc1
  v_mov_b32 v8, -1
  v_mov_b32 v9, -1
  v_mov_b32 v10, -1
  v_mov_b32 v11, -1
  v_and_b32 v12, 63, v0
  v_lshlrev_b32 v12, 4, v12
  v_bfe_u32 v13, v0, 6, 1
  v_lshl_or_b32 v12, v13, 22, v12
  v_mov_b32 v13, 0x40000000
  v_cmp_gt_u32 vcc, 0x80, v0
  s_nop 1
  v_cndmask_b32 v12, v13, v12, vcc
  s_lshl_b32 s45, s2, 10
  s_add_u32 s45, s45, 0x23c0000
  buffer_store_dwordx4 v[8:11], v12, s[4:7], s45 offen sc1
  s_waitcnt vmcnt(4)
  s_branch L_en_got_3
L_en_late_1:
  s_mov_b32 s22, 0
  buffer_store_dwordx2 v[2:3], v1, s[4:7], s16 offen sc1
  buffer_store_dwordx2 v[2:3], v1, s[4:7], s17 offen sc1
  buffer_store_dword v4, v5, s[4:7], s18 offen sc1
  v_mov_b32 v8, -1
  v_mov_b32 v9, -1
  v_mov_b32 v10, -1
  v_mov_b32 v11, -1
  v_and_b32 v12, 63, v0
  v_lshlrev_b32 v12, 4, v12
  v_bfe_u32 v13, v0, 6, 1
  v_lshl_or_b32 v12, v13, 22, v12
  v_mov_b32 v13, 0x40000000
  v_cmp_gt_u32 vcc, 0x80, v0
  s_nop 1
  v_cndmask_b32 v12, v13, v12, vcc
  s_lshl_b32 s45, s2, 10
  s_add_u32 s45, s45, 0x23c0000
  buffer_store_dwordx4 v[8:11], v12, s[4:7], s45 offen sc1
L_en_nopf_2:
  s_waitcnt vmcnt(0)
  s_barrier
L_en_s1_5:
  s_cmp_lg_u32 s14, 0
  s_cbranch_scc1 L_en_s1_5b
  buffer_atomic_add v6, v7, s[8:11], s19 offen sc0 sc1
L_en_s1_5b:
  s_waitcnt vmcnt(0)
L_en_got_3:
  v_readfirstlane_b32 s13, v6
  v_mov_b32 v7, 0
  s_cmp_lg_u32 s14, 0
  s_cbranch_scc1 L_en_s0_4b
  v_mov_b32 v6, s13
  ds_write_b32 v7, v6
L_en_s0_4b:
  s_waitcnt lgkmcnt(0)
  s_barrier
  ds_read_b32 v6, v7
  s_waitcnt lgkmcnt(0)
  v_readfirstlane_b32 s13, v6
  s_barrier
  s_mov_b32 s21, 0
  s_lshl_b32 s20, s12, 5
  s_add_u32 s20, s20, s13
  s_cmp_lt_u32 s13, 32
  s_cbranch_scc1 L_dispatch
  s_cmp_eq_u32 s22, 0
  s_cbranch_scc1 L_rf_skip_6
  s_waitcnt vmcnt(0)
  s_barrier
  s_mov_b32 s22, 0
  s_cmp_lg_u32 s14, 0
  s_cbranch_scc1 L_rf_w_7
  v_mov_b32 v2, 1
  v_mov_b32 v3, 0x40000000
  v_cmp_eq_u32 vcc, 0, v0
  s_nop 1
  v_cndmask_b32 v3, v3, 0, vcc
  buffer_atomic_add v2, v3, s[8:11], 0 offen offset:32 sc1
L_rf_w_7:
L_rf_skip_6:
  s_mov_b32 s15, 200000
  v_and_b32 v3, 63, v0
  v_lshlrev_b32 v3, 2, v3
L_rdy_top_8:
  buffer_load_dword v2, v3, s[8:11], 0 offen sc1
  s_waitcnt vmcnt(0)
  v_readlane_b32 s16, v2, 8
  v_readlane_b32 s17, v2, 36
  s_add_u32 s16, s16, s17
  v_readlane_b32 s17, v2, 37
  s_add_u32 s16, s16, s17
  v_readlane_b32 s17, v2, 38
  s_add_u32 s16, s16, s17
  v_readlane_b32 s17, v2, 39
  s_add_u32 s16, s16, s17
  s_cmp_ge_u32 s16, 256
  s_cbranch_scc1 L_rdy_out_9
  s_sub_u32 s15, s15, 1
  s_cmp_lg_u32 s15, 0
  s_cbranch_scc1 L_rdy_top_8
L_rdy_out_9:
L_fallback:
  s_waitcnt vmcnt(0) lgkmcnt(0)
  s_barrier
  s_mov_b32 s21, 1
  s_mov_b32 s20, s2
  v_mbcnt_lo_u32_b32 v0, -1, 0
  v_mbcnt_hi_u32_b32 v0, -1, v0
  s_lshl_b32 s15, s14, 6
  v_add_u32 v0, s15, v0
L_dispatch:
  s_cmp_ge_u32 s20, 128
  s_cbranch_scc1 L_f
  s_cmp_ge_u32 s20, 32
  s_cbranch_scc1 L_h
  s_mov_b32 s44, s20
  s_load_dwordx2 s[24:25], s[0:1], 16
  s_mov_b32 s26, 0x400000
  s_mov_b32 s27, 0x20000
  s_load_dwordx2 s[28:29], s[0:1], 24
  s_mov_b32 s30, 0x400000
  s_mov_b32 s31, 0x20000
  s_load_dwordx2 s[32:33], s[0:1], 32
  s_mov_b32 s34, 0x400000
  s_mov_b32 s35, 0x20000
  s_load_dwordx2 s[36:37], s[0:1], 40
  s_mov_b32 s38, 0x400000
  s_mov_b32 s39, 0x20000
  s_load_dwordx2 s[40:41], s[0:1], 8
  s_mov_b32 s42, 0x2000
  s_mov_b32 s43, 0x20000
  s_mov_b32 s62, 0x05040100
  s_mov_b32 s63, 0x07060302
  v_mov_b32 v114, v0
  s_waitcnt lgkmcnt(0)
  v_mov_b32 v113, 0x0
  v_bfe_u32 v132, v114, 0, 4
  v_mad_i32_i24 v113, v132, 16, v113
  v_bfe_u32 v132, v114, 4, 2
  s_mov_b32 s57, 0x1040
  v_mad_i32_i24 v113, v132, s57, v113
  v_bfe_u32 v132, v114, 2, 1
  v_bfe_u32 v133, v114, 4, 1
  v_and_b32 v132, v132, v133
  s_mov_b32 s57, 0xffffff80
  v_mad_i32_i24 v113, v132, s57, v113
  v_bfe_u32 v132, v114, 3, 1
  v_bfe_u32 v133, v114, 5, 1
  v_and_b32 v132, v132, v133
  s_mov_b32 s57, 0xffffff00
  v_mad_i32_i24 v113, v132, s57, v113
  s_and_b32 s94, s14, 1
  s_lshr_b32 s101, s14, 1
  s_lshl_b32 s23, s94, 16
  s_lshl_b32 s81, s94, 11
  s_lshl_b32 s101, s101, 14
  s_or_b32 s23, s23, s101
  s_or_b32 s81, s81, s101
  s_lshl_b32 s94, s44, 8
  s_or_b32 s23, s23, s94
  s_lshl_b32 s94, s44, 17
  s_or_b32 s81, s81, s94
  s_lshl_b32 s94, s14, 11
  s_add_u32 s95, s94, 0xc700
  s_add_u32 s96, s94, 0x14f00
  s_add_u32 s97, s94, 0x1d700
  s_add_u32 s98, s94, 0x25f00
  s_add_u32 s99, s94, 0x2000
  s_add_u32 s100, s94, 0x0
  s_mov_b32 m0, s95
  s_add_u32 s94, s81, 0x0
  buffer_load_dwordx4 v113, s[36:39], s94 offen lds
  buffer_load_dwordx4 v113, s[36:39], s94 offen offset:1024 lds
  s_mov_b32 m0, s96
  s_add_u32 s94, s81, 0x100
  buffer_load_dwordx4 v113, s[36:39], s94 offen lds
  buffer_load_dwordx4 v113, s[36:39], s94 offen offset:1024 lds
  s_mov_b32 m0, s97
  s_add_u32 s94, s81, 0x200
  buffer_load_dwordx4 v113, s[36:39], s94 offen lds
  buffer_load_dwordx4 v113, s[36:39], s94 offen offset:1024 lds
  s_mov_b32 m0, s98
  s_add_u32 s94, s81, 0x300
  buffer_load_dwordx4 v113, s[36:39], s94 offen lds
  buffer_load_dwordx4 v113, s[36:39], s94 offen offset:1024 lds
  s_mov_b32 m0, s99
  s_add_u32 s94, s81, 0x8000
  buffer_load_dwordx4 v113, s[36:39], s94 offen lds
  buffer_load_dwordx4 v113, s[36:39], s94 offen offset:1024 lds
  v_mov_b32 v112, 0x0
  v_bfe_u32 v132, v114, 0, 4
  v_mad_i32_i24 v112, v132, 16, v112
  v_bfe_u32 v132, v114, 4, 1
  s_mov_b32 s57, 0x8040
  v_mad_i32_i24 v112, v132, s57, v112
  v_bfe_u32 v132, v114, 5, 1
  s_mov_b32 s57, 0x20080
  v_mad_i32_i24 v112, v132, s57, v112
  v_bfe_u32 v132, v114, 2, 1
  v_bfe_u32 v133, v114, 4, 1
  v_and_b32 v132, v132, v133
  s_mov_b32 s57, 0xffffff80
  v_mad_i32_i24 v112, v132, s57, v112
  v_bfe_u32 v132, v114, 3, 1
  v_bfe_u32 v133, v114, 5, 1
  v_and_b32 v132, v132, v133
  s_mov_b32 s57, 0xffffff00
  v_mad_i32_i24 v112, v132, s57, v112
  v_mov_b32 v4, 0x5f00
  v_bfe_u32 v132, v114, 0, 6
  v_mad_i32_i24 v4, v132, 16, v4
  v_bfe_u32 v132, v114, 6, 2
  s_mov_b32 s57, 0x8800
  v_mad_i32_i24 v4, v132, s57, v4
  v_mov_b32 v68, 0x0
  v_bfe_u32 v132, v114, 0, 4
  v_mad_i32_i24 v68, v132, 4, v68
  v_bfe_u32 v132, v114, 4, 2
  s_mov_b32 s57, 0x140
  v_mad_i32_i24 v68, v132, s57, v68
  v_bfe_u32 v132, v114, 6, 2
  s_mov_b32 s57, 0xfffff840
  v_mad_i32_i24 v68, v132, s57, v68
  v_bfe_u32 v132, v114, 4, 1
  v_bfe_u32 v133, v114, 6, 1
  v_and_b32 v132, v132, v133
  s_mov_b32 s57, 0xffffff80
  v_mad_i32_i24 v68, v132, s57, v68
  v_bfe_u32 v132, v114, 5, 1
  v_bfe_u32 v133, v114, 7, 1
  v_and_b32 v132, v132, v133
  s_mov_b32 s57, 0xffffff00
  v_mad_i32_i24 v68, v132, s57, v68
  s_mov_b64 s[88:89], s[28:29]
  s_mov_b64 s[90:91], s[30:31]
  s_mov_b32 s86, s23
  s_waitcnt vmcnt(8) lgkmcnt(0)
  s_barrier
  s_mov_b32 m0, s100
  s_add_u32 s94, s81, 0x8100
  buffer_load_dwordx4 v113, s[36:39], s94 offen lds
  buffer_load_dwordx4 v113, s[36:39], s94 offen offset:1024 lds
  v_add_u32 v69, s95, v68
  ds_read2st64_b32 v[20:21], v69 offset0:0 offset1:4
  ds_read2st64_b32 v[22:23], v69 offset0:8 offset1:12
  ds_read2st64_b32 v[24:25], v69 offset0:16 offset1:20
  ds_read2st64_b32 v[26:27], v69 offset0:24 offset1:28
  v_mov_b32 v92, 0x0
  v_bfe_u32 v132, v114, 0, 1
  s_mov_b32 s57, 0x400
  v_mad_i32_i24 v92, v132, s57, v92
  v_bfe_u32 v132, v114, 1, 1
  v_mad_i32_i24 v92, v132, 16, v92
  v_bfe_u32 v132, v114, 2, 2
  s_mov_b32 s57, 0x800
  v_mad_i32_i24 v92, v132, s57, v92
  v_bfe_u32 v132, v114, 4, 2
  v_mad_i32_i24 v92, v132, 32, v92
  v_bfe_u32 v132, v114, 6, 2
  s_mov_b32 s57, 0x100
  v_mad_i32_i24 v92, v132, s57, v92
  buffer_load_dwordx4 v[96:99], v92, s[40:43], 0 offen offset:0
  buffer_load_dwordx4 v[100:103], v92, s[40:43], 0 offen offset:128
  v_mov_b32 v1, 0x4444
  v_bfe_u32 v132, v114, 1, 1
  s_mov_b32 s57, 0xaaaa
  v_mad_i32_i24 v1, v132, s57, v1
  v_mov_b32 v2, 0x0
  v_bfe_u32 v132, v114, 0, 1
  v_mad_i32_i24 v2, v132, 32, v2
  v_bfe_u32 v132, v114, 1, 1
  v_mad_i32_i24 v2, v132, 16, v2
  v_bfe_u32 v132, v114, 2, 4
  v_mad_i32_i24 v2, v132, 64, v2
  v_bfe_u32 v132, v114, 6, 2
  s_mov_b32 s57, 0x800
  v_mad_i32_i24 v2, v132, s57, v2
  v_xor_b32 v3, 0x800, v2
  v_xor_b32 v12, 0x1000, v2
  v_xor_b32 v7, 0x1800, v2
  v_mov_b32 v4, 0x5f00
  v_bfe_u32 v132, v114, 0, 6
  v_mad_i32_i24 v4, v132, 16, v4
  v_bfe_u32 v132, v114, 6, 2
  s_mov_b32 s57, 0x8800
  v_mad_i32_i24 v4, v132, s57, v4
  v_mov_b32 v5, 0x4000
  v_bfe_u32 v132, v114, 0, 4
  v_mad_i32_i24 v5, v132, 4, v5
  v_bfe_u32 v132, v114, 4, 2
  s_mov_b32 s57, 0x280
  v_mad_i32_i24 v5, v132, s57, v5
  v_bfe_u32 v132, v114, 6, 2
  v_mad_i32_i24 v5, v132, 64, v5
  v_add_u32 v13, 5120, v5
  v_mov_b32 v6, 0x4000
  v_bfe_u32 v132, v114, 0, 1
  s_mov_b32 s57, 0x140
  v_mad_i32_i24 v6, v132, s57, v6
  v_bfe_u32 v132, v114, 2, 2
  s_mov_b32 s57, 0x280
  v_mad_i32_i24 v6, v132, s57, v6
  v_bfe_u32 v132, v114, 4, 2
  v_mad_i32_i24 v6, v132, 16, v6
  v_mov_b32 v8, 0x2000
  v_bfe_u32 v132, v114, 0, 3
  v_mad_i32_i24 v8, v132, 16, v8
  v_bfe_u32 v132, v114, 3, 1
  s_mov_b32 s57, 0x180
  v_mad_i32_i24 v8, v132, s57, v8
  v_bfe_u32 v132, v114, 4, 2
  s_mov_b32 s57, 0x200
  v_mad_i32_i24 v8, v132, s57, v8
  v_mov_b32 v9, 0x2080
  v_bfe_u32 v132, v114, 0, 4
  v_mad_i32_i24 v9, v132, 16, v9
  v_bfe_u32 v132, v114, 4, 2
  s_mov_b32 s57, 0x200
  v_mad_i32_i24 v9, v132, s57, v9
  s_waitcnt vmcnt(8) lgkmcnt(0)
  s_barrier
  s_mov_b32 m0, s95
  s_add_u32 s94, s81, 0x8200
  buffer_load_dwordx4 v113, s[36:39], s94 offen lds
  buffer_load_dwordx4 v113, s[36:39], s94 offen offset:1024 lds
  v_add_u32 v69, s96, v68
  ds_read2st64_b32 v[28:29], v69 offset0:0 offset1:4
  ds_read2st64_b32 v[30:31], v69 offset0:8 offset1:12
  ds_read2st64_b32 v[32:33], v69 offset0:16 offset1:20
  ds_read2st64_b32 v[34:35], v69 offset0:24 offset1:28
  v_perm_b32 v104, v21, v20, s62
  v_perm_b32 v105, v21, v20, s63
  v_perm_b32 v106, v23, v22, s62
  v_perm_b32 v107, v23, v22, s63
  v_accvgpr_write_b32 a192, v104
  v_accvgpr_write_b32 a193, v105
  v_accvgpr_write_b32 a194, v106
  v_accvgpr_write_b32 a195, v107
  v_perm_b32 v108, v25, v24, s62
  v_perm_b32 v109, v25, v24, s63
  v_perm_b32 v110, v27, v26, s62
  v_perm_b32 v111, v27, v26, s63
  v_accvgpr_write_b32 a196, v108
  v_accvgpr_write_b32 a197, v109
  v_accvgpr_write_b32 a198, v110
  v_accvgpr_write_b32 a199, v111
  v_mov_b32 v10, 0x0
  v_bfe_u32 v132, v114, 0, 4
  v_mad_i32_i24 v10, v132, 16, v10
  v_bfe_u32 v132, v114, 4, 1
  s_mov_b32 s57, 0x180
  v_mad_i32_i24 v10, v132, s57, v10
  v_bfe_u32 v132, v114, 5, 1
  s_mov_b32 s57, 0x200
  v_mad_i32_i24 v10, v132, s57, v10
  v_bfe_u32 v132, v114, 6, 2
  s_mov_b32 s57, 0x800
  v_mad_i32_i24 v10, v132, s57, v10
  v_bfe_u32 v132, v114, 3, 1
  v_bfe_u32 v133, v114, 4, 1
  v_and_b32 v132, v132, v133
  s_mov_b32 s57, 0xffffff00
  v_mad_i32_i24 v10, v132, s57, v10
  v_mov_b32 v11, 0x0
  v_bfe_u32 v132, v114, 0, 4
  v_mad_i32_i24 v11, v132, 16, v11
  v_bfe_u32 v132, v114, 4, 2
  s_mov_b32 s57, 0x200
  v_mad_i32_i24 v11, v132, s57, v11
  v_bfe_u32 v132, v114, 6, 1
  s_mov_b32 s57, 0x100
  v_mad_i32_i24 v11, v132, s57, v11
  v_bfe_u32 v132, v114, 7, 1
  s_mov_b32 s57, 0x1000
  v_mad_i32_i24 v11, v132, s57, v11
  v_mov_b32 v15, 0x0
  v_bfe_u32 v132, v114, 0, 3
  v_mad_i32_i24 v15, v132, 8, v15
  v_bfe_u32 v132, v114, 3, 1
  s_mov_b32 s57, 0x2000
  v_mad_i32_i24 v15, v132, s57, v15
  v_bfe_u32 v132, v114, 4, 2
  s_mov_b32 s57, 0x800
  v_mad_i32_i24 v15, v132, s57, v15
  v_mov_b32 v17, 0x0
  v_bfe_u32 v132, v114, 0, 1
  v_mad_i32_i24 v17, v132, 16, v17
  v_bfe_u32 v132, v114, 1, 1
  v_mad_i32_i24 v17, v132, 8, v17
  v_bfe_u32 v132, v114, 2, 1
  s_mov_b32 s57, 0x40000000
  v_mul_lo_u32 v133, v132, s57
  v_add_u32 v17, v17, v133
  v_bfe_u32 v132, v114, 3, 1
  s_mov_b32 s57, 0x40000000
  v_mul_lo_u32 v133, v132, s57
  v_add_u32 v17, v17, v133
  v_bfe_u32 v132, v114, 4, 1
  v_mad_i32_i24 v17, v132, 32, v17
  v_bfe_u32 v132, v114, 5, 1
  v_mad_i32_i24 v17, v132, 4, v17
  v_bfe_u32 v132, v114, 6, 2
  v_mad_i32_i24 v17, v132, 64, v17
  v_bfe_u32 v132, v114, 0, 1
  v_bfe_u32 v133, v114, 2, 1
  v_and_b32 v132, v132, v133
  v_mad_i32_i24 v17, v132, -16, v17
  v_bfe_u32 v132, v114, 1, 1
  v_bfe_u32 v133, v114, 2, 1
  v_and_b32 v132, v132, v133
  v_mad_i32_i24 v17, v132, -8, v17
  v_bfe_u32 v132, v114, 0, 1
  v_bfe_u32 v133, v114, 3, 1
  v_and_b32 v132, v132, v133
  v_mad_i32_i24 v17, v132, -16, v17
  v_bfe_u32 v132, v114, 1, 1
  v_bfe_u32 v133, v114, 3, 1
  v_and_b32 v132, v132, v133
  v_mad_i32_i24 v17, v132, -8, v17
  v_bfe_u32 v132, v114, 2, 1
  v_bfe_u32 v133, v114, 3, 1
  v_and_b32 v132, v132, v133
  s_mov_b32 s57, 0xc0000000
  v_mul_lo_u32 v133, v132, s57
  v_add_u32 v17, v17, v133
  v_bfe_u32 v132, v114, 0, 1
  v_bfe_u32 v133, v114, 2, 1
  v_and_b32 v132, v132, v133
  v_bfe_u32 v133, v114, 3, 1
  v_and_b32 v132, v132, v133
  v_mad_i32_i24 v17, v132, 16, v17
  v_bfe_u32 v132, v114, 1, 1
  v_bfe_u32 v133, v114, 2, 1
  v_and_b32 v132, v132, v133
  v_bfe_u32 v133, v114, 3, 1
  v_and_b32 v132, v132, v133
  v_mad_i32_i24 v17, v132, 8, v17
  v_bfe_u32 v132, v114, 2, 1
  v_bfe_u32 v133, v114, 4, 1
  v_and_b32 v132, v132, v133
  s_mov_b32 s57, 0xffffffe0
  v_mad_i32_i24 v17, v132, s57, v17
  v_bfe_u32 v132, v114, 3, 1
  v_bfe_u32 v133, v114, 4, 1
  v_and_b32 v132, v132, v133
  s_mov_b32 s57, 0xffffffe0
  v_mad_i32_i24 v17, v132, s57, v17
  v_bfe_u32 v132, v114, 2, 1
  v_bfe_u32 v133, v114, 3, 1
  v_and_b32 v132, v132, v133
  v_bfe_u32 v133, v114, 4, 1
  v_and_b32 v132, v132, v133
  v_mad_i32_i24 v17, v132, 32, v17
  v_bfe_u32 v132, v114, 2, 1
  v_bfe_u32 v133, v114, 5, 1
  v_and_b32 v132, v132, v133
  v_mad_i32_i24 v17, v132, -4, v17
  v_bfe_u32 v132, v114, 3, 1
  v_bfe_u32 v133, v114, 5, 1
  v_and_b32 v132, v132, v133
  v_mad_i32_i24 v17, v132, -4, v17
  v_bfe_u32 v132, v114, 2, 1
  v_bfe_u32 v133, v114, 3, 1
  v_and_b32 v132, v132, v133
  v_bfe_u32 v133, v114, 5, 1
  v_and_b32 v132, v132, v133
  v_mad_i32_i24 v17, v132, 4, v17
  v_bfe_u32 v132, v114, 2, 1
  v_bfe_u32 v133, v114, 6, 1
  v_and_b32 v132, v132, v133
  s_mov_b32 s57, 0xffffffc0
  v_mad_i32_i24 v17, v132, s57, v17
  v_bfe_u32 v132, v114, 3, 1
  v_bfe_u32 v133, v114, 6, 1
  v_and_b32 v132, v132, v133
  s_mov_b32 s57, 0xffffffc0
  v_mad_i32_i24 v17, v132, s57, v17
  v_bfe_u32 v132, v114, 2, 1
  v_bfe_u32 v133, v114, 3, 1
  v_and_b32 v132, v132, v133
  v_bfe_u32 v133, v114, 6, 1
  v_and_b32 v132, v132, v133
  v_mad_i32_i24 v17, v132, 64, v17
  v_bfe_u32 v132, v114, 2, 1
  v_bfe_u32 v133, v114, 7, 1
  v_and_b32 v132, v132, v133
  s_mov_b32 s57, 0xffffff80
  v_mad_i32_i24 v17, v132, s57, v17
  v_bfe_u32 v132, v114, 3, 1
  v_bfe_u32 v133, v114, 7, 1
  v_and_b32 v132, v132, v133
  s_mov_b32 s57, 0xffffff80
  v_mad_i32_i24 v17, v132, s57, v17
  v_bfe_u32 v132, v114, 2, 1
  v_bfe_u32 v133, v114, 3, 1
  v_and_b32 v132, v132, v133
  v_bfe_u32 v133, v114, 7, 1
  v_and_b32 v132, v132, v133
  s_mov_b32 s57, 0x80
  v_mad_i32_i24 v17, v132, s57, v17
  s_waitcnt vmcnt(8) lgkmcnt(0)
  s_barrier
  s_mov_b32 m0, s96
  s_add_u32 s94, s81, 0x8300
  buffer_load_dwordx4 v113, s[36:39], s94 offen lds
  buffer_load_dwordx4 v113, s[36:39], s94 offen offset:1024 lds
  v_add_u32 v69, s97, v68
  ds_read2st64_b32 v[20:21], v69 offset0:0 offset1:4
  ds_read2st64_b32 v[22:23], v69 offset0:8 offset1:12
  ds_read2st64_b32 v[24:25], v69 offset0:16 offset1:20
  ds_read2st64_b32 v[26:27], v69 offset0:24 offset1:28
  v_perm_b32 v104, v29, v28, s62
  v_perm_b32 v105, v29, v28, s63
  v_perm_b32 v106, v31, v30, s62
  v_perm_b32 v107, v31, v30, s63
  v_accvgpr_write_b32 a224, v104
  v_accvgpr_write_b32 a225, v105
  v_accvgpr_write_b32 a226, v106
  v_accvgpr_write_b32 a227, v107
  v_perm_b32 v108, v33, v32, s62
  v_perm_b32 v109, v33, v32, s63
  v_perm_b32 v110, v35, v34, s62
  v_perm_b32 v111, v35, v34, s63
  v_accvgpr_write_b32 a228, v108
  v_accvgpr_write_b32 a229, v109
  v_accvgpr_write_b32 a230, v110
  v_accvgpr_write_b32 a231, v111
  s_cmp_eq_u32 s22, 0
  s_cbranch_scc1 L_rf_skip_10
  s_barrier
  s_mov_b32 s22, 0
  s_cmp_lg_u32 s14, 0
  s_cbranch_scc1 L_rf_w_11
  v_mov_b32 v92, 1
  v_mov_b32 v93, 0x40000000
  v_cmp_eq_u32 vcc, 0, v0
  s_nop 1
  v_cndmask_b32 v93, v93, 0, vcc
  buffer_atomic_add v92, v93, s[8:11], 0 offen offset:32 sc1
L_rf_w_11:
L_rf_skip_10:
  s_waitcnt vmcnt(8) lgkmcnt(0)
  s_barrier
  s_mov_b32 m0, s97
  s_add_u32 s94, s81, 0x10000
  buffer_load_dwordx4 v113, s[36:39], s94 offen lds
  buffer_load_dwordx4 v113, s[36:39], s94 offen offset:1024 lds
  v_add_u32 v69, s98, v68
  ds_read2st64_b32 v[28:29], v69 offset0:0 offset1:4
  ds_read2st64_b32 v[30:31], v69 offset0:8 offset1:12
  ds_read2st64_b32 v[32:33], v69 offset0:16 offset1:20
  ds_read2st64_b32 v[34:35], v69 offset0:24 offset1:28
  v_perm_b32 v104, v21, v20, s62
  v_perm_b32 v105, v21, v20, s63
  v_perm_b32 v106, v23, v22, s62
  v_perm_b32 v107, v23, v22, s63
  ds_write_b128 v4, v[104:107] offset:18432
  v_perm_b32 v108, v25, v24, s62
  v_perm_b32 v109, v25, v24, s63
  v_perm_b32 v110, v27, v26, s62
  v_perm_b32 v111, v27, v26, s63
  ds_write_b128 v4, v[108:111] offset:19456
  v_mov_b32 v16, 0x4000
  v_bfe_u32 v132, v114, 0, 2
  v_mad_i32_i24 v16, v132, 16, v16
  v_bfe_u32 v132, v114, 2, 2
  s_mov_b32 s57, 0x140
  v_mad_i32_i24 v16, v132, s57, v16
  v_bfe_u32 v132, v114, 4, 2
  v_mad_i32_i24 v16, v132, 4, v16
  v_bfe_u32 v132, v114, 6, 2
  v_mad_i32_i24 v16, v132, 64, v16
  v_mov_b32 v18, 0x4a00
  v_bfe_u32 v132, v114, 0, 2
  v_mad_i32_i24 v18, v132, 16, v18
  v_bfe_u32 v132, v114, 2, 3
  s_mov_b32 s57, 0x140
  v_mad_i32_i24 v18, v132, s57, v18
  v_bfe_u32 v132, v114, 5, 1
  s_mov_b32 s57, 0xfffff600
  v_mad_i32_i24 v18, v132, s57, v18
  v_bfe_u32 v132, v114, 6, 2
  v_mad_i32_i24 v18, v132, 64, v18
  v_mov_b32 v19, 0x0
  v_bfe_u32 v132, v114, 0, 2
  v_mad_i32_i24 v19, v132, 16, v19
  v_bfe_u32 v132, v114, 2, 3
  s_mov_b32 s57, 0x100
  v_mad_i32_i24 v19, v132, s57, v19
  v_bfe_u32 v132, v114, 5, 1
  s_mov_b32 s57, 0x400000
  v_mad_i32_i24 v19, v132, s57, v19
  v_bfe_u32 v132, v114, 6, 2
  v_mad_i32_i24 v19, v132, 64, v19
  v_bfe_u32 v132, v114, 2, 1
  v_bfe_u32 v133, v114, 5, 1
  v_and_b32 v132, v132, v133
  s_mov_b32 s57, 0xffffff40
  v_mad_i32_i24 v19, v132, s57, v19
  v_bfe_u32 v132, v114, 3, 1
  v_bfe_u32 v133, v114, 5, 1
  v_and_b32 v132, v132, v133
  s_mov_b32 s57, 0xfffffe80
  v_mad_i32_i24 v19, v132, s57, v19
  v_bfe_u32 v132, v114, 4, 1
  v_bfe_u32 v133, v114, 5, 1
  v_and_b32 v132, v132, v133
  s_mov_b32 s57, 0xfffffe00
  v_mad_i32_i24 v19, v132, s57, v19
  v_bfe_u32 v132, v114, 5, 1
  v_bfe_u32 v133, v114, 6, 1
  v_and_b32 v132, v132, v133
  s_mov_b32 s57, 0xc0
  v_mad_i32_i24 v19, v132, s57, v19
  v_bfe_u32 v132, v114, 5, 1
  v_bfe_u32 v133, v114, 7, 1
  v_and_b32 v132, v132, v133
  s_mov_b32 s57, 0x380
  v_mad_i32_i24 v19, v132, s57, v19
  s_waitcnt vmcnt(8) lgkmcnt(0)
  s_barrier
  s_mov_b32 m0, s98
  s_add_u32 s94, s81, 0x10100
  buffer_load_dwordx4 v113, s[36:39], s94 offen lds
  buffer_load_dwordx4 v113, s[36:39], s94 offen offset:1024 lds
  v_add_u32 v69, s99, v68
  ds_read2st64_b32 v[20:21], v69 offset0:0 offset1:4
  ds_read2st64_b32 v[22:23], v69 offset0:8 offset1:12
  ds_read2st64_b32 v[24:25], v69 offset0:16 offset1:20
  ds_read2st64_b32 v[26:27], v69 offset0:24 offset1:28
  v_perm_b32 v104, v29, v28, s62
  v_perm_b32 v105, v29, v28, s63
  v_perm_b32 v106, v31, v30, s62
  v_perm_b32 v107, v31, v30, s63
  ds_write_b128 v4, v[104:107] offset:20480
  v_perm_b32 v108, v33, v32, s62
  v_perm_b32 v109, v33, v32, s63
  v_perm_b32 v110, v35, v34, s62
  v_perm_b32 v111, v35, v34, s63
  ds_write_b128 v4, v[108:111] offset:21504
  v_mov_b32 v14, 0x0
  v_bfe_u32 v132, v114, 0, 4
  s_mov_b32 s57, 0x80
  v_mad_i32_i24 v14, v132, s57, v14
  v_bfe_u32 v132, v114, 4, 1
  s_mov_b32 s57, 0x40000000
  v_mul_lo_u32 v133, v132, s57
  v_add_u32 v14, v14, v133
  v_bfe_u32 v132, v114, 5, 1
  s_mov_b32 s57, 0x40000000
  v_mul_lo_u32 v133, v132, s57
  v_add_u32 v14, v14, v133
  v_bfe_u32 v132, v114, 6, 2
  s_mov_b32 s57, 0x800
  v_mad_i32_i24 v14, v132, s57, v14
  v_bfe_u32 v132, v114, 0, 1
  v_bfe_u32 v133, v114, 4, 1
  v_and_b32 v132, v132, v133
  s_mov_b32 s57, 0xffffff80
  v_mad_i32_i24 v14, v132, s57, v14
  v_bfe_u32 v132, v114, 1, 1
  v_bfe_u32 v133, v114, 4, 1
  v_and_b32 v132, v132, v133
  s_mov_b32 s57, 0xffffff00
  v_mad_i32_i24 v14, v132, s57, v14
  v_bfe_u32 v132, v114, 2, 1
  v_bfe_u32 v133, v114, 4, 1
  v_and_b32 v132, v132, v133
  s_mov_b32 s57, 0xfffffe00
  v_mad_i32_i24 v14, v132, s57, v14
  v_bfe_u32 v132, v114, 3, 1
  v_bfe_u32 v133, v114, 4, 1
  v_and_b32 v132, v132, v133
  s_mov_b32 s57, 0xfffffc00
  v_mad_i32_i24 v14, v132, s57, v14
  v_bfe_u32 v132, v114, 0, 1
  v_bfe_u32 v133, v114, 5, 1
  v_and_b32 v132, v132, v133
  s_mov_b32 s57, 0xffffff80
  v_mad_i32_i24 v14, v132, s57, v14
  v_bfe_u32 v132, v114, 1, 1
  v_bfe_u32 v133, v114, 5, 1
  v_and_b32 v132, v132, v133
  s_mov_b32 s57, 0xffffff00
  v_mad_i32_i24 v14, v132, s57, v14
  v_bfe_u32 v132, v114, 2, 1
  v_bfe_u32 v133, v114, 5, 1
  v_and_b32 v132, v132, v133
  s_mov_b32 s57, 0xfffffe00
  v_mad_i32_i24 v14, v132, s57, v14
  v_bfe_u32 v132, v114, 3, 1
  v_bfe_u32 v133, v114, 5, 1
  v_and_b32 v132, v132, v133
  s_mov_b32 s57, 0xfffffc00
  v_mad_i32_i24 v14, v132, s57, v14
  v_bfe_u32 v132, v114, 4, 1
  v_bfe_u32 v133, v114, 5, 1
  v_and_b32 v132, v132, v133
  s_mov_b32 s57, 0xc0000000
  v_mul_lo_u32 v133, v132, s57
  v_add_u32 v14, v14, v133
  v_bfe_u32 v132, v114, 0, 1
  v_bfe_u32 v133, v114, 4, 1
  v_and_b32 v132, v132, v133
  v_bfe_u32 v133, v114, 5, 1
  v_and_b32 v132, v132, v133
  s_mov_b32 s57, 0x80
  v_mad_i32_i24 v14, v132, s57, v14
  v_bfe_u32 v132, v114, 1, 1
  v_bfe_u32 v133, v114, 4, 1
  v_and_b32 v132, v132, v133
  v_bfe_u32 v133, v114, 5, 1
  v_and_b32 v132, v132, v133
  s_mov_b32 s57, 0x100
  v_mad_i32_i24 v14, v132, s57, v14
  v_bfe_u32 v132, v114, 2, 1
  v_bfe_u32 v133, v114, 4, 1
  v_and_b32 v132, v132, v133
  v_bfe_u32 v133, v114, 5, 1
  v_and_b32 v132, v132, v133
  s_mov_b32 s57, 0x200
  v_mad_i32_i24 v14, v132, s57, v14
  v_bfe_u32 v132, v114, 3, 1
  v_bfe_u32 v133, v114, 4, 1
  v_and_b32 v132, v132, v133
  v_bfe_u32 v133, v114, 5, 1
  v_and_b32 v132, v132, v133
  s_mov_b32 s57, 0x400
  v_mad_i32_i24 v14, v132, s57, v14
  v_bfe_u32 v132, v114, 4, 1
  v_bfe_u32 v133, v114, 6, 1
  v_and_b32 v132, v132, v133
  s_mov_b32 s57, 0xfffff800
  v_mad_i32_i24 v14, v132, s57, v14
  v_bfe_u32 v132, v114, 5, 1
  v_bfe_u32 v133, v114, 6, 1
  v_and_b32 v132, v132, v133
  s_mov_b32 s57, 0xfffff800
  v_mad_i32_i24 v14, v132, s57, v14
  v_bfe_u32 v132, v114, 4, 1
  v_bfe_u32 v133, v114, 5, 1
  v_and_b32 v132, v132, v133
  v_bfe_u32 v133, v114, 6, 1
  v_and_b32 v132, v132, v133
  s_mov_b32 s57, 0x800
  v_mad_i32_i24 v14, v132, s57, v14
  v_bfe_u32 v132, v114, 4, 1
  v_bfe_u32 v133, v114, 7, 1
  v_and_b32 v132, v132, v133
  s_mov_b32 s57, 0xfffff000
  v_mad_i32_i24 v14, v132, s57, v14
  v_bfe_u32 v132, v114, 5, 1
  v_bfe_u32 v133, v114, 7, 1
  v_and_b32 v132, v132, v133
  s_mov_b32 s57, 0xfffff000
  v_mad_i32_i24 v14, v132, s57, v14
  v_bfe_u32 v132, v114, 4, 1
  v_bfe_u32 v133, v114, 5, 1
  v_and_b32 v132, v132, v133
  v_bfe_u32 v133, v114, 7, 1
  v_and_b32 v132, v132, v133
  s_mov_b32 s57, 0x1000
  v_mad_i32_i24 v14, v132, s57, v14
  v_and_b32 v132, 63, v114
  v_lshlrev_b32 v0, 2, v132
  s_waitcnt vmcnt(8) lgkmcnt(0)
  s_barrier
  s_mov_b32 m0, s99
  s_add_u32 s94, s81, 0x10200
  buffer_load_dwordx4 v113, s[36:39], s94 offen lds
  buffer_load_dwordx4 v113, s[36:39], s94 offen offset:1024 lds
  v_add_u32 v69, s100, v68
  ds_read2st64_b32 v[28:29], v69 offset0:0 offset1:4
  ds_read2st64_b32 v[30:31], v69 offset0:8 offset1:12
  ds_read2st64_b32 v[32:33], v69 offset0:16 offset1:20
  ds_read2st64_b32 v[34:35], v69 offset0:24 offset1:28
  v_perm_b32 v104, v21, v20, s62
  v_perm_b32 v105, v21, v20, s63
  v_perm_b32 v106, v23, v22, s62
  v_perm_b32 v107, v23, v22, s63
  v_accvgpr_write_b32 a200, v104
  v_accvgpr_write_b32 a201, v105
  v_accvgpr_write_b32 a202, v106
  v_accvgpr_write_b32 a203, v107
  v_perm_b32 v108, v25, v24, s62
  v_perm_b32 v109, v25, v24, s63
  v_perm_b32 v110, v27, v26, s62
  v_perm_b32 v111, v27, v26, s63
  v_accvgpr_write_b32 a204, v108
  v_accvgpr_write_b32 a205, v109
  v_accvgpr_write_b32 a206, v110
  v_accvgpr_write_b32 a207, v111
  s_waitcnt vmcnt(8) lgkmcnt(0)
  s_barrier
  s_mov_b32 m0, s100
  s_add_u32 s94, s81, 0x10300
  buffer_load_dwordx4 v113, s[36:39], s94 offen lds
  buffer_load_dwordx4 v113, s[36:39], s94 offen offset:1024 lds
  v_add_u32 v69, s95, v68
  ds_read2st64_b32 v[20:21], v69 offset0:0 offset1:4
  ds_read2st64_b32 v[22:23], v69 offset0:8 offset1:12
  ds_read2st64_b32 v[24:25], v69 offset0:16 offset1:20
  ds_read2st64_b32 v[26:27], v69 offset0:24 offset1:28
  v_perm_b32 v104, v29, v28, s62
  v_perm_b32 v105, v29, v28, s63
  v_perm_b32 v106, v31, v30, s62
  v_perm_b32 v107, v31, v30, s63
  v_accvgpr_write_b32 a232, v104
  v_accvgpr_write_b32 a233, v105
  v_accvgpr_write_b32 a234, v106
  v_accvgpr_write_b32 a235, v107
  v_perm_b32 v108, v33, v32, s62
  v_perm_b32 v109, v33, v32, s63
  v_perm_b32 v110, v35, v34, s62
  v_perm_b32 v111, v35, v34, s63
  v_accvgpr_write_b32 a236, v108
  v_accvgpr_write_b32 a237, v109
  v_accvgpr_write_b32 a238, v110
  v_accvgpr_write_b32 a239, v111
  v_mov_b32 v116, 0x3f80
  v_bfe_u32 v132, v114, 0, 1
  s_mov_b32 s57, 0x3f7fc080
  v_mul_lo_u32 v133, v132, s57
  v_add_u32 v116, v116, v133
  v_bfe_u32 v132, v114, 2, 1
  s_mov_b32 s57, 0xffffc080
  v_mad_i32_i24 v116, v132, s57, v116
  v_bfe_u32 v132, v114, 3, 1
  s_mov_b32 s57, 0xffffc080
  v_mad_i32_i24 v116, v132, s57, v116
  v_bfe_u32 v132, v114, 0, 1
  v_bfe_u32 v133, v114, 2, 1
  v_and_b32 v132, v132, v133
  s_mov_b32 s57, 0xc0803f80
  v_mul_lo_u32 v133, v132, s57
  v_add_u32 v116, v116, v133
  v_bfe_u32 v132, v114, 0, 1
  v_bfe_u32 v133, v114, 3, 1
  v_and_b32 v132, v132, v133
  s_mov_b32 s57, 0xc0803f80
  v_mul_lo_u32 v133, v132, s57
  v_add_u32 v116, v116, v133
  v_bfe_u32 v132, v114, 2, 1
  v_bfe_u32 v133, v114, 3, 1
  v_and_b32 v132, v132, v133
  s_mov_b32 s57, 0x3f80
  v_mad_i32_i24 v116, v132, s57, v116
  v_bfe_u32 v132, v114, 0, 1
  v_bfe_u32 v133, v114, 2, 1
  v_and_b32 v132, v132, v133
  v_bfe_u32 v133, v114, 3, 1
  v_and_b32 v132, v132, v133
  s_mov_b32 s57, 0x3f7fc080
  v_mul_lo_u32 v133, v132, s57
  v_add_u32 v116, v116, v133
  v_mov_b32 v117, 0x0
  v_bfe_u32 v132, v114, 2, 1
  s_mov_b32 s57, 0x3f80
  v_mad_i32_i24 v117, v132, s57, v117
  v_bfe_u32 v132, v114, 0, 1
  v_bfe_u32 v133, v114, 2, 1
  v_and_b32 v132, v132, v133
  s_mov_b32 s57, 0x3f7fc080
  v_mul_lo_u32 v133, v132, s57
  v_add_u32 v117, v117, v133
  v_bfe_u32 v132, v114, 2, 1
  v_bfe_u32 v133, v114, 3, 1
  v_and_b32 v132, v132, v133
  s_mov_b32 s57, 0xffffc080
  v_mad_i32_i24 v117, v132, s57, v117
  v_bfe_u32 v132, v114, 0, 1
  v_bfe_u32 v133, v114, 2, 1
  v_and_b32 v132, v132, v133
  v_bfe_u32 v133, v114, 3, 1
  v_and_b32 v132, v132, v133
  s_mov_b32 s57, 0xc0803f80
  v_mul_lo_u32 v133, v132, s57
  v_add_u32 v117, v117, v133
  v_mov_b32 v118, 0x0
  v_bfe_u32 v132, v114, 3, 1
  s_mov_b32 s57, 0x3f80
  v_mad_i32_i24 v118, v132, s57, v118
  v_bfe_u32 v132, v114, 0, 1
  v_bfe_u32 v133, v114, 3, 1
  v_and_b32 v132, v132, v133
  s_mov_b32 s57, 0x3f7fc080
  v_mul_lo_u32 v133, v132, s57
  v_add_u32 v118, v118, v133
  v_bfe_u32 v132, v114, 2, 1
  v_bfe_u32 v133, v114, 3, 1
  v_and_b32 v132, v132, v133
  s_mov_b32 s57, 0xffffc080
  v_mad_i32_i24 v118, v132, s57, v118
  v_bfe_u32 v132, v114, 0, 1
  v_bfe_u32 v133, v114, 2, 1
  v_and_b32 v132, v132, v133
  v_bfe_u32 v133, v114, 3, 1
  v_and_b32 v132, v132, v133
  s_mov_b32 s57, 0xc0803f80
  v_mul_lo_u32 v133, v132, s57
  v_add_u32 v118, v118, v133
  s_waitcnt vmcnt(8) lgkmcnt(0)
  s_barrier
  s_mov_b32 m0, s95
  s_add_u32 s94, s81, 0x18000
  buffer_load_dwordx4 v113, s[36:39], s94 offen lds
  buffer_load_dwordx4 v113, s[36:39], s94 offen offset:1024 lds
  v_add_u32 v69, s96, v68
  ds_read2st64_b32 v[28:29], v69 offset0:0 offset1:4
  ds_read2st64_b32 v[30:31], v69 offset0:8 offset1:12
  ds_read2st64_b32 v[32:33], v69 offset0:16 offset1:20
  ds_read2st64_b32 v[34:35], v69 offset0:24 offset1:28
  v_perm_b32 v104, v21, v20, s62
  v_perm_b32 v105, v21, v20, s63
  v_perm_b32 v106, v23, v22, s62
  v_perm_b32 v107, v23, v22, s63
  ds_write_b128 v4, v[104:107] offset:22528
  v_perm_b32 v108, v25, v24, s62
  v_perm_b32 v109, v25, v24, s63
  v_perm_b32 v110, v27, v26, s62
  v_perm_b32 v111, v27, v26, s63
  ds_write_b128 v4, v[108:111] offset:23552
  v_mov_b32 v119, 0x0
  v_bfe_u32 v132, v114, 2, 1
  v_bfe_u32 v133, v114, 3, 1
  v_and_b32 v132, v132, v133
  s_mov_b32 s57, 0x3f80
  v_mad_i32_i24 v119, v132, s57, v119
  v_bfe_u32 v132, v114, 0, 1
  v_bfe_u32 v133, v114, 2, 1
  v_and_b32 v132, v132, v133
  v_bfe_u32 v133, v114, 3, 1
  v_and_b32 v132, v132, v133
  s_mov_b32 s57, 0x3f7fc080
  v_mul_lo_u32 v133, v132, s57
  v_add_u32 v119, v119, v133
  ds_write_b128 v6, v[116:119] offset:256
  s_mov_b32 s45, 0
  s_mov_b32 s47, 0
  s_mov_b32 s46, 0
  s_mov_b32 s48, 0x100000
  s_mov_b32 s49, 0x3f80000
  s_lshl_b32 s57, s44, 8
  s_add_u32 s50, s57, 0x3f82000
  s_add_u32 s55, s57, 0x4000000
  s_add_u32 s56, s57, 0x4002000
  s_lshl_b32 s57, s44, 11
  s_add_u32 s51, s57, 0x2000000
  s_add_u32 s79, s57, 0x4800000
  s_mov_b32 s78, 0
  s_cmp_eq_u32 s14, 0
  s_cselect_b32 s72, 1, 0
  s_mov_b32 s73, 0
  s_add_u32 s52, s57, 0x2400000
  s_lshl_b32 s57, s44, 13
  s_add_u32 s53, s57, 0x0
  s_add_u32 s54, s57, 0x1000000
  s_mov_b32 s58, 0
  s_mov_b32 s59, -1
  s_mov_b32 s60, 0x3f803f80
  s_mov_b32 s61, 0x3f803f80
  s_mov_b32 s64, 0x3e0293ee
  s_mov_b32 s65, 0x3e0293ee
  s_mov_b32 s66, 0xbe0293ee
  s_lshl_b32 s67, s14, 11
  s_add_u32 s67, s67, 8192
  s_lshl_b32 s57, s14, 14
  s_lshl_b32 s80, s44, 6
  s_add_u32 s57, s57, s80
  s_add_u32 s68, s57, 0x3f00000
  s_add_u32 s69, s57, 0x3f10000
  s_add_u32 s70, s57, 0x3f20000
  s_add_u32 s71, s57, 0x3f30000
  s_lshl_b32 s57, s44, 13
  s_add_u32 s76, s57, 0x3f00000
  s_lshr_b32 s77, s44, 3
  s_waitcnt vmcnt(8) lgkmcnt(0)
  s_barrier
  s_mov_b32 m0, s96
  s_add_u32 s94, s81, 0x18100
  buffer_load_dwordx4 v113, s[36:39], s94 offen lds
  buffer_load_dwordx4 v113, s[36:39], s94 offen offset:1024 lds
  v_add_u32 v69, s97, v68
  ds_read2st64_b32 v[20:21], v69 offset0:0 offset1:4
  ds_read2st64_b32 v[22:23], v69 offset0:8 offset1:12
  ds_read2st64_b32 v[24:25], v69 offset0:16 offset1:20
  ds_read2st64_b32 v[26:27], v69 offset0:24 offset1:28
  v_perm_b32 v104, v29, v28, s62
  v_perm_b32 v105, v29, v28, s63
  v_perm_b32 v106, v31, v30, s62
  v_perm_b32 v107, v31, v30, s63
  ds_write_b128 v4, v[104:107] offset:24576
  v_perm_b32 v108, v33, v32, s62
  v_perm_b32 v109, v33, v32, s63
  v_perm_b32 v110, v35, v34, s62
  v_perm_b32 v111, v35, v34, s63
  ds_write_b128 v4, v[108:111] offset:25600
  s_waitcnt vmcnt(8) lgkmcnt(0)
  s_barrier
  s_mov_b32 m0, s97
  s_add_u32 s94, s81, 0x18200
  buffer_load_dwordx4 v113, s[36:39], s94 offen lds
  buffer_load_dwordx4 v113, s[36:39], s94 offen offset:1024 lds
  v_add_u32 v69, s98, v68
  ds_read2st64_b32 v[28:29], v69 offset0:0 offset1:4
  ds_read2st64_b32 v[30:31], v69 offset0:8 offset1:12
  ds_read2st64_b32 v[32:33], v69 offset0:16 offset1:20
  ds_read2st64_b32 v[34:35], v69 offset0:24 offset1:28
  v_perm_b32 v104, v21, v20, s62
  v_perm_b32 v105, v21, v20, s63
  v_perm_b32 v106, v23, v22, s62
  v_perm_b32 v107, v23, v22, s63
  v_accvgpr_write_b32 a208, v104
  v_accvgpr_write_b32 a209, v105
  v_accvgpr_write_b32 a210, v106
  v_accvgpr_write_b32 a211, v107
  v_perm_b32 v108, v25, v24, s62
  v_perm_b32 v109, v25, v24, s63
  v_perm_b32 v110, v27, v26, s62
  v_perm_b32 v111, v27, v26, s63
  v_accvgpr_write_b32 a212, v108
  v_accvgpr_write_b32 a213, v109
  v_accvgpr_write_b32 a214, v110
  v_accvgpr_write_b32 a215, v111
  s_waitcnt vmcnt(8) lgkmcnt(0)
  s_barrier
  s_mov_b32 m0, s98
  s_add_u32 s94, s81, 0x18300
  buffer_load_dwordx4 v113, s[36:39], s94 offen lds
  buffer_load_dwordx4 v113, s[36:39], s94 offen offset:1024 lds
  v_add_u32 v69, s99, v68
  ds_read2st64_b32 v[20:21], v69 offset0:0 offset1:4
  ds_read2st64_b32 v[22:23], v69 offset0:8 offset1:12
  ds_read2st64_b32 v[24:25], v69 offset0:16 offset1:20
  ds_read2st64_b32 v[26:27], v69 offset0:24 offset1:28
  v_perm_b32 v104, v29, v28, s62
  v_perm_b32 v105, v29, v28, s63
  v_perm_b32 v106, v31, v30, s62
  v_perm_b32 v107, v31, v30, s63
  v_accvgpr_write_b32 a240, v104
  v_accvgpr_write_b32 a241, v105
  v_accvgpr_write_b32 a242, v106
  v_accvgpr_write_b32 a243, v107
  v_perm_b32 v108, v33, v32, s62
  v_perm_b32 v109, v33, v32, s63
  v_perm_b32 v110, v35, v34, s62
  v_perm_b32 v111, v35, v34, s63
  v_accvgpr_write_b32 a244, v108
  v_accvgpr_write_b32 a245, v109
  v_accvgpr_write_b32 a246, v110
  v_accvgpr_write_b32 a247, v111
  s_waitcnt vmcnt(8) lgkmcnt(0)
  s_barrier
  s_mov_b32 m0, s99
  s_add_u32 s94, s86, 7168
  buffer_load_dwordx4 v112, s[88:91], s86 offen nt lds
  buffer_load_dwordx4 v112, s[88:91], s94 offen offset:1024 nt lds
  s_add_u32 s86, s86, 0x40000
  v_add_u32 v69, s100, v68
  ds_read2st64_b32 v[28:29], v69 offset0:0 offset1:4
  ds_read2st64_b32 v[30:31], v69 offset0:8 offset1:12
  ds_read2st64_b32 v[32:33], v69 offset0:16 offset1:20
  ds_read2st64_b32 v[34:35], v69 offset0:24 offset1:28
  v_perm_b32 v36, v21, v20, s62
  v_perm_b32 v37, v21, v20, s63
  v_perm_b32 v38, v23, v22, s62
  v_perm_b32 v39, v23, v22, s63
  v_perm_b32 v40, v25, v24, s62
  v_perm_b32 v41, v25, v24, s63
  v_perm_b32 v42, v27, v26, s62
  v_perm_b32 v43, v27, v26, s63
  s_waitcnt vmcnt(8) lgkmcnt(0)
  s_barrier
  s_mov_b32 m0, s100
  s_add_u32 s94, s86, 7168
  buffer_load_dwordx4 v112, s[88:91], s86 offen nt lds
  buffer_load_dwordx4 v112, s[88:91], s94 offen offset:1024 nt lds
  s_add_u32 s86, s86, 0x40000
  v_add_u32 v69, s95, v68
  ds_read2st64_b32 v[20:21], v69 offset0:0 offset1:4
  ds_read2st64_b32 v[22:23], v69 offset0:8 offset1:12
  ds_read2st64_b32 v[24:25], v69 offset0:16 offset1:20
  ds_read2st64_b32 v[26:27], v69 offset0:24 offset1:28
  v_perm_b32 v44, v29, v28, s62
  v_perm_b32 v45, v29, v28, s63
  v_perm_b32 v46, v31, v30, s62
  v_perm_b32 v47, v31, v30, s63
  v_perm_b32 v48, v33, v32, s62
  v_perm_b32 v49, v33, v32, s63
  v_perm_b32 v50, v35, v34, s62
  v_perm_b32 v51, v35, v34, s63
  s_waitcnt vmcnt(8) lgkmcnt(0)
  s_barrier
  s_mov_b32 m0, s95
  s_add_u32 s94, s86, 7168
  buffer_load_dwordx4 v112, s[88:91], s86 offen nt lds
  buffer_load_dwordx4 v112, s[88:91], s94 offen offset:1024 nt lds
  s_add_u32 s86, s86, 0x40000
  v_add_u32 v69, s96, v68
  ds_read2st64_b32 v[28:29], v69 offset0:0 offset1:4
  ds_read2st64_b32 v[30:31], v69 offset0:8 offset1:12
  ds_read2st64_b32 v[32:33], v69 offset0:16 offset1:20
  ds_read2st64_b32 v[34:35], v69 offset0:24 offset1:28
  v_perm_b32 v104, v21, v20, s62
  v_perm_b32 v105, v21, v20, s63
  v_perm_b32 v106, v23, v22, s62
  v_perm_b32 v107, v23, v22, s63
  v_accvgpr_write_b32 a216, v104
  v_accvgpr_write_b32 a217, v105
  v_accvgpr_write_b32 a218, v106
  v_accvgpr_write_b32 a219, v107
  v_perm_b32 v108, v25, v24, s62
  v_perm_b32 v109, v25, v24, s63
  v_perm_b32 v110, v27, v26, s62
  v_perm_b32 v111, v27, v26, s63
  v_accvgpr_write_b32 a220, v108
  v_accvgpr_write_b32 a221, v109
  v_accvgpr_write_b32 a222, v110
  v_accvgpr_write_b32 a223, v111
  s_waitcnt vmcnt(8) lgkmcnt(0)
  s_barrier
  s_mov_b32 m0, s96
  s_add_u32 s94, s86, 7168
  buffer_load_dwordx4 v112, s[88:91], s86 offen nt lds
  buffer_load_dwordx4 v112, s[88:91], s94 offen offset:1024 nt lds
  s_add_u32 s86, s86, 0x40000
  v_add_u32 v69, s97, v68
  ds_read2st64_b32 v[20:21], v69 offset0:0 offset1:4
  ds_read2st64_b32 v[22:23], v69 offset0:8 offset1:12
  ds_read2st64_b32 v[24:25], v69 offset0:16 offset1:20
  ds_read2st64_b32 v[26:27], v69 offset0:24 offset1:28
  v_perm_b32 v104, v29, v28, s62
  v_perm_b32 v105, v29, v28, s63
  v_perm_b32 v106, v31, v30, s62
  v_perm_b32 v107, v31, v30, s63
  v_accvgpr_write_b32 a248, v104
  v_accvgpr_write_b32 a249, v105
  v_accvgpr_write_b32 a250, v106
  v_accvgpr_write_b32 a251, v107
  v_perm_b32 v108, v33, v32, s62
  v_perm_b32 v109, v33, v32, s63
  v_perm_b32 v110, v35, v34, s62
  v_perm_b32 v111, v35, v34, s63
  v_accvgpr_write_b32 a252, v108
  v_accvgpr_write_b32 a253, v109
  v_accvgpr_write_b32 a254, v110
  v_accvgpr_write_b32 a255, v111
  s_waitcnt vmcnt(8) lgkmcnt(0)
  s_barrier
  s_mov_b32 m0, s97
  s_add_u32 s94, s86, 7168
  buffer_load_dwordx4 v112, s[88:91], s86 offen nt lds
  buffer_load_dwordx4 v112, s[88:91], s94 offen offset:1024 nt lds
  s_add_u32 s86, s86, 0x40000
  v_add_u32 v69, s98, v68
  ds_read2st64_b32 v[28:29], v69 offset0:0 offset1:4
  ds_read2st64_b32 v[30:31], v69 offset0:8 offset1:12
  ds_read2st64_b32 v[32:33], v69 offset0:16 offset1:20
  ds_read2st64_b32 v[34:35], v69 offset0:24 offset1:28
  v_perm_b32 v52, v21, v20, s62
  v_perm_b32 v53, v21, v20, s63
  v_perm_b32 v54, v23, v22, s62
  v_perm_b32 v55, v23, v22, s63
  v_perm_b32 v56, v25, v24, s62
  v_perm_b32 v57, v25, v24, s63
  v_perm_b32 v58, v27, v26, s62
  v_perm_b32 v59, v27, v26, s63
  s_waitcnt lgkmcnt(3)
  v_perm_b32 v60, v29, v28, s62
  v_perm_b32 v61, v29, v28, s63
  s_waitcnt lgkmcnt(2)
  v_perm_b32 v62, v31, v30, s62
  v_perm_b32 v63, v31, v30, s63
  s_waitcnt lgkmcnt(1)
  v_perm_b32 v64, v33, v32, s62
  v_perm_b32 v65, v33, v32, s63
  s_waitcnt lgkmcnt(0)
  v_perm_b32 v66, v35, v34, s62
  v_perm_b32 v67, v35, v34, s63
  s_mov_b32 s101, s95
  s_mov_b32 s95, s99
  s_mov_b32 s99, s97
  s_mov_b32 s97, s101
  s_mov_b32 s101, s96
  s_mov_b32 s96, s100
  s_mov_b32 s100, s98
  s_mov_b32 s98, s101
  s_mov_b32 s93, 0
L_lw_top_12:
  s_xor_b32 s94, s93, s14
  s_cmp_eq_u32 s94, 1
  s_cbranch_scc1 L_lw_c_16
  s_cmp_eq_u32 s94, 2
  s_cbranch_scc1 L_lw_c_17
  s_cmp_eq_u32 s94, 3
  s_cbranch_scc1 L_lw_c_18
L_lw_c_15:
  s_waitcnt vmcnt(8) lgkmcnt(0)
  s_barrier
  s_mov_b32 m0, s100
  s_add_u32 s94, s86, 7168
  buffer_load_dwordx4 v112, s[88:91], s86 offen nt lds
  buffer_load_dwordx4 v112, s[88:91], s94 offen offset:1024 nt lds
  s_add_u32 s86, s86, 0x40000
  v_add_u32 v69, s95, v68
  ds_read2st64_b32 v[20:21], v69 offset0:0 offset1:4
  ds_read2st64_b32 v[22:23], v69 offset0:8 offset1:12
  ds_read2st64_b32 v[24:25], v69 offset0:16 offset1:20
  ds_read2st64_b32 v[26:27], v69 offset0:24 offset1:28
  s_waitcnt vmcnt(8) lgkmcnt(0)
  s_barrier
  s_mov_b32 m0, s95
  s_add_u32 s94, s86, 7168
  buffer_load_dwordx4 v112, s[88:91], s86 offen nt lds
  buffer_load_dwordx4 v112, s[88:91], s94 offen offset:1024 nt lds
  s_add_u32 s86, s86, 0x40000
  v_add_u32 v69, s96, v68
  ds_read2st64_b32 v[28:29], v69 offset0:0 offset1:4
  ds_read2st64_b32 v[30:31], v69 offset0:8 offset1:12
  ds_read2st64_b32 v[32:33], v69 offset0:16 offset1:20
  ds_read2st64_b32 v[34:35], v69 offset0:24 offset1:28
  v_perm_b32 v192, v21, v20, s62
  v_perm_b32 v193, v23, v22, s62
  v_perm_b32 v194, v25, v24, s62
  v_perm_b32 v195, v27, v26, s62
  v_perm_b32 v200, v21, v20, s63
  v_perm_b32 v201, v23, v22, s63
  v_perm_b32 v202, v25, v24, s63
  v_perm_b32 v203, v27, v26, s63
  s_waitcnt vmcnt(8) lgkmcnt(0)
  s_barrier
  s_mov_b32 m0, s96
  s_add_u32 s94, s86, 7168
  buffer_load_dwordx4 v112, s[88:91], s86 offen nt lds
  buffer_load_dwordx4 v112, s[88:91], s94 offen offset:1024 nt lds
  s_add_u32 s86, s86, 0x40000
  v_add_u32 v69, s97, v68
  ds_read2st64_b32 v[20:21], v69 offset0:0 offset1:4
  ds_read2st64_b32 v[22:23], v69 offset0:8 offset1:12
  ds_read2st64_b32 v[24:25], v69 offset0:16 offset1:20
  ds_read2st64_b32 v[26:27], v69 offset0:24 offset1:28
  v_perm_b32 v196, v29, v28, s62
  v_perm_b32 v197, v31, v30, s62
  v_perm_b32 v198, v33, v32, s62
  v_perm_b32 v199, v35, v34, s62
  v_perm_b32 v204, v29, v28, s63
  v_perm_b32 v205, v31, v30, s63
  v_perm_b32 v206, v33, v32, s63
  v_perm_b32 v207, v35, v34, s63
  s_waitcnt vmcnt(8) lgkmcnt(0)
  s_barrier
  s_cmp_lg_u32 s93, 2
  s_cbranch_scc1 L_lw_keep6_19
  s_mov_b64 s[88:89], s[32:33]
  s_mov_b64 s[90:91], s[34:35]
  s_mov_b32 s86, s23
L_lw_keep6_19:
  s_mov_b32 m0, s97
  s_add_u32 s94, s86, 7168
  buffer_load_dwordx4 v112, s[88:91], s86 offen nt lds
  buffer_load_dwordx4 v112, s[88:91], s94 offen offset:1024 nt lds
  s_add_u32 s86, s86, 0x40000
  v_add_u32 v69, s98, v68
  ds_read2st64_b32 v[28:29], v69 offset0:0 offset1:4
  ds_read2st64_b32 v[30:31], v69 offset0:8 offset1:12
  ds_read2st64_b32 v[32:33], v69 offset0:16 offset1:20
  ds_read2st64_b32 v[34:35], v69 offset0:24 offset1:28
  v_perm_b32 v208, v21, v20, s62
  v_perm_b32 v209, v23, v22, s62
  v_perm_b32 v210, v25, v24, s62
  v_perm_b32 v211, v27, v26, s62
  v_perm_b32 v216, v21, v20, s63
  v_perm_b32 v217, v23, v22, s63
  v_perm_b32 v218, v25, v24, s63
  v_perm_b32 v219, v27, v26, s63
  s_waitcnt lgkmcnt(3)
  v_perm_b32 v212, v29, v28, s62
  s_waitcnt lgkmcnt(2)
  v_perm_b32 v213, v31, v30, s62
  s_waitcnt lgkmcnt(1)
  v_perm_b32 v214, v33, v32, s62
  s_waitcnt lgkmcnt(0)
  v_perm_b32 v215, v35, v34, s62
  v_perm_b32 v220, v29, v28, s63
  v_perm_b32 v221, v31, v30, s63
  v_perm_b32 v222, v33, v32, s63
  v_perm_b32 v223, v35, v34, s63
  s_branch L_lw_next_13
L_lw_c_16:
  s_waitcnt vmcnt(8) lgkmcnt(0)
  s_barrier
  s_mov_b32 m0, s100
  s_add_u32 s94, s86, 7168
  buffer_load_dwordx4 v112, s[88:91], s86 offen nt lds
  buffer_load_dwordx4 v112, s[88:91], s94 offen offset:1024 nt lds
  s_add_u32 s86, s86, 0x40000
  v_add_u32 v69, s95, v68
  ds_read2st64_b32 v[20:21], v69 offset0:0 offset1:4
  ds_read2st64_b32 v[22:23], v69 offset0:8 offset1:12
  ds_read2st64_b32 v[24:25], v69 offset0:16 offset1:20
  ds_read2st64_b32 v[26:27], v69 offset0:24 offset1:28
  s_waitcnt vmcnt(8) lgkmcnt(0)
  s_barrier
  s_mov_b32 m0, s95
  s_add_u32 s94, s86, 7168
  buffer_load_dwordx4 v112, s[88:91], s86 offen nt lds
  buffer_load_dwordx4 v112, s[88:91], s94 offen offset:1024 nt lds
  s_add_u32 s86, s86, 0x40000
  v_add_u32 v69, s96, v68
  ds_read2st64_b32 v[28:29], v69 offset0:0 offset1:4
  ds_read2st64_b32 v[30:31], v69 offset0:8 offset1:12
  ds_read2st64_b32 v[32:33], v69 offset0:16 offset1:20
  ds_read2st64_b32 v[34:35], v69 offset0:24 offset1:28
  v_perm_b32 v224, v21, v20, s62
  v_perm_b32 v225, v23, v22, s62
  v_perm_b32 v226, v25, v24, s62
  v_perm_b32 v227, v27, v26, s62
  v_perm_b32 v232, v21, v20, s63
  v_perm_b32 v233, v23, v22, s63
  v_perm_b32 v234, v25, v24, s63
  v_perm_b32 v235, v27, v26, s63
  s_waitcnt vmcnt(8) lgkmcnt(0)
  s_barrier
  s_mov_b32 m0, s96
  s_add_u32 s94, s86, 7168
  buffer_load_dwordx4 v112, s[88:91], s86 offen nt lds
  buffer_load_dwordx4 v112, s[88:91], s94 offen offset:1024 nt lds
  s_add_u32 s86, s86, 0x40000
  v_add_u32 v69, s97, v68
  ds_read2st64_b32 v[20:21], v69 offset0:0 offset1:4
  ds_read2st64_b32 v[22:23], v69 offset0:8 offset1:12
  ds_read2st64_b32 v[24:25], v69 offset0:16 offset1:20
  ds_read2st64_b32 v[26:27], v69 offset0:24 offset1:28
  v_perm_b32 v228, v29, v28, s62
  v_perm_b32 v229, v31, v30, s62
  v_perm_b32 v230, v33, v32, s62
  v_perm_b32 v231, v35, v34, s62
  v_perm_b32 v236, v29, v28, s63
  v_perm_b32 v237, v31, v30, s63
  v_perm_b32 v238, v33, v32, s63
  v_perm_b32 v239, v35, v34, s63
  s_waitcnt vmcnt(8) lgkmcnt(0)
  s_barrier
  s_cmp_lg_u32 s93, 2
  s_cbranch_scc1 L_lw_keep6_20
  s_mov_b64 s[88:89], s[32:33]
  s_mov_b64 s[90:91], s[34:35]
  s_mov_b32 s86, s23
L_lw_keep6_20:
  s_mov_b32 m0, s97
  s_add_u32 s94, s86, 7168
  buffer_load_dwordx4 v112, s[88:91], s86 offen nt lds
  buffer_load_dwordx4 v112, s[88:91], s94 offen offset:1024 nt lds
  s_add_u32 s86, s86, 0x40000
  v_add_u32 v69, s98, v68
  ds_read2st64_b32 v[28:29], v69 offset0:0 offset1:4
  ds_read2st64_b32 v[30:31], v69 offset0:8 offset1:12
  ds_read2st64_b32 v[32:33], v69 offset0:16 offset1:20
  ds_read2st64_b32 v[34:35], v69 offset0:24 offset1:28
  v_perm_b32 v240, v21, v20, s62
  v_perm_b32 v241, v23, v22, s62
  v_perm_b32 v242, v25, v24, s62
  v_perm_b32 v243, v27, v26, s62
  v_perm_b32 v248, v21, v20, s63
  v_perm_b32 v249, v23, v22, s63
  v_perm_b32 v250, v25, v24, s63
  v_perm_b32 v251, v27, v26, s63
  s_waitcnt lgkmcnt(3)
  v_perm_b32 v244, v29, v28, s62
  s_waitcnt lgkmcnt(2)
  v_perm_b32 v245, v31, v30, s62
  s_waitcnt lgkmcnt(1)
  v_perm_b32 v246, v33, v32, s62
  s_waitcnt lgkmcnt(0)
  v_perm_b32 v247, v35, v34, s62
  v_perm_b32 v252, v29, v28, s63
  v_perm_b32 v253, v31, v30, s63
  v_perm_b32 v254, v33, v32, s63
  v_perm_b32 v255, v35, v34, s63
  s_branch L_lw_next_13
L_lw_c_17:
  s_waitcnt vmcnt(8) lgkmcnt(0)
  s_barrier
  s_mov_b32 m0, s100
  s_add_u32 s94, s86, 7168
  buffer_load_dwordx4 v112, s[88:91], s86 offen nt lds
  buffer_load_dwordx4 v112, s[88:91], s94 offen offset:1024 nt lds
  s_add_u32 s86, s86, 0x40000
  v_add_u32 v69, s95, v68
  ds_read2st64_b32 v[20:21], v69 offset0:0 offset1:4
  ds_read2st64_b32 v[22:23], v69 offset0:8 offset1:12
  ds_read2st64_b32 v[24:25], v69 offset0:16 offset1:20
  ds_read2st64_b32 v[26:27], v69 offset0:24 offset1:28
  s_waitcnt vmcnt(8) lgkmcnt(0)
  s_barrier
  s_mov_b32 m0, s95
  s_add_u32 s94, s86, 7168
  buffer_load_dwordx4 v112, s[88:91], s86 offen nt lds
  buffer_load_dwordx4 v112, s[88:91], s94 offen offset:1024 nt lds
  s_add_u32 s86, s86, 0x40000
  v_add_u32 v69, s96, v68
  ds_read2st64_b32 v[28:29], v69 offset0:0 offset1:4
  ds_read2st64_b32 v[30:31], v69 offset0:8 offset1:12
  ds_read2st64_b32 v[32:33], v69 offset0:16 offset1:20
  ds_read2st64_b32 v[34:35], v69 offset0:24 offset1:28
  v_perm_b32 v104, v21, v20, s62
  v_perm_b32 v105, v23, v22, s62
  v_perm_b32 v106, v25, v24, s62
  v_perm_b32 v107, v27, v26, s62
  v_accvgpr_write_b32 a0, v104
  v_accvgpr_write_b32 a1, v105
  v_accvgpr_write_b32 a2, v106
  v_accvgpr_write_b32 a3, v107
  v_perm_b32 v108, v21, v20, s63
  v_perm_b32 v109, v23, v22, s63
  v_perm_b32 v110, v25, v24, s63
  v_perm_b32 v111, v27, v26, s63
  v_accvgpr_write_b32 a8, v108
  v_accvgpr_write_b32 a9, v109
  v_accvgpr_write_b32 a10, v110
  v_accvgpr_write_b32 a11, v111
  s_waitcnt vmcnt(8) lgkmcnt(0)
  s_barrier
  s_mov_b32 m0, s96
  s_add_u32 s94, s86, 7168
  buffer_load_dwordx4 v112, s[88:91], s86 offen nt lds
  buffer_load_dwordx4 v112, s[88:91], s94 offen offset:1024 nt lds
  s_add_u32 s86, s86, 0x40000
  v_add_u32 v69, s97, v68
  ds_read2st64_b32 v[20:21], v69 offset0:0 offset1:4
  ds_read2st64_b32 v[22:23], v69 offset0:8 offset1:12
  ds_read2st64_b32 v[24:25], v69 offset0:16 offset1:20
  ds_read2st64_b32 v[26:27], v69 offset0:24 offset1:28
  v_perm_b32 v104, v29, v28, s62
  v_perm_b32 v105, v31, v30, s62
  v_perm_b32 v106, v33, v32, s62
  v_perm_b32 v107, v35, v34, s62
  v_accvgpr_write_b32 a4, v104
  v_accvgpr_write_b32 a5, v105
  v_accvgpr_write_b32 a6, v106
  v_accvgpr_write_b32 a7, v107
  v_perm_b32 v108, v29, v28, s63
  v_perm_b32 v109, v31, v30, s63
  v_perm_b32 v110, v33, v32, s63
  v_perm_b32 v111, v35, v34, s63
  v_accvgpr_write_b32 a12, v108
  v_accvgpr_write_b32 a13, v109
  v_accvgpr_write_b32 a14, v110
  v_accvgpr_write_b32 a15, v111
  s_waitcnt vmcnt(8) lgkmcnt(0)
  s_barrier
  s_cmp_lg_u32 s93, 2
  s_cbranch_scc1 L_lw_keep6_21
  s_mov_b64 s[88:89], s[32:33]
  s_mov_b64 s[90:91], s[34:35]
  s_mov_b32 s86, s23
L_lw_keep6_21:
  s_mov_b32 m0, s97
  s_add_u32 s94, s86, 7168
  buffer_load_dwordx4 v112, s[88:91], s86 offen nt lds
  buffer_load_dwordx4 v112, s[88:91], s94 offen offset:1024 nt lds
  s_add_u32 s86, s86, 0x40000
  v_add_u32 v69, s98, v68
  ds_read2st64_b32 v[28:29], v69 offset0:0 offset1:4
  ds_read2st64_b32 v[30:31], v69 offset0:8 offset1:12
  ds_read2st64_b32 v[32:33], v69 offset0:16 offset1:20
  ds_read2st64_b32 v[34:35], v69 offset0:24 offset1:28
  v_perm_b32 v104, v21, v20, s62
  v_perm_b32 v105, v23, v22, s62
  v_perm_b32 v106, v25, v24, s62
  v_perm_b32 v107, v27, v26, s62
  v_accvgpr_write_b32 a16, v104
  v_accvgpr_write_b32 a17, v105
  v_accvgpr_write_b32 a18, v106
  v_accvgpr_write_b32 a19, v107
  v_perm_b32 v108, v21, v20, s63
  v_perm_b32 v109, v23, v22, s63
  v_perm_b32 v110, v25, v24, s63
  v_perm_b32 v111, v27, v26, s63
  v_accvgpr_write_b32 a24, v108
  v_accvgpr_write_b32 a25, v109
  v_accvgpr_write_b32 a26, v110
  v_accvgpr_write_b32 a27, v111
  s_waitcnt lgkmcnt(3)
  v_perm_b32 v104, v29, v28, s62
  s_waitcnt lgkmcnt(2)
  v_perm_b32 v105, v31, v30, s62
  s_waitcnt lgkmcnt(1)
  v_perm_b32 v106, v33, v32, s62
  s_waitcnt lgkmcnt(0)
  v_perm_b32 v107, v35, v34, s62
  v_accvgpr_write_b32 a20, v104
  v_accvgpr_write_b32 a21, v105
  v_accvgpr_write_b32 a22, v106
  v_accvgpr_write_b32 a23, v107
  v_perm_b32 v108, v29, v28, s63
  v_perm_b32 v109, v31, v30, s63
  v_perm_b32 v110, v33, v32, s63
  v_perm_b32 v111, v35, v34, s63
  v_accvgpr_write_b32 a28, v108
  v_accvgpr_write_b32 a29, v109
  v_accvgpr_write_b32 a30, v110
  v_accvgpr_write_b32 a31, v111
  s_branch L_lw_next_13
L_lw_c_18:
  s_waitcnt vmcnt(8) lgkmcnt(0)
  s_barrier
  s_mov_b32 m0, s100
  s_add_u32 s94, s86, 7168
  buffer_load_dwordx4 v112, s[88:91], s86 offen nt lds
  buffer_load_dwordx4 v112, s[88:91], s94 offen offset:1024 nt lds
  s_add_u32 s86, s86, 0x40000
  v_add_u32 v69, s95, v68
  ds_read2st64_b32 v[20:21], v69 offset0:0 offset1:4
  ds_read2st64_b32 v[22:23], v69 offset0:8 offset1:12
  ds_read2st64_b32 v[24:25], v69 offset0:16 offset1:20
  ds_read2st64_b32 v[26:27], v69 offset0:24 offset1:28
  s_waitcnt vmcnt(8) lgkmcnt(0)
  s_barrier
  s_mov_b32 m0, s95
  s_add_u32 s94, s86, 7168
  buffer_load_dwordx4 v112, s[88:91], s86 offen nt lds
  buffer_load_dwordx4 v112, s[88:91], s94 offen offset:1024 nt lds
  s_add_u32 s86, s86, 0x40000
  v_add_u32 v69, s96, v68
  ds_read2st64_b32 v[28:29], v69 offset0:0 offset1:4
  ds_read2st64_b32 v[30:31], v69 offset0:8 offset1:12
  ds_read2st64_b32 v[32:33], v69 offset0:16 offset1:20
  ds_read2st64_b32 v[34:35], v69 offset0:24 offset1:28
  v_perm_b32 v104, v21, v20, s62
  v_perm_b32 v105, v23, v22, s62
  v_perm_b32 v106, v25, v24, s62
  v_perm_b32 v107, v27, v26, s62
  v_accvgpr_write_b32 a32, v104
  v_accvgpr_write_b32 a33, v105
  v_accvgpr_write_b32 a34, v106
  v_accvgpr_write_b32 a35, v107
  v_perm_b32 v108, v21, v20, s63
  v_perm_b32 v109, v23, v22, s63
  v_perm_b32 v110, v25, v24, s63
  v_perm_b32 v111, v27, v26, s63
  v_accvgpr_write_b32 a40, v108
  v_accvgpr_write_b32 a41, v109
  v_accvgpr_write_b32 a42, v110
  v_accvgpr_write_b32 a43, v111
  s_waitcnt vmcnt(8) lgkmcnt(0)
  s_barrier
  s_mov_b32 m0, s96
  s_add_u32 s94, s86, 7168
  buffer_load_dwordx4 v112, s[88:91], s86 offen nt lds
  buffer_load_dwordx4 v112, s[88:91], s94 offen offset:1024 nt lds
  s_add_u32 s86, s86, 0x40000
  v_add_u32 v69, s97, v68
  ds_read2st64_b32 v[20:21], v69 offset0:0 offset1:4
  ds_read2st64_b32 v[22:23], v69 offset0:8 offset1:12
  ds_read2st64_b32 v[24:25], v69 offset0:16 offset1:20
  ds_read2st64_b32 v[26:27], v69 offset0:24 offset1:28
  v_perm_b32 v104, v29, v28, s62
  v_perm_b32 v105, v31, v30, s62
  v_perm_b32 v106, v33, v32, s62
  v_perm_b32 v107, v35, v34, s62
  v_accvgpr_write_b32 a36, v104
  v_accvgpr_write_b32 a37, v105
  v_accvgpr_write_b32 a38, v106
  v_accvgpr_write_b32 a39, v107
  v_perm_b32 v108, v29, v28, s63
  v_perm_b32 v109, v31, v30, s63
  v_perm_b32 v110, v33, v32, s63
  v_perm_b32 v111, v35, v34, s63
  v_accvgpr_write_b32 a44, v108
  v_accvgpr_write_b32 a45, v109
  v_accvgpr_write_b32 a46, v110
  v_accvgpr_write_b32 a47, v111
  s_waitcnt vmcnt(8) lgkmcnt(0)
  s_barrier
  s_cmp_lg_u32 s93, 2
  s_cbranch_scc1 L_lw_keep6_22
  s_mov_b64 s[88:89], s[32:33]
  s_mov_b64 s[90:91], s[34:35]
  s_mov_b32 s86, s23
L_lw_keep6_22:
  s_mov_b32 m0, s97
  s_add_u32 s94, s86, 7168
  buffer_load_dwordx4 v112, s[88:91], s86 offen nt lds
  buffer_load_dwordx4 v112, s[88:91], s94 offen offset:1024 nt lds
  s_add_u32 s86, s86, 0x40000
  v_add_u32 v69, s98, v68
  ds_read2st64_b32 v[28:29], v69 offset0:0 offset1:4
  ds_read2st64_b32 v[30:31], v69 offset0:8 offset1:12
  ds_read2st64_b32 v[32:33], v69 offset0:16 offset1:20
  ds_read2st64_b32 v[34:35], v69 offset0:24 offset1:28
  v_perm_b32 v104, v21, v20, s62
  v_perm_b32 v105, v23, v22, s62
  v_perm_b32 v106, v25, v24, s62
  v_perm_b32 v107, v27, v26, s62
  v_accvgpr_write_b32 a48, v104
  v_accvgpr_write_b32 a49, v105
  v_accvgpr_write_b32 a50, v106
  v_accvgpr_write_b32 a51, v107
  v_perm_b32 v108, v21, v20, s63
  v_perm_b32 v109, v23, v22, s63
  v_perm_b32 v110, v25, v24, s63
  v_perm_b32 v111, v27, v26, s63
  v_accvgpr_write_b32 a56, v108
  v_accvgpr_write_b32 a57, v109
  v_accvgpr_write_b32 a58, v110
  v_accvgpr_write_b32 a59, v111
  s_waitcnt lgkmcnt(3)
  v_perm_b32 v104, v29, v28, s62
  s_waitcnt lgkmcnt(2)
  v_perm_b32 v105, v31, v30, s62
  s_waitcnt lgkmcnt(1)
  v_perm_b32 v106, v33, v32, s62
  s_waitcnt lgkmcnt(0)
  v_perm_b32 v107, v35, v34, s62
  v_accvgpr_write_b32 a52, v104
  v_accvgpr_write_b32 a53, v105
  v_accvgpr_write_b32 a54, v106
  v_accvgpr_write_b32 a55, v107
  v_perm_b32 v108, v29, v28, s63
  v_perm_b32 v109, v31, v30, s63
  v_perm_b32 v110, v33, v32, s63
  v_perm_b32 v111, v35, v34, s63
  v_accvgpr_write_b32 a60, v108
  v_accvgpr_write_b32 a61, v109
  v_accvgpr_write_b32 a62, v110
  v_accvgpr_write_b32 a63, v111
L_lw_next_13:
  s_mov_b32 s101, s95
  s_mov_b32 s95, s99
  s_mov_b32 s99, s97
  s_mov_b32 s97, s101
  s_mov_b32 s101, s96
  s_mov_b32 s96, s100
  s_mov_b32 s100, s98
  s_mov_b32 s98, s101
  s_add_u32 s93, s93, 1
  s_cmp_lt_u32 s93, 4
  s_cbranch_scc1 L_lw_top_12
  s_mov_b32 s93, 0
L_lw_top_23:
  s_xor_b32 s94, s93, s14
  s_cmp_eq_u32 s94, 1
  s_cbranch_scc1 L_lw_c_27
  s_cmp_eq_u32 s94, 2
  s_cbranch_scc1 L_lw_c_28
  s_cmp_eq_u32 s94, 3
  s_cbranch_scc1 L_lw_c_29
L_lw_c_26:
  s_waitcnt vmcnt(8) lgkmcnt(0)
  s_barrier
  s_mov_b32 m0, s100
  s_add_u32 s94, s86, 7168
  buffer_load_dwordx4 v112, s[88:91], s86 offen nt lds
  buffer_load_dwordx4 v112, s[88:91], s94 offen offset:1024 nt lds
  s_add_u32 s86, s86, 0x40000
  v_add_u32 v69, s95, v68
  ds_read2st64_b32 v[20:21], v69 offset0:0 offset1:4
  ds_read2st64_b32 v[22:23], v69 offset0:8 offset1:12
  ds_read2st64_b32 v[24:25], v69 offset0:16 offset1:20
  ds_read2st64_b32 v[26:27], v69 offset0:24 offset1:28
  s_waitcnt vmcnt(8) lgkmcnt(0)
  s_barrier
  s_mov_b32 m0, s95
  s_add_u32 s94, s86, 7168
  buffer_load_dwordx4 v112, s[88:91], s86 offen nt lds
  buffer_load_dwordx4 v112, s[88:91], s94 offen offset:1024 nt lds
  s_add_u32 s86, s86, 0x40000
  v_add_u32 v69, s96, v68
  ds_read2st64_b32 v[28:29], v69 offset0:0 offset1:4
  ds_read2st64_b32 v[30:31], v69 offset0:8 offset1:12
  ds_read2st64_b32 v[32:33], v69 offset0:16 offset1:20
  ds_read2st64_b32 v[34:35], v69 offset0:24 offset1:28
  v_perm_b32 v104, v21, v20, s62
  v_perm_b32 v105, v23, v22, s62
  v_perm_b32 v106, v25, v24, s62
  v_perm_b32 v107, v27, v26, s62
  v_accvgpr_write_b32 a64, v104
  v_accvgpr_write_b32 a65, v105
  v_accvgpr_write_b32 a66, v106
  v_accvgpr_write_b32 a67, v107
  v_perm_b32 v108, v21, v20, s63
  v_perm_b32 v109, v23, v22, s63
  v_perm_b32 v110, v25, v24, s63
  v_perm_b32 v111, v27, v26, s63
  v_accvgpr_write_b32 a72, v108
  v_accvgpr_write_b32 a73, v109
  v_accvgpr_write_b32 a74, v110
  v_accvgpr_write_b32 a75, v111
  s_waitcnt vmcnt(8) lgkmcnt(0)
  s_barrier
  s_mov_b32 m0, s96
  s_add_u32 s94, s86, 7168
  buffer_load_dwordx4 v112, s[88:91], s86 offen nt lds
  buffer_load_dwordx4 v112, s[88:91], s94 offen offset:1024 nt lds
  s_add_u32 s86, s86, 0x40000
  v_add_u32 v69, s97, v68
  ds_read2st64_b32 v[20:21], v69 offset0:0 offset1:4
  ds_read2st64_b32 v[22:23], v69 offset0:8 offset1:12
  ds_read2st64_b32 v[24:25], v69 offset0:16 offset1:20
  ds_read2st64_b32 v[26:27], v69 offset0:24 offset1:28
  v_perm_b32 v104, v29, v28, s62
  v_perm_b32 v105, v31, v30, s62
  v_perm_b32 v106, v33, v32, s62
  v_perm_b32 v107, v35, v34, s62
  v_accvgpr_write_b32 a68, v104
  v_accvgpr_write_b32 a69, v105
  v_accvgpr_write_b32 a70, v106
  v_accvgpr_write_b32 a71, v107
  v_perm_b32 v108, v29, v28, s63
  v_perm_b32 v109, v31, v30, s63
  v_perm_b32 v110, v33, v32, s63
  v_perm_b32 v111, v35, v34, s63
  v_accvgpr_write_b32 a76, v108
  v_accvgpr_write_b32 a77, v109
  v_accvgpr_write_b32 a78, v110
  v_accvgpr_write_b32 a79, v111
  s_waitcnt vmcnt(8) lgkmcnt(0)
  s_barrier
  s_cmp_lg_u32 s93, 2
  s_cbranch_scc1 L_lw_keep6_30
  s_mov_b64 s[88:89], s[24:25]
  s_mov_b64 s[90:91], s[26:27]
  s_mov_b32 s86, s23
L_lw_keep6_30:
  s_mov_b32 m0, s97
  s_add_u32 s94, s86, 7168
  buffer_load_dwordx4 v112, s[88:91], s86 offen nt lds
  buffer_load_dwordx4 v112, s[88:91], s94 offen offset:1024 nt lds
  s_add_u32 s86, s86, 0x40000
  v_add_u32 v69, s98, v68
  ds_read2st64_b32 v[28:29], v69 offset0:0 offset1:4
  ds_read2st64_b32 v[30:31], v69 offset0:8 offset1:12
  ds_read2st64_b32 v[32:33], v69 offset0:16 offset1:20
  ds_read2st64_b32 v[34:35], v69 offset0:24 offset1:28
  v_perm_b32 v104, v21, v20, s62
  v_perm_b32 v105, v23, v22, s62
  v_perm_b32 v106, v25, v24, s62
  v_perm_b32 v107, v27, v26, s62
  v_accvgpr_write_b32 a80, v104
  v_accvgpr_write_b32 a81, v105
  v_accvgpr_write_b32 a82, v106
  v_accvgpr_write_b32 a83, v107
  v_perm_b32 v108, v21, v20, s63
  v_perm_b32 v109, v23, v22, s63
  v_perm_b32 v110, v25, v24, s63
  v_perm_b32 v111, v27, v26, s63
  v_accvgpr_write_b32 a88, v108
  v_accvgpr_write_b32 a89, v109
  v_accvgpr_write_b32 a90, v110
  v_accvgpr_write_b32 a91, v111
  s_waitcnt lgkmcnt(3)
  v_perm_b32 v104, v29, v28, s62
  s_waitcnt lgkmcnt(2)
  v_perm_b32 v105, v31, v30, s62
  s_waitcnt lgkmcnt(1)
  v_perm_b32 v106, v33, v32, s62
  s_waitcnt lgkmcnt(0)
  v_perm_b32 v107, v35, v34, s62
  v_accvgpr_write_b32 a84, v104
  v_accvgpr_write_b32 a85, v105
  v_accvgpr_write_b32 a86, v106
  v_accvgpr_write_b32 a87, v107
  v_perm_b32 v108, v29, v28, s63
  v_perm_b32 v109, v31, v30, s63
  v_perm_b32 v110, v33, v32, s63
  v_perm_b32 v111, v35, v34, s63
  v_accvgpr_write_b32 a92, v108
  v_accvgpr_write_b32 a93, v109
  v_accvgpr_write_b32 a94, v110
  v_accvgpr_write_b32 a95, v111
  s_branch L_lw_next_24
L_lw_c_27:
  s_waitcnt vmcnt(8) lgkmcnt(0)
  s_barrier
  s_mov_b32 m0, s100
  s_add_u32 s94, s86, 7168
  buffer_load_dwordx4 v112, s[88:91], s86 offen nt lds
  buffer_load_dwordx4 v112, s[88:91], s94 offen offset:1024 nt lds
  s_add_u32 s86, s86, 0x40000
  v_add_u32 v69, s95, v68
  ds_read2st64_b32 v[20:21], v69 offset0:0 offset1:4
  ds_read2st64_b32 v[22:23], v69 offset0:8 offset1:12
  ds_read2st64_b32 v[24:25], v69 offset0:16 offset1:20
  ds_read2st64_b32 v[26:27], v69 offset0:24 offset1:28
  s_waitcnt vmcnt(8) lgkmcnt(0)
  s_barrier
  s_mov_b32 m0, s95
  s_add_u32 s94, s86, 7168
  buffer_load_dwordx4 v112, s[88:91], s86 offen nt lds
  buffer_load_dwordx4 v112, s[88:91], s94 offen offset:1024 nt lds
  s_add_u32 s86, s86, 0x40000
  v_add_u32 v69, s96, v68
  ds_read2st64_b32 v[28:29], v69 offset0:0 offset1:4
  ds_read2st64_b32 v[30:31], v69 offset0:8 offset1:12
  ds_read2st64_b32 v[32:33], v69 offset0:16 offset1:20
  ds_read2st64_b32 v[34:35], v69 offset0:24 offset1:28
  v_perm_b32 v104, v21, v20, s62
  v_perm_b32 v105, v23, v22, s62
  v_perm_b32 v106, v25, v24, s62
  v_perm_b32 v107, v27, v26, s62
  v_accvgpr_write_b32 a96, v104
  v_accvgpr_write_b32 a97, v105
  v_accvgpr_write_b32 a98, v106
  v_accvgpr_write_b32 a99, v107
  v_perm_b32 v108, v21, v20, s63
  v_perm_b32 v109, v23, v22, s63
  v_perm_b32 v110, v25, v24, s63
  v_perm_b32 v111, v27, v26, s63
  v_accvgpr_write_b32 a104, v108
  v_accvgpr_write_b32 a105, v109
  v_accvgpr_write_b32 a106, v110
  v_accvgpr_write_b32 a107, v111
  s_waitcnt vmcnt(8) lgkmcnt(0)
  s_barrier
  s_mov_b32 m0, s96
  s_add_u32 s94, s86, 7168
  buffer_load_dwordx4 v112, s[88:91], s86 offen nt lds
  buffer_load_dwordx4 v112, s[88:91], s94 offen offset:1024 nt lds
  s_add_u32 s86, s86, 0x40000
  v_add_u32 v69, s97, v68
  ds_read2st64_b32 v[20:21], v69 offset0:0 offset1:4
  ds_read2st64_b32 v[22:23], v69 offset0:8 offset1:12
  ds_read2st64_b32 v[24:25], v69 offset0:16 offset1:20
  ds_read2st64_b32 v[26:27], v69 offset0:24 offset1:28
  v_perm_b32 v104, v29, v28, s62
  v_perm_b32 v105, v31, v30, s62
  v_perm_b32 v106, v33, v32, s62
  v_perm_b32 v107, v35, v34, s62
  v_accvgpr_write_b32 a100, v104
  v_accvgpr_write_b32 a101, v105
  v_accvgpr_write_b32 a102, v106
  v_accvgpr_write_b32 a103, v107
  v_perm_b32 v108, v29, v28, s63
  v_perm_b32 v109, v31, v30, s63
  v_perm_b32 v110, v33, v32, s63
  v_perm_b32 v111, v35, v34, s63
  v_accvgpr_write_b32 a108, v108
  v_accvgpr_write_b32 a109, v109
  v_accvgpr_write_b32 a110, v110
  v_accvgpr_write_b32 a111, v111
  s_waitcnt vmcnt(8) lgkmcnt(0)
  s_barrier
  s_cmp_lg_u32 s93, 2
  s_cbranch_scc1 L_lw_keep6_31
  s_mov_b64 s[88:89], s[24:25]
  s_mov_b64 s[90:91], s[26:27]
  s_mov_b32 s86, s23
L_lw_keep6_31:
  s_mov_b32 m0, s97
  s_add_u32 s94, s86, 7168
  buffer_load_dwordx4 v112, s[88:91], s86 offen nt lds
  buffer_load_dwordx4 v112, s[88:91], s94 offen offset:1024 nt lds
  s_add_u32 s86, s86, 0x40000
  v_add_u32 v69, s98, v68
  ds_read2st64_b32 v[28:29], v69 offset0:0 offset1:4
  ds_read2st64_b32 v[30:31], v69 offset0:8 offset1:12
  ds_read2st64_b32 v[32:33], v69 offset0:16 offset1:20
  ds_read2st64_b32 v[34:35], v69 offset0:24 offset1:28
  v_perm_b32 v104, v21, v20, s62
  v_perm_b32 v105, v23, v22, s62
  v_perm_b32 v106, v25, v24, s62
  v_perm_b32 v107, v27, v26, s62
  v_accvgpr_write_b32 a112, v104
  v_accvgpr_write_b32 a113, v105
  v_accvgpr_write_b32 a114, v106
  v_accvgpr_write_b32 a115, v107
  v_perm_b32 v108, v21, v20, s63
  v_perm_b32 v109, v23, v22, s63
  v_perm_b32 v110, v25, v24, s63
  v_perm_b32 v111, v27, v26, s63
  v_accvgpr_write_b32 a120, v108
  v_accvgpr_write_b32 a121, v109
  v_accvgpr_write_b32 a122, v110
  v_accvgpr_write_b32 a123, v111
  s_waitcnt lgkmcnt(3)
  v_perm_b32 v104, v29, v28, s62
  s_waitcnt lgkmcnt(2)
  v_perm_b32 v105, v31, v30, s62
  s_waitcnt lgkmcnt(1)
  v_perm_b32 v106, v33, v32, s62
  s_waitcnt lgkmcnt(0)
  v_perm_b32 v107, v35, v34, s62
  v_accvgpr_write_b32 a116, v104
  v_accvgpr_write_b32 a117, v105
  v_accvgpr_write_b32 a118, v106
  v_accvgpr_write_b32 a119, v107
  v_perm_b32 v108, v29, v28, s63
  v_perm_b32 v109, v31, v30, s63
  v_perm_b32 v110, v33, v32, s63
  v_perm_b32 v111, v35, v34, s63
  v_accvgpr_write_b32 a124, v108
  v_accvgpr_write_b32 a125, v109
  v_accvgpr_write_b32 a126, v110
  v_accvgpr_write_b32 a127, v111
  s_branch L_lw_next_24
L_lw_c_28:
  s_waitcnt vmcnt(8) lgkmcnt(0)
  s_barrier
  s_mov_b32 m0, s100
  s_add_u32 s94, s86, 7168
  buffer_load_dwordx4 v112, s[88:91], s86 offen nt lds
  buffer_load_dwordx4 v112, s[88:91], s94 offen offset:1024 nt lds
  s_add_u32 s86, s86, 0x40000
  v_add_u32 v69, s95, v68
  ds_read2st64_b32 v[20:21], v69 offset0:0 offset1:4
  ds_read2st64_b32 v[22:23], v69 offset0:8 offset1:12
  ds_read2st64_b32 v[24:25], v69 offset0:16 offset1:20
  ds_read2st64_b32 v[26:27], v69 offset0:24 offset1:28
  s_waitcnt vmcnt(8) lgkmcnt(0)
  s_barrier
  s_mov_b32 m0, s95
  s_add_u32 s94, s86, 7168
  buffer_load_dwordx4 v112, s[88:91], s86 offen nt lds
  buffer_load_dwordx4 v112, s[88:91], s94 offen offset:1024 nt lds
  s_add_u32 s86, s86, 0x40000
  v_add_u32 v69, s96, v68
  ds_read2st64_b32 v[28:29], v69 offset0:0 offset1:4
  ds_read2st64_b32 v[30:31], v69 offset0:8 offset1:12
  ds_read2st64_b32 v[32:33], v69 offset0:16 offset1:20
  ds_read2st64_b32 v[34:35], v69 offset0:24 offset1:28
  v_perm_b32 v104, v21, v20, s62
  v_perm_b32 v105, v23, v22, s62
  v_perm_b32 v106, v25, v24, s62
  v_perm_b32 v107, v27, v26, s62
  v_accvgpr_write_b32 a128, v104
  v_accvgpr_write_b32 a129, v105
  v_accvgpr_write_b32 a130, v106
  v_accvgpr_write_b32 a131, v107
  v_perm_b32 v108, v21, v20, s63
  v_perm_b32 v109, v23, v22, s63
  v_perm_b32 v110, v25, v24, s63
  v_perm_b32 v111, v27, v26, s63
  v_accvgpr_write_b32 a136, v108
  v_accvgpr_write_b32 a137, v109
  v_accvgpr_write_b32 a138, v110
  v_accvgpr_write_b32 a139, v111
  s_waitcnt vmcnt(8) lgkmcnt(0)
  s_barrier
  s_mov_b32 m0, s96
  s_add_u32 s94, s86, 7168
  buffer_load_dwordx4 v112, s[88:91], s86 offen nt lds
  buffer_load_dwordx4 v112, s[88:91], s94 offen offset:1024 nt lds
  s_add_u32 s86, s86, 0x40000
  v_add_u32 v69, s97, v68
  ds_read2st64_b32 v[20:21], v69 offset0:0 offset1:4
  ds_read2st64_b32 v[22:23], v69 offset0:8 offset1:12
  ds_read2st64_b32 v[24:25], v69 offset0:16 offset1:20
  ds_read2st64_b32 v[26:27], v69 offset0:24 offset1:28
  v_perm_b32 v104, v29, v28, s62
  v_perm_b32 v105, v31, v30, s62
  v_perm_b32 v106, v33, v32, s62
  v_perm_b32 v107, v35, v34, s62
  v_accvgpr_write_b32 a132, v104
  v_accvgpr_write_b32 a133, v105
  v_accvgpr_write_b32 a134, v106
  v_accvgpr_write_b32 a135, v107
  v_perm_b32 v108, v29, v28, s63
  v_perm_b32 v109, v31, v30, s63
  v_perm_b32 v110, v33, v32, s63
  v_perm_b32 v111, v35, v34, s63
  v_accvgpr_write_b32 a140, v108
  v_accvgpr_write_b32 a141, v109
  v_accvgpr_write_b32 a142, v110
  v_accvgpr_write_b32 a143, v111
  s_waitcnt vmcnt(8) lgkmcnt(0)
  s_barrier
  s_cmp_lg_u32 s93, 2
  s_cbranch_scc1 L_lw_keep6_32
  s_mov_b64 s[88:89], s[24:25]
  s_mov_b64 s[90:91], s[26:27]
  s_mov_b32 s86, s23
L_lw_keep6_32:
  s_mov_b32 m0, s97
  s_add_u32 s94, s86, 7168
  buffer_load_dwordx4 v112, s[88:91], s86 offen nt lds
  buffer_load_dwordx4 v112, s[88:91], s94 offen offset:1024 nt lds
  s_add_u32 s86, s86, 0x40000
  v_add_u32 v69, s98, v68
  ds_read2st64_b32 v[28:29], v69 offset0:0 offset1:4
  ds_read2st64_b32 v[30:31], v69 offset0:8 offset1:12
  ds_read2st64_b32 v[32:33], v69 offset0:16 offset1:20
  ds_read2st64_b32 v[34:35], v69 offset0:24 offset1:28
  v_perm_b32 v104, v21, v20, s62
  v_perm_b32 v105, v23, v22, s62
  v_perm_b32 v106, v25, v24, s62
  v_perm_b32 v107, v27, v26, s62
  v_accvgpr_write_b32 a144, v104
  v_accvgpr_write_b32 a145, v105
  v_accvgpr_write_b32 a146, v106
  v_accvgpr_write_b32 a147, v107
  v_perm_b32 v108, v21, v20, s63
  v_perm_b32 v109, v23, v22, s63
  v_perm_b32 v110, v25, v24, s63
  v_perm_b32 v111, v27, v26, s63
  v_accvgpr_write_b32 a152, v108
  v_accvgpr_write_b32 a153, v109
  v_accvgpr_write_b32 a154, v110
  v_accvgpr_write_b32 a155, v111
  s_waitcnt lgkmcnt(3)
  v_perm_b32 v104, v29, v28, s62
  s_waitcnt lgkmcnt(2)
  v_perm_b32 v105, v31, v30, s62
  s_waitcnt lgkmcnt(1)
  v_perm_b32 v106, v33, v32, s62
  s_waitcnt lgkmcnt(0)
  v_perm_b32 v107, v35, v34, s62
  v_accvgpr_write_b32 a148, v104
  v_accvgpr_write_b32 a149, v105
  v_accvgpr_write_b32 a150, v106
  v_accvgpr_write_b32 a151, v107
  v_perm_b32 v108, v29, v28, s63
  v_perm_b32 v109, v31, v30, s63
  v_perm_b32 v110, v33, v32, s63
  v_perm_b32 v111, v35, v34, s63
  v_accvgpr_write_b32 a156, v108
  v_accvgpr_write_b32 a157, v109
  v_accvgpr_write_b32 a158, v110
  v_accvgpr_write_b32 a159, v111
  s_branch L_lw_next_24
L_lw_c_29:
  s_waitcnt vmcnt(8) lgkmcnt(0)
  s_barrier
  s_mov_b32 m0, s100
  s_add_u32 s94, s86, 7168
  buffer_load_dwordx4 v112, s[88:91], s86 offen nt lds
  buffer_load_dwordx4 v112, s[88:91], s94 offen offset:1024 nt lds
  s_add_u32 s86, s86, 0x40000
  v_add_u32 v69, s95, v68
  ds_read2st64_b32 v[20:21], v69 offset0:0 offset1:4
  ds_read2st64_b32 v[22:23], v69 offset0:8 offset1:12
  ds_read2st64_b32 v[24:25], v69 offset0:16 offset1:20
  ds_read2st64_b32 v[26:27], v69 offset0:24 offset1:28
  s_waitcnt vmcnt(8) lgkmcnt(0)
  s_barrier
  s_mov_b32 m0, s95
  s_add_u32 s94, s86, 7168
  buffer_load_dwordx4 v112, s[88:91], s86 offen nt lds
  buffer_load_dwordx4 v112, s[88:91], s94 offen offset:1024 nt lds
  s_add_u32 s86, s86, 0x40000
  v_add_u32 v69, s96, v68
  ds_read2st64_b32 v[28:29], v69 offset0:0 offset1:4
  ds_read2st64_b32 v[30:31], v69 offset0:8 offset1:12
  ds_read2st64_b32 v[32:33], v69 offset0:16 offset1:20
  ds_read2st64_b32 v[34:35], v69 offset0:24 offset1:28
  v_perm_b32 v104, v21, v20, s62
  v_perm_b32 v105, v23, v22, s62
  v_perm_b32 v106, v25, v24, s62
  v_perm_b32 v107, v27, v26, s62
  v_accvgpr_write_b32 a160, v104
  v_accvgpr_write_b32 a161, v105
  v_accvgpr_write_b32 a162, v106
  v_accvgpr_write_b32 a163, v107
  v_perm_b32 v108, v21, v20, s63
  v_perm_b32 v109, v23, v22, s63
  v_perm_b32 v110, v25, v24, s63
  v_perm_b32 v111, v27, v26, s63
  v_accvgpr_write_b32 a168, v108
  v_accvgpr_write_b32 a169, v109
  v_accvgpr_write_b32 a170, v110
  v_accvgpr_write_b32 a171, v111
  s_waitcnt vmcnt(8) lgkmcnt(0)
  s_barrier
  s_mov_b32 m0, s96
  s_add_u32 s94, s86, 7168
  buffer_load_dwordx4 v112, s[88:91], s86 offen nt lds
  buffer_load_dwordx4 v112, s[88:91], s94 offen offset:1024 nt lds
  s_add_u32 s86, s86, 0x40000
  v_add_u32 v69, s97, v68
  ds_read2st64_b32 v[20:21], v69 offset0:0 offset1:4
  ds_read2st64_b32 v[22:23], v69 offset0:8 offset1:12
  ds_read2st64_b32 v[24:25], v69 offset0:16 offset1:20
  ds_read2st64_b32 v[26:27], v69 offset0:24 offset1:28
  v_perm_b32 v104, v29, v28, s62
  v_perm_b32 v105, v31, v30, s62
  v_perm_b32 v106, v33, v32, s62
  v_perm_b32 v107, v35, v34, s62
  v_accvgpr_write_b32 a164, v104
  v_accvgpr_write_b32 a165, v105
  v_accvgpr_write_b32 a166, v106
  v_accvgpr_write_b32 a167, v107
  v_perm_b32 v108, v29, v28, s63
  v_perm_b32 v109, v31, v30, s63
  v_perm_b32 v110, v33, v32, s63
  v_perm_b32 v111, v35, v34, s63
  v_accvgpr_write_b32 a172, v108
  v_accvgpr_write_b32 a173, v109
  v_accvgpr_write_b32 a174, v110
  v_accvgpr_write_b32 a175, v111
  s_waitcnt vmcnt(8) lgkmcnt(0)
  s_barrier
  s_cmp_lg_u32 s93, 2
  s_cbranch_scc1 L_lw_keep6_33
  s_mov_b64 s[88:89], s[24:25]
  s_mov_b64 s[90:91], s[26:27]
  s_mov_b32 s86, s23
L_lw_keep6_33:
  s_mov_b32 m0, s97
  s_add_u32 s94, s86, 7168
  buffer_load_dwordx4 v112, s[88:91], s86 offen nt lds
  buffer_load_dwordx4 v112, s[88:91], s94 offen offset:1024 nt lds
  s_add_u32 s86, s86, 0x40000
  v_add_u32 v69, s98, v68
  ds_read2st64_b32 v[28:29], v69 offset0:0 offset1:4
  ds_read2st64_b32 v[30:31], v69 offset0:8 offset1:12
  ds_read2st64_b32 v[32:33], v69 offset0:16 offset1:20
  ds_read2st64_b32 v[34:35], v69 offset0:24 offset1:28
  v_perm_b32 v104, v21, v20, s62
  v_perm_b32 v105, v23, v22, s62
  v_perm_b32 v106, v25, v24, s62
  v_perm_b32 v107, v27, v26, s62
  v_accvgpr_write_b32 a176, v104
  v_accvgpr_write_b32 a177, v105
  v_accvgpr_write_b32 a178, v106
  v_accvgpr_write_b32 a179, v107
  v_perm_b32 v108, v21, v20, s63
  v_perm_b32 v109, v23, v22, s63
  v_perm_b32 v110, v25, v24, s63
  v_perm_b32 v111, v27, v26, s63
  v_accvgpr_write_b32 a184, v108
  v_accvgpr_write_b32 a185, v109
  v_accvgpr_write_b32 a186, v110
  v_accvgpr_write_b32 a187, v111
  s_waitcnt lgkmcnt(3)
  v_perm_b32 v104, v29, v28, s62
  s_waitcnt lgkmcnt(2)
  v_perm_b32 v105, v31, v30, s62
  s_waitcnt lgkmcnt(1)
  v_perm_b32 v106, v33, v32, s62
  s_waitcnt lgkmcnt(0)
  v_perm_b32 v107, v35, v34, s62
  v_accvgpr_write_b32 a180, v104
  v_accvgpr_write_b32 a181, v105
  v_accvgpr_write_b32 a182, v106
  v_accvgpr_write_b32 a183, v107
  v_perm_b32 v108, v29, v28, s63
  v_perm_b32 v109, v31, v30, s63
  v_perm_b32 v110, v33, v32, s63
  v_perm_b32 v111, v35, v34, s63
  v_accvgpr_write_b32 a188, v108
  v_accvgpr_write_b32 a189, v109
  v_accvgpr_write_b32 a190, v110
  v_accvgpr_write_b32 a191, v111
L_lw_next_24:
  s_mov_b32 s101, s95
  s_mov_b32 s95, s99
  s_mov_b32 s99, s97
  s_mov_b32 s97, s101
  s_mov_b32 s101, s96
  s_mov_b32 s96, s100
  s_mov_b32 s100, s98
  s_mov_b32 s98, s101
  s_add_u32 s93, s93, 1
  s_cmp_lt_u32 s93, 4
  s_cbranch_scc1 L_lw_top_23
  s_mov_b32 s93, 0
L_lw_top_34:
  s_cmp_lg_u32 s93, 0
  s_cbranch_scc1 L_lw_nohook_42
  buffer_load_dword v92, v0, s[8:11], 0 offen sc1
  s_branch L_lw_hooked_41
L_lw_nohook_42:
  s_cmp_lg_u32 s93, 1
  s_cbranch_scc1 L_lw_nohook_43
  s_waitcnt vmcnt(0)
  v_readlane_b32 s85, v92, 8
  v_readlane_b32 s17, v92, 36
  s_add_u32 s85, s85, s17
  v_readlane_b32 s17, v92, 37
  s_add_u32 s85, s85, s17
  v_readlane_b32 s17, v92, 38
  s_add_u32 s85, s85, s17
  v_readlane_b32 s17, v92, 39
  s_add_u32 s85, s85, s17
  s_cmp_ge_u32 s85, 256
  s_cselect_b32 s85, 1, 0
  buffer_load_dword v93, v0, s[8:11], 0 offen sc1
  buffer_load_dword v132, v0, s[4:7], s55 offen sc1
  s_branch L_lw_hooked_41
L_lw_nohook_43:
  s_cmp_lg_u32 s93, 3
  s_cbranch_scc1 L_lw_nohook_44
  s_waitcnt vmcnt(1)
  v_cmp_ne_u32 vcc, 32, v93
  s_and_b32 s57, vcc_hi, 0xfe
  s_and_b32 vcc_lo, vcc_lo, 1
  s_or_b32 s57, s57, vcc_lo
  s_cselect_b32 s57, 0, 1
  s_or_b32 s57, s57, s21
  s_and_b32 s85, s85, s57
  s_waitcnt vmcnt(0)
  v_cmp_le_u32 vcc, 4, v132
  s_and_b32 s57, vcc_lo, 1
  s_and_b32 s85, s85, s57
  s_mov_b32 m0, s67
  s_nop 0
  buffer_load_dwordx4 v10, s[4:7], s53 offen sc1 lds
  buffer_load_dwordx4 v10, s[4:7], s53 offen offset:1024 sc1 lds
  buffer_load_dwordx4 v[124:127], v11, s[4:7], s54 offen sc1
  buffer_load_dwordx4 v[128:131], v11, s[4:7], s54 offen offset:2048 sc1
  s_branch L_lw_hooked_41
L_lw_nohook_44:
L_lw_hooked_41:
  s_xor_b32 s94, s93, s14
  s_cmp_eq_u32 s94, 1
  s_cbranch_scc1 L_lw_c_38
  s_cmp_eq_u32 s94, 2
  s_cbranch_scc1 L_lw_c_39
  s_cmp_eq_u32 s94, 3
  s_cbranch_scc1 L_lw_c_40
L_lw_c_37:
  s_cmp_eq_u32 s93, 3
  s_cbranch_scc1 L_lw_last_45
  s_waitcnt vmcnt(8) lgkmcnt(0)
  s_barrier
  s_mov_b32 m0, s100
  s_add_u32 s94, s86, 7168
  buffer_load_dwordx4 v112, s[88:91], s86 offen nt lds
  buffer_load_dwordx4 v112, s[88:91], s94 offen offset:1024 nt lds
  s_add_u32 s86, s86, 0x40000
  s_branch L_lw_join_46
L_lw_last_45:
  s_waitcnt vmcnt(10) lgkmcnt(0)
  s_barrier
L_lw_join_46:
  v_add_u32 v69, s95, v68
  ds_read2st64_b32 v[20:21], v69 offset0:0 offset1:4
  ds_read2st64_b32 v[22:23], v69 offset0:8 offset1:12
  ds_read2st64_b32 v[24:25], v69 offset0:16 offset1:20
  ds_read2st64_b32 v[26:27], v69 offset0:24 offset1:28
  s_cmp_eq_u32 s93, 3
  s_cbranch_scc1 L_lw_last_47
  s_waitcnt vmcnt(8) lgkmcnt(0)
  s_barrier
  s_mov_b32 m0, s95
  s_add_u32 s94, s86, 7168
  buffer_load_dwordx4 v112, s[88:91], s86 offen nt lds
  buffer_load_dwordx4 v112, s[88:91], s94 offen offset:1024 nt lds
  s_add_u32 s86, s86, 0x40000
  s_branch L_lw_join_48
L_lw_last_47:
  s_waitcnt vmcnt(8) lgkmcnt(0)
  s_barrier
L_lw_join_48:
  v_add_u32 v69, s96, v68
  ds_read2st64_b32 v[28:29], v69 offset0:0 offset1:4
  ds_read2st64_b32 v[30:31], v69 offset0:8 offset1:12
  ds_read2st64_b32 v[32:33], v69 offset0:16 offset1:20
  ds_read2st64_b32 v[34:35], v69 offset0:24 offset1:28
  v_perm_b32 v104, v21, v20, s62
  v_perm_b32 v105, v23, v22, s62
  v_perm_b32 v106, v25, v24, s62
  v_perm_b32 v107, v27, v26, s62
  ds_write_b128 v4, v[104:107] offset:0
  v_perm_b32 v108, v21, v20, s63
  v_perm_b32 v109, v23, v22, s63
  v_perm_b32 v110, v25, v24, s63
  v_perm_b32 v111, v27, v26, s63
  ds_write_b128 v4, v[108:111] offset:2048
  s_cmp_eq_u32 s93, 3
  s_cbranch_scc1 L_lw_last_49
  s_waitcnt vmcnt(8) lgkmcnt(0)
  s_barrier
  s_mov_b32 m0, s96
  s_add_u32 s94, s86, 7168
  buffer_load_dwordx4 v112, s[88:91], s86 offen nt lds
  buffer_load_dwordx4 v112, s[88:91], s94 offen offset:1024 nt lds
  s_add_u32 s86, s86, 0x40000
  s_branch L_lw_join_50
L_lw_last_49:
  s_waitcnt vmcnt(6) lgkmcnt(0)
  s_barrier
L_lw_join_50:
  v_add_u32 v69, s97, v68
  ds_read2st64_b32 v[20:21], v69 offset0:0 offset1:4
  ds_read2st64_b32 v[22:23], v69 offset0:8 offset1:12
  ds_read2st64_b32 v[24:25], v69 offset0:16 offset1:20
  ds_read2st64_b32 v[26:27], v69 offset0:24 offset1:28
  v_perm_b32 v104, v29, v28, s62
  v_perm_b32 v105, v31, v30, s62
  v_perm_b32 v106, v33, v32, s62
  v_perm_b32 v107, v35, v34, s62
  ds_write_b128 v4, v[104:107] offset:1024
  v_perm_b32 v108, v29, v28, s63
  v_perm_b32 v109, v31, v30, s63
  v_perm_b32 v110, v33, v32, s63
  v_perm_b32 v111, v35, v34, s63
  ds_write_b128 v4, v[108:111] offset:3072
  s_cmp_eq_u32 s93, 3
  s_cbranch_scc1 L_lw_last_51
  s_waitcnt vmcnt(8) lgkmcnt(0)
  s_barrier
  s_cmp_eq_u32 s93, 2
  s_cbranch_scc1 L_lw_join_52
  s_mov_b32 m0, s97
  s_add_u32 s94, s86, 7168
  buffer_load_dwordx4 v112, s[88:91], s86 offen nt lds
  buffer_load_dwordx4 v112, s[88:91], s94 offen offset:1024 nt lds
  s_add_u32 s86, s86, 0x40000
  s_branch L_lw_join_52
L_lw_last_51:
  s_waitcnt vmcnt(4) lgkmcnt(0)
  s_barrier
L_lw_join_52:
  v_add_u32 v69, s98, v68
  ds_read2st64_b32 v[28:29], v69 offset0:0 offset1:4
  ds_read2st64_b32 v[30:31], v69 offset0:8 offset1:12
  ds_read2st64_b32 v[32:33], v69 offset0:16 offset1:20
  ds_read2st64_b32 v[34:35], v69 offset0:24 offset1:28
  v_perm_b32 v104, v21, v20, s62
  v_perm_b32 v105, v23, v22, s62
  v_perm_b32 v106, v25, v24, s62
  v_perm_b32 v107, v27, v26, s62
  ds_write_b128 v4, v[104:107] offset:4096
  v_perm_b32 v108, v21, v20, s63
  v_perm_b32 v109, v23, v22, s63
  v_perm_b32 v110, v25, v24, s63
  v_perm_b32 v111, v27, v26, s63
  ds_write_b128 v4, v[108:111] offset:6144
  s_waitcnt lgkmcnt(5)
  v_perm_b32 v104, v29, v28, s62
  s_waitcnt lgkmcnt(4)
  v_perm_b32 v105, v31, v30, s62
  s_waitcnt lgkmcnt(3)
  v_perm_b32 v106, v33, v32, s62
  s_waitcnt lgkmcnt(2)
  v_perm_b32 v107, v35, v34, s62
  ds_write_b128 v4, v[104:107] offset:5120
  v_perm_b32 v108, v29, v28, s63
  v_perm_b32 v109, v31, v30, s63
  v_perm_b32 v110, v33, v32, s63
  v_perm_b32 v111, v35, v34, s63
  ds_write_b128 v4, v[108:111] offset:7168
  s_branch L_lw_next_35
L_lw_c_38:
  s_cmp_eq_u32 s93, 3
  s_cbranch_scc1 L_lw_last_53
  s_waitcnt vmcnt(8) lgkmcnt(0)
  s_barrier
  s_mov_b32 m0, s100
  s_add_u32 s94, s86, 7168
  buffer_load_dwordx4 v112, s[88:91], s86 offen nt lds
  buffer_load_dwordx4 v112, s[88:91], s94 offen offset:1024 nt lds
  s_add_u32 s86, s86, 0x40000
  s_branch L_lw_join_54
L_lw_last_53:
  s_waitcnt vmcnt(10) lgkmcnt(0)
  s_barrier
L_lw_join_54:
  v_add_u32 v69, s95, v68
  ds_read2st64_b32 v[20:21], v69 offset0:0 offset1:4
  ds_read2st64_b32 v[22:23], v69 offset0:8 offset1:12
  ds_read2st64_b32 v[24:25], v69 offset0:16 offset1:20
  ds_read2st64_b32 v[26:27], v69 offset0:24 offset1:28
  s_cmp_eq_u32 s93, 3
  s_cbranch_scc1 L_lw_last_55
  s_waitcnt vmcnt(8) lgkmcnt(0)
  s_barrier
  s_mov_b32 m0, s95
  s_add_u32 s94, s86, 7168
  buffer_load_dwordx4 v112, s[88:91], s86 offen nt lds
  buffer_load_dwordx4 v112, s[88:91], s94 offen offset:1024 nt lds
  s_add_u32 s86, s86, 0x40000
  s_branch L_lw_join_56
L_lw_last_55:
  s_waitcnt vmcnt(8) lgkmcnt(0)
  s_barrier
L_lw_join_56:
  v_add_u32 v69, s96, v68
  ds_read2st64_b32 v[28:29], v69 offset0:0 offset1:4
  ds_read2st64_b32 v[30:31], v69 offset0:8 offset1:12
  ds_read2st64_b32 v[32:33], v69 offset0:16 offset1:20
  ds_read2st64_b32 v[34:35], v69 offset0:24 offset1:28
  v_perm_b32 v104, v21, v20, s62
  v_perm_b32 v105, v23, v22, s62
  v_perm_b32 v106, v25, v24, s62
  v_perm_b32 v107, v27, v26, s62
  ds_write_b128 v4, v[104:107] offset:8192
  v_perm_b32 v108, v21, v20, s63
  v_perm_b32 v109, v23, v22, s63
  v_perm_b32 v110, v25, v24, s63
  v_perm_b32 v111, v27, v26, s63
  ds_write_b128 v4, v[108:111] offset:10240
  s_cmp_eq_u32 s93, 3
  s_cbranch_scc1 L_lw_last_57
  s_waitcnt vmcnt(8) lgkmcnt(0)
  s_barrier
  s_mov_b32 m0, s96
  s_add_u32 s94, s86, 7168
  buffer_load_dwordx4 v112, s[88:91], s86 offen nt lds
  buffer_load_dwordx4 v112, s[88:91], s94 offen offset:1024 nt lds
  s_add_u32 s86, s86, 0x40000
  s_branch L_lw_join_58
L_lw_last_57:
  s_waitcnt vmcnt(6) lgkmcnt(0)
  s_barrier
L_lw_join_58:
  v_add_u32 v69, s97, v68
  ds_read2st64_b32 v[20:21], v69 offset0:0 offset1:4
  ds_read2st64_b32 v[22:23], v69 offset0:8 offset1:12
  ds_read2st64_b32 v[24:25], v69 offset0:16 offset1:20
  ds_read2st64_b32 v[26:27], v69 offset0:24 offset1:28
  v_perm_b32 v104, v29, v28, s62
  v_perm_b32 v105, v31, v30, s62
  v_perm_b32 v106, v33, v32, s62
  v_perm_b32 v107, v35, v34, s62
  ds_write_b128 v4, v[104:107] offset:9216
  v_perm_b32 v108, v29, v28, s63
  v_perm_b32 v109, v31, v30, s63
  v_perm_b32 v110, v33, v32, s63
  v_perm_b32 v111, v35, v34, s63
  ds_write_b128 v4, v[108:111] offset:11264
  s_cmp_eq_u32 s93, 3
  s_cbranch_scc1 L_lw_last_59
  s_waitcnt vmcnt(8) lgkmcnt(0)
  s_barrier
  s_cmp_eq_u32 s93, 2
  s_cbranch_scc1 L_lw_join_60
  s_mov_b32 m0, s97
  s_add_u32 s94, s86, 7168
  buffer_load_dwordx4 v112, s[88:91], s86 offen nt lds
  buffer_load_dwordx4 v112, s[88:91], s94 offen offset:1024 nt lds
  s_add_u32 s86, s86, 0x40000
  s_branch L_lw_join_60
L_lw_last_59:
  s_waitcnt vmcnt(4) lgkmcnt(0)
  s_barrier
L_lw_join_60:
  v_add_u32 v69, s98, v68
  ds_read2st64_b32 v[28:29], v69 offset0:0 offset1:4
  ds_read2st64_b32 v[30:31], v69 offset0:8 offset1:12
  ds_read2st64_b32 v[32:33], v69 offset0:16 offset1:20
  ds_read2st64_b32 v[34:35], v69 offset0:24 offset1:28
  v_perm_b32 v104, v21, v20, s62
  v_perm_b32 v105, v23, v22, s62
  v_perm_b32 v106, v25, v24, s62
  v_perm_b32 v107, v27, v26, s62
  ds_write_b128 v4, v[104:107] offset:12288
  v_perm_b32 v136, v21, v20, s63
  v_perm_b32 v137, v23, v22, s63
  v_perm_b32 v138, v25, v24, s63
  v_perm_b32 v139, v27, v26, s63
  s_waitcnt lgkmcnt(4)
  v_perm_b32 v104, v29, v28, s62
  s_waitcnt lgkmcnt(3)
  v_perm_b32 v105, v31, v30, s62
  s_waitcnt lgkmcnt(2)
  v_perm_b32 v106, v33, v32, s62
  s_waitcnt lgkmcnt(1)
  v_perm_b32 v107, v35, v34, s62
  ds_write_b128 v4, v[104:107] offset:13312
  v_perm_b32 v140, v29, v28, s63
  v_perm_b32 v141, v31, v30, s63
  v_perm_b32 v142, v33, v32, s63
  v_perm_b32 v143, v35, v34, s63
  s_branch L_lw_next_35
L_lw_c_39:
  s_cmp_eq_u32 s93, 3
  s_cbranch_scc1 L_lw_last_61
  s_waitcnt vmcnt(8) lgkmcnt(0)
  s_barrier
  s_mov_b32 m0, s100
  s_add_u32 s94, s86, 7168
  buffer_load_dwordx4 v112, s[88:91], s86 offen nt lds
  buffer_load_dwordx4 v112, s[88:91], s94 offen offset:1024 nt lds
  s_add_u32 s86, s86, 0x40000
  s_branch L_lw_join_62
L_lw_last_61:
  s_waitcnt vmcnt(10) lgkmcnt(0)
  s_barrier
L_lw_join_62:
  v_add_u32 v69, s95, v68
  ds_read2st64_b32 v[20:21], v69 offset0:0 offset1:4
  ds_read2st64_b32 v[22:23], v69 offset0:8 offset1:12
  ds_read2st64_b32 v[24:25], v69 offset0:16 offset1:20
  ds_read2st64_b32 v[26:27], v69 offset0:24 offset1:28
  s_cmp_eq_u32 s93, 3
  s_cbranch_scc1 L_lw_last_63
  s_waitcnt vmcnt(8) lgkmcnt(0)
  s_barrier
  s_mov_b32 m0, s95
  s_add_u32 s94, s86, 7168
  buffer_load_dwordx4 v112, s[88:91], s86 offen nt lds
  buffer_load_dwordx4 v112, s[88:91], s94 offen offset:1024 nt lds
  s_add_u32 s86, s86, 0x40000
  s_branch L_lw_join_64
L_lw_last_63:
  s_waitcnt vmcnt(8) lgkmcnt(0)
  s_barrier
L_lw_join_64:
  v_add_u32 v69, s96, v68
  ds_read2st64_b32 v[28:29], v69 offset0:0 offset1:4
  ds_read2st64_b32 v[30:31], v69 offset0:8 offset1:12
  ds_read2st64_b32 v[32:33], v69 offset0:16 offset1:20
  ds_read2st64_b32 v[34:35], v69 offset0:24 offset1:28
  v_perm_b32 v144, v21, v20, s62
  v_perm_b32 v145, v23, v22, s62
  v_perm_b32 v146, v25, v24, s62
  v_perm_b32 v147, v27, v26, s62
  v_perm_b32 v152, v21, v20, s63
  v_perm_b32 v153, v23, v22, s63
  v_perm_b32 v154, v25, v24, s63
  v_perm_b32 v155, v27, v26, s63
  s_cmp_eq_u32 s93, 3
  s_cbranch_scc1 L_lw_last_65
  s_waitcnt vmcnt(8) lgkmcnt(0)
  s_barrier
  s_mov_b32 m0, s96
  s_add_u32 s94, s86, 7168
  buffer_load_dwordx4 v112, s[88:91], s86 offen nt lds
  buffer_load_dwordx4 v112, s[88:91], s94 offen offset:1024 nt lds
  s_add_u32 s86, s86, 0x40000
  s_branch L_lw_join_66
L_lw_last_65:
  s_waitcnt vmcnt(6) lgkmcnt(0)
  s_barrier
L_lw_join_66:
  v_add_u32 v69, s97, v68
  ds_read2st64_b32 v[20:21], v69 offset0:0 offset1:4
  ds_read2st64_b32 v[22:23], v69 offset0:8 offset1:12
  ds_read2st64_b32 v[24:25], v69 offset0:16 offset1:20
  ds_read2st64_b32 v[26:27], v69 offset0:24 offset1:28
  v_perm_b32 v148, v29, v28, s62
  v_perm_b32 v149, v31, v30, s62
  v_perm_b32 v150, v33, v32, s62
  v_perm_b32 v151, v35, v34, s62
  v_perm_b32 v156, v29, v28, s63
  v_perm_b32 v157, v31, v30, s63
  v_perm_b32 v158, v33, v32, s63
  v_perm_b32 v159, v35, v34, s63
  s_cmp_eq_u32 s93, 3
  s_cbranch_scc1 L_lw_last_67
  s_waitcnt vmcnt(8) lgkmcnt(0)
  s_barrier
  s_cmp_eq_u32 s93, 2
  s_cbranch_scc1 L_lw_join_68
  s_mov_b32 m0, s97
  s_add_u32 s94, s86, 7168
  buffer_load_dwordx4 v112, s[88:91], s86 offen nt lds
  buffer_load_dwordx4 v112, s[88:91], s94 offen offset:1024 nt lds
  s_add_u32 s86, s86, 0x40000
  s_branch L_lw_join_68
L_lw_last_67:
  s_waitcnt vmcnt(4) lgkmcnt(0)
  s_barrier
L_lw_join_68:
  v_add_u32 v69, s98, v68
  ds_read2st64_b32 v[28:29], v69 offset0:0 offset1:4
  ds_read2st64_b32 v[30:31], v69 offset0:8 offset1:12
  ds_read2st64_b32 v[32:33], v69 offset0:16 offset1:20
  ds_read2st64_b32 v[34:35], v69 offset0:24 offset1:28
  v_perm_b32 v160, v21, v20, s62
  v_perm_b32 v161, v23, v22, s62
  v_perm_b32 v162, v25, v24, s62
  v_perm_b32 v163, v27, v26, s62
  v_perm_b32 v168, v21, v20, s63
  v_perm_b32 v169, v23, v22, s63
  v_perm_b32 v170, v25, v24, s63
  v_perm_b32 v171, v27, v26, s63
  s_waitcnt lgkmcnt(3)
  v_perm_b32 v164, v29, v28, s62
  s_waitcnt lgkmcnt(2)
  v_perm_b32 v165, v31, v30, s62
  s_waitcnt lgkmcnt(1)
  v_perm_b32 v166, v33, v32, s62
  s_waitcnt lgkmcnt(0)
  v_perm_b32 v167, v35, v34, s62
  v_perm_b32 v172, v29, v28, s63
  v_perm_b32 v173, v31, v30, s63
  v_perm_b32 v174, v33, v32, s63
  v_perm_b32 v175, v35, v34, s63
  s_branch L_lw_next_35
L_lw_c_40:
  s_cmp_eq_u32 s93, 3
  s_cbranch_scc1 L_lw_last_69
  s_waitcnt vmcnt(8) lgkmcnt(0)
  s_barrier
  s_mov_b32 m0, s100
  s_add_u32 s94, s86, 7168
  buffer_load_dwordx4 v112, s[88:91], s86 offen nt lds
  buffer_load_dwordx4 v112, s[88:91], s94 offen offset:1024 nt lds
  s_add_u32 s86, s86, 0x40000
  s_branch L_lw_join_70
L_lw_last_69:
  s_waitcnt vmcnt(10) lgkmcnt(0)
  s_barrier
L_lw_join_70:
  v_add_u32 v69, s95, v68
  ds_read2st64_b32 v[20:21], v69 offset0:0 offset1:4
  ds_read2st64_b32 v[22:23], v69 offset0:8 offset1:12
  ds_read2st64_b32 v[24:25], v69 offset0:16 offset1:20
  ds_read2st64_b32 v[26:27], v69 offset0:24 offset1:28
  s_cmp_eq_u32 s93, 3
  s_cbranch_scc1 L_lw_last_71
  s_waitcnt vmcnt(8) lgkmcnt(0)
  s_barrier
  s_mov_b32 m0, s95
  s_add_u32 s94, s86, 7168
  buffer_load_dwordx4 v112, s[88:91], s86 offen nt lds
  buffer_load_dwordx4 v112, s[88:91], s94 offen offset:1024 nt lds
  s_add_u32 s86, s86, 0x40000
  s_branch L_lw_join_72
L_lw_last_71:
  s_waitcnt vmcnt(8) lgkmcnt(0)
  s_barrier
L_lw_join_72:
  v_add_u32 v69, s96, v68
  ds_read2st64_b32 v[28:29], v69 offset0:0 offset1:4
  ds_read2st64_b32 v[30:31], v69 offset0:8 offset1:12
  ds_read2st64_b32 v[32:33], v69 offset0:16 offset1:20
  ds_read2st64_b32 v[34:35], v69 offset0:24 offset1:28
  v_perm_b32 v176, v21, v20, s62
  v_perm_b32 v177, v23, v22, s62
  v_perm_b32 v178, v25, v24, s62
  v_perm_b32 v179, v27, v26, s62
  v_perm_b32 v184, v21, v20, s63
  v_perm_b32 v185, v23, v22, s63
  v_perm_b32 v186, v25, v24, s63
  v_perm_b32 v187, v27, v26, s63
  s_cmp_eq_u32 s93, 3
  s_cbranch_scc1 L_lw_last_73
  s_waitcnt vmcnt(8) lgkmcnt(0)
  s_barrier
  s_mov_b32 m0, s96
  s_add_u32 s94, s86, 7168
  buffer_load_dwordx4 v112, s[88:91], s86 offen nt lds
  buffer_load_dwordx4 v112, s[88:91], s94 offen offset:1024 nt lds
  s_add_u32 s86, s86, 0x40000
  s_branch L_lw_join_74
L_lw_last_73:
  s_waitcnt vmcnt(6) lgkmcnt(0)
  s_barrier
L_lw_join_74:
  v_add_u32 v69, s97, v68
  ds_read2st64_b32 v[20:21], v69 offset0:0 offset1:4
  ds_read2st64_b32 v[22:23], v69 offset0:8 offset1:12
  ds_read2st64_b32 v[24:25], v69 offset0:16 offset1:20
  ds_read2st64_b32 v[26:27], v69 offset0:24 offset1:28
  v_perm_b32 v180, v29, v28, s62
  v_perm_b32 v181, v31, v30, s62
  v_perm_b32 v182, v33, v32, s62
  v_perm_b32 v183, v35, v34, s62
  v_perm_b32 v188, v29, v28, s63
  v_perm_b32 v189, v31, v30, s63
  v_perm_b32 v190, v33, v32, s63
  v_perm_b32 v191, v35, v34, s63
  s_cmp_eq_u32 s93, 3
  s_cbranch_scc1 L_lw_last_75
  s_waitcnt vmcnt(8) lgkmcnt(0)
  s_barrier
  s_cmp_eq_u32 s93, 2
  s_cbranch_scc1 L_lw_join_76
  s_mov_b32 m0, s97
  s_add_u32 s94, s86, 7168
  buffer_load_dwordx4 v112, s[88:91], s86 offen nt lds
  buffer_load_dwordx4 v112, s[88:91], s94 offen offset:1024 nt lds
  s_add_u32 s86, s86, 0x40000
  s_branch L_lw_join_76
L_lw_last_75:
  s_waitcnt vmcnt(4) lgkmcnt(0)
  s_barrier
L_lw_join_76:
  v_add_u32 v69, s98, v68
  ds_read2st64_b32 v[28:29], v69 offset0:0 offset1:4
  ds_read2st64_b32 v[30:31], v69 offset0:8 offset1:12
  ds_read2st64_b32 v[32:33], v69 offset0:16 offset1:20
  ds_read2st64_b32 v[34:35], v69 offset0:24 offset1:28
  v_perm_b32 v104, v21, v20, s62
  v_perm_b32 v105, v23, v22, s62
  v_perm_b32 v106, v25, v24, s62
  v_perm_b32 v107, v27, v26, s62
  ds_write_b128 v4, v[104:107] offset:14336
  v_perm_b32 v108, v21, v20, s63
  v_perm_b32 v109, v23, v22, s63
  v_perm_b32 v110, v25, v24, s63
  v_perm_b32 v111, v27, v26, s63
  ds_write_b128 v4, v[108:111] offset:16384
  s_waitcnt lgkmcnt(5)
  v_perm_b32 v104, v29, v28, s62
  s_waitcnt lgkmcnt(4)
  v_perm_b32 v105, v31, v30, s62
  s_waitcnt lgkmcnt(3)
  v_perm_b32 v106, v33, v32, s62
  s_waitcnt lgkmcnt(2)
  v_perm_b32 v107, v35, v34, s62
  ds_write_b128 v4, v[104:107] offset:15360
  v_perm_b32 v108, v29, v28, s63
  v_perm_b32 v109, v31, v30, s63
  v_perm_b32 v110, v33, v32, s63
  v_perm_b32 v111, v35, v34, s63
  ds_write_b128 v4, v[108:111] offset:17408
L_lw_next_35:
  s_mov_b32 s101, s95
  s_mov_b32 s95, s99
  s_mov_b32 s99, s97
  s_mov_b32 s97, s101
  s_mov_b32 s101, s96
  s_mov_b32 s96, s100
  s_mov_b32 s100, s98
  s_mov_b32 s98, s101
  s_add_u32 s93, s93, 1
  s_cmp_lt_u32 s93, 4
  s_cbranch_scc1 L_lw_top_34
  s_waitcnt lgkmcnt(0)
  s_barrier
  ds_write_b128 v4, v[36:39] offset:26624
  ds_write_b128 v4, v[40:43] offset:27648
  ds_write_b128 v4, v[44:47] offset:28672
  ds_write_b128 v4, v[48:51] offset:29696
  ds_write_b128 v4, v[52:55] offset:30720
  ds_write_b128 v4, v[56:59] offset:31744
  ds_write_b128 v4, v[60:63] offset:32768
  ds_write_b128 v4, v[64:67] offset:33792
  v_mov_b32 v76, v96
  v_mov_b32 v77, v97
  v_mov_b32 v78, v98
  v_mov_b32 v79, v99
  v_mov_b32 v80, v100
  v_mov_b32 v81, v101
  v_mov_b32 v82, v102
  v_mov_b32 v83, v103
  s_waitcnt vmcnt(0)
  s_cmp_lg_u32 s85, 0
  s_cbranch_scc1 L_pre_ok_77
  s_cmp_lg_u32 s21, 0
  s_cbranch_scc1 L_mode_ok_78
  s_mov_b32 s15, 200000
  v_mov_b32 v135, v0
L_rdy_top_79:
  buffer_load_dword v134, v135, s[8:11], 0 offen sc1
  s_waitcnt vmcnt(0)
  v_readlane_b32 s16, v134, 8
  v_readlane_b32 s17, v134, 36
  s_add_u32 s16, s16, s17
  v_readlane_b32 s17, v134, 37
  s_add_u32 s16, s16, s17
  v_readlane_b32 s17, v134, 38
  s_add_u32 s16, s16, s17
  v_readlane_b32 s17, v134, 39
  s_add_u32 s16, s16, s17
  s_cmp_ge_u32 s16, 256
  s_cbranch_scc1 L_rdy_out_80
  s_sub_u32 s15, s15, 1
  s_cmp_lg_u32 s15, 0
  s_cbranch_scc1 L_rdy_top_79
L_rdy_out_80:
  buffer_load_dword v134, v135, s[8:11], 0 offen sc1
  s_waitcnt vmcnt(0)
  v_cmp_ne_u32 vcc, 32, v134
  s_and_b32 s15, vcc_hi, 0xfe
  s_and_b32 vcc_lo, vcc_lo, 1
  s_or_b32 s15, s15, vcc_lo
  s_cmp_lg_u32 s15, 0
  s_cbranch_scc1 L_fallback
L_mode_ok_78:
L_pre_ok_77:
  s_lshl_b32 s57, s44, 8
  s_add_u32 s57, s57, 0x4002004
  v_mov_b32 v134, 1
  buffer_store_dword v134, off, s[4:7], s57 sc1
  s_cmp_lg_u32 s21, 0
  s_cbranch_scc1 L_chain_agent
  s_cmp_lg_u32 s85, 0
  s_cbranch_scc1 L_cb_ok_81
  s_mov_b32 s45, -1
  buffer_load_dword v132, v0, s[4:7], s55 offen sc1
  s_add_u32 s80, s45, 1
L_kvf_top_82:
  s_waitcnt vmcnt(0)
  v_cmp_le_u32 vcc, 4, v132
  s_bitcmp1_b64 vcc, s80
  s_cbranch_scc1 L_kvf_out_83
  buffer_load_dword v132, v0, s[4:7], s55 offen sc1
  s_waitcnt vmcnt(0)
  s_cmp_eq_u32 s48, 0
  s_cbranch_scc1 L_kvf_out_83
  s_sub_u32 s48, s48, 1
  s_branch L_kvf_top_82
L_kvf_out_83:
  s_mov_b32 s45, 0
  s_waitcnt vmcnt(0)
  s_mov_b32 m0, s67
  s_nop 0
  buffer_load_dwordx4 v10, s[4:7], s53 offen sc1 lds
  buffer_load_dwordx4 v10, s[4:7], s53 offen offset:1024 sc1 lds
  buffer_load_dwordx4 v[124:127], v11, s[4:7], s54 offen sc1
  buffer_load_dwordx4 v[128:131], v11, s[4:7], s54 offen offset:2048 sc1
  s_waitcnt vmcnt(0)
L_cb_ok_81:
  s_add_u32 s53, s53, 0x40000
  s_waitcnt lgkmcnt(0)
  ds_read_b128 v[124:127], v4 offset:0
  ds_read_b128 v[128:131], v4 offset:1024
  ds_read_b128 v[84:87], v4 offset:2048
  ds_read_b128 v[88:91], v4 offset:3072
  ds_read_b128 v[92:95], v4 offset:4096
  ds_read_b128 v[96:99], v4 offset:5120
  ds_read_b128 v[100:103], v4 offset:6144
  ds_read_b128 v[104:107], v4 offset:7168
  ds_read_b128 v[108:111], v4 offset:8192
  ds_read_b128 v[112:115], v4 offset:9216
  ds_read_b128 v[116:119], v4 offset:10240
  ds_read_b128 v[120:123], v4 offset:11264
  ds_read_b128 v[68:71], v4 offset:12288
  ds_read_b128 v[72:75], v4 offset:13312
  v_mov_b64 v[52:53], 0
  v_mov_b64 v[54:55], 0
  v_mov_b64 v[56:57], 0
  v_mov_b64 v[58:59], 0
  v_mov_b64 v[60:61], 0
  v_mov_b64 v[62:63], 0
  v_mov_b64 v[64:65], 0
  v_mov_b64 v[66:67], 0
  s_waitcnt lgkmcnt(0)
  s_add_u32 s80, s45, 1
L_kvf_top_84:
  v_cmp_le_u32 vcc, 4, v132
  s_bitcmp1_b64 vcc, s80
  s_cbranch_scc1 L_kvf_out_85
  buffer_load_dword v132, v0, s[4:7], s55 offen sc1
  s_waitcnt vmcnt(0)
  s_cmp_eq_u32 s48, 0
  s_cbranch_scc1 L_kvf_out_85
  s_sub_u32 s48, s48, 1
  s_branch L_kvf_top_84
L_kvf_out_85:
L_role_86:
  s_branch L_step_in_89
L_step_88:
  s_add_u32 s80, s45, 1
L_kvf_top_90:
  v_cmp_le_u32 vcc, 4, v132
  s_bitcmp1_b64 vcc, s80
  s_cbranch_scc1 L_kvf_out_91
  buffer_load_dword v132, v0, s[4:7], s55 offen sc1
  s_waitcnt vmcnt(0)
  s_cmp_eq_u32 s48, 0
  s_cbranch_scc1 L_kvf_out_91
  s_sub_u32 s48, s48, 1
  s_branch L_kvf_top_90
L_kvf_out_91:
  s_cmp_gt_u32 s77, 0
  s_cbranch_scc1 L_pm_now_93
  s_waitcnt vmcnt(0)
L_pm_now_93:
  buffer_load_dwordx4 v[76:79], v2, s[4:7], s49 offen sc1
  buffer_load_dwordx4 v[80:83], v2, s[4:7], s49 offen offset:1024 sc1
  ds_read_b128 v[124:127], v4 offset:0
  ds_read_b128 v[128:131], v4 offset:1024
  ds_read_b128 v[84:87], v4 offset:2048
  ds_read_b128 v[88:91], v4 offset:3072
  ds_read_b128 v[92:95], v4 offset:4096
  ds_read_b128 v[96:99], v4 offset:5120
  ds_read_b128 v[100:103], v4 offset:6144
  ds_read_b128 v[104:107], v4 offset:7168
  ds_read_b128 v[108:111], v4 offset:8192
  ds_read_b128 v[112:115], v4 offset:9216
  ds_read_b128 v[116:119], v4 offset:10240
  ds_read_b128 v[120:123], v4 offset:11264
  ds_read_b128 v[68:71], v4 offset:12288
  ds_read_b128 v[72:75], v4 offset:13312
  s_nop 3
L_pmf_top_94:
  buffer_load_dwordx4 v[76:79], v2, s[4:7], s49 offen sc1
  buffer_load_dwordx4 v[80:83], v2, s[4:7], s49 offen offset:1024 sc1
  s_sub_u32 s48, s48, 1
  s_cbranch_scc1 L_pmf_expired_96
L_pmf_wait_97:
  s_waitcnt vmcnt(2)
  v_max3_u32 v133, v76, v77, v78
  v_max3_u32 v134, v79, v80, v81
  v_max3_u32 v133, v133, v82, v83
  v_max_u32 v133, v133, v134
  v_cmp_eq_u32 vcc, -1, v133
  s_cbranch_vccnz L_pmf_top_94
L_pmf_out_95:
L_pm_done_92:
L_step_in_89:
  ds_write_b128 v2, v[76:79] offset:0
  ds_write_b128 v2, v[80:83] offset:1024
  s_waitcnt lgkmcnt(14)
  v_smfmac_f32_16x16x64_bf16 v[52:55], v[76:79], v[124:131], v1
  s_waitcnt lgkmcnt(12)
  v_smfmac_f32_16x16x64_bf16 v[56:59], v[76:79], v[84:91], v1
  buffer_load_dwordx4 v[124:127], v11, s[4:7], s54 offen sc1
  s_waitcnt lgkmcnt(10)
  v_smfmac_f32_16x16x64_bf16 v[52:55], v[80:83], v[92:99], v1
  buffer_load_dwordx4 v[128:131], v11, s[4:7], s54 offen offset:2048 sc1
  s_waitcnt lgkmcnt(8)
  v_smfmac_f32_16x16x64_bf16 v[56:59], v[80:83], v[100:107], v1
  s_waitcnt lgkmcnt(0)
  s_barrier
  ds_read_b128 v[28:31], v3 offset:0
  v_smfmac_f32_16x16x64_bf16 v[60:63], v[76:79], v[192:199], v1
  ds_read_b128 v[32:35], v3 offset:1024
  v_smfmac_f32_16x16x64_bf16 v[64:67], v[76:79], v[200:207], v1
  ds_read_b128 v[36:39], v12 offset:0
  s_mov_b32 m0, 24064
  v_smfmac_f32_16x16x64_bf16 v[60:63], v[80:83], v[208:215], v1
  ds_read_b128 v[40:43], v12 offset:1024
  buffer_load_dword v17, s[4:7], s50 offen lds
  v_smfmac_f32_16x16x64_bf16 v[64:67], v[80:83], v[216:223], v1
  ds_read_b128 v[44:47], v7 offset:0
  s_waitcnt lgkmcnt(4)
  v_smfmac_f32_16x16x64_bf16 v[52:55], v[28:31], v[108:115], v1
  ds_read_b128 v[48:51], v7 offset:1024
  v_smfmac_f32_16x16x64_bf16 v[56:59], v[28:31], v[116:123], v1
  s_waitcnt lgkmcnt(4)
  v_smfmac_f32_16x16x64_bf16 v[52:55], v[32:35], v[68:75], v1
  buffer_load_dword v132, v0, s[4:7], s55 offen sc1
  v_smfmac_f32_16x16x64_bf16 v[56:59], v[32:35], v[136:143], v1
  ds_read_b128 v[20:23], v18
  s_waitcnt lgkmcnt(4)
  v_smfmac_f32_16x16x64_bf16 v[52:55], v[36:39], v[144:151], v1
  ds_read_b128 v[84:87], v4 offset:14336
  v_mov_b32 v134, s78
  s_mov_b64 exec, s[72:73]
  buffer_store_dword v134, off, s[4:7], s56 sc1
  s_mov_b64 exec, -1
  v_smfmac_f32_16x16x64_bf16 v[56:59], v[36:39], v[152:159], v1
  ds_read_b128 v[88:91], v4 offset:15360
  s_waitcnt lgkmcnt(5)
  v_smfmac_f32_16x16x64_bf16 v[52:55], v[40:43], v[160:167], v1
  ds_read_b128 v[92:95], v4 offset:16384
  buffer_load_dword v133, v14, s[4:7], s53 offen
  v_smfmac_f32_16x16x64_bf16 v[56:59], v[40:43], v[168:175], v1
  ds_read_b128 v[96:99], v4 offset:17408
  s_waitcnt lgkmcnt(6)
  v_smfmac_f32_16x16x64_bf16 v[52:55], v[44:47], v[176:183], v1
  s_waitcnt lgkmcnt(4)
  v_min_u32 v20, -2, v20
  v_min_u32 v21, -2, v21
  v_smfmac_f32_16x16x64_bf16 v[56:59], v[44:47], v[184:191], v1
  v_mov_b64 v[68:69], 0
  v_min_u32 v22, -2, v22
  v_min_u32 v23, -2, v23
  s_waitcnt lgkmcnt(2)
  v_smfmac_f32_16x16x64_bf16 v[52:55], v[48:51], v[84:91], v1
  buffer_store_dwordx4 v[20:23], v19, s[4:7], s79 offen sc1
  v_mov_b64 v[70:71], 0
  s_waitcnt lgkmcnt(0)
  v_smfmac_f32_16x16x64_bf16 v[56:59], v[48:51], v[92:99], v1
  ds_read_b128 v[84:87], v8 offset:0
  v_mov_b64 v[72:73], 0
  v_smfmac_f32_16x16x64_bf16 v[60:63], v[28:31], v[224:231], v1
  ds_read_b128 v[88:91], v8 offset:2048
  v_mov_b64 v[74:75], 0
  v_smfmac_f32_16x16x64_bf16 v[64:67], v[28:31], v[232:239], v1
  ds_read_b128 v[92:95], v8 offset:4096
  v_add_f32 v52, v52, v54
  v_smfmac_f32_16x16x64_bf16 v[60:63], v[32:35], v[240:247], v1
  ds_read_b128 v[96:99], v8 offset:6144
  v_add_f32 v56, v56, v58
  v_smfmac_f32_16x16x64_bf16 v[64:67], v[32:35], v[248:255], v1
  ds_read_b128 v[100:103], v9 offset:0
  v_mul_f32 v52, s64, v52
  v_smfmac_f32_16x16x64_bf16 v[60:63], v[36:39], a[0:7], v1
  ds_read_b128 v[104:107], v9 offset:2048
  v_add_f32 v53, v53, v55
  v_smfmac_f32_16x16x64_bf16 v[64:67], v[36:39], a[8:15], v1
  ds_read_b128 v[108:111], v9 offset:4096
  v_add_f32 v57, v57, v59
  v_smfmac_f32_16x16x64_bf16 v[60:63], v[40:43], a[16:23], v1
  ds_read_b128 v[112:115], v9 offset:6144
  v_mul_f32 v56, s64, v56
  v_smfmac_f32_16x16x64_bf16 v[64:67], v[40:43], a[24:31], v1
  v_mul_f32 v53, s64, v53
  v_smfmac_f32_16x16x64_bf16 v[60:63], v[44:47], a[32:39], v1
  v_mul_f32 v57, s64, v57
  v_smfmac_f32_16x16x64_bf16 v[64:67], v[44:47], a[40:47], v1
  v_cvt_pk_bf16_f32 v54, v52, v56
  v_smfmac_f32_16x16x64_bf16 v[60:63], v[48:51], a[48:55], v1
  v_cvt_pk_bf16_f32 v55, v53, v57
  v_smfmac_f32_16x16x64_bf16 v[64:67], v[48:51], a[56:63], v1
  ds_write2_b32 v5, v54, v55 offset0:0 offset1:80
  v_smfmac_f32_16x16x64_bf16 v[68:71], v[76:79], a[64:71], v1
  v_add_f32 v60, v60, v62
  v_smfmac_f32_16x16x64_bf16 v[68:71], v[80:83], a[80:87], v1
  v_add_f32 v64, v64, v66
  v_add_f32 v61, v61, v63
  v_add_f32 v65, v65, v67
  v_smfmac_f32_16x16x64_bf16 v[68:71], v[28:31], a[96:103], v1
  v_cvt_pk_bf16_f32 v134, v60, v64
  v_cvt_pk_bf16_f32 v135, v61, v65
  v_smfmac_f32_16x16x64_bf16 v[68:71], v[32:35], a[112:119], v1
  ds_write_b32 v5, v134 offset:2560
  ds_write_b32 v5, v135 offset:2880
  v_smfmac_f32_16x16x64_bf16 v[68:71], v[36:39], a[128:135], v1
  v_smfmac_f32_16x16x64_bf16 v[68:71], v[40:43], a[144:151], v1
  v_smfmac_f32_16x16x64_bf16 v[68:71], v[44:47], a[160:167], v1
  v_smfmac_f32_16x16x64_bf16 v[68:71], v[48:51], a[176:183], v1
  s_waitcnt lgkmcnt(0)
  s_barrier
  v_smfmac_f32_16x16x64_bf16 v[72:75], v[76:79], a[72:79], v1
  ds_read_b128 v[20:23], v6 offset:0
  v_smfmac_f32_16x16x64_bf16 v[72:75], v[80:83], a[88:95], v1
  ds_read_b128 v[24:27], v6 offset:64
  v_smfmac_f32_16x16x64_bf16 v[72:75], v[28:31], a[104:111], v1
  ds_read_b128 v[28:31], v6 offset:128
  v_add_f32 v68, v68, v70
  v_smfmac_f32_16x16x64_bf16 v[72:75], v[32:35], a[120:127], v1
  ds_read_b128 v[32:35], v6 offset:192
  v_add_f32 v69, v69, v71
  v_smfmac_f32_16x16x64_bf16 v[72:75], v[36:39], a[136:143], v1
  ds_read_b128 v[116:119], v6 offset:2560
  v_cvt_pk_bf16_f32 v68, v68, v69
  v_smfmac_f32_16x16x64_bf16 v[72:75], v[40:43], a[152:159], v1
  ds_read_b128 v[120:123], v6 offset:2624
  v_mov_b32 v69, 0
  v_smfmac_f32_16x16x64_bf16 v[72:75], v[44:47], a[168:175], v1
  ds_read_b128 v[60:63], v6 offset:2688
  v_smfmac_f32_16x16x64_bf16 v[72:75], v[48:51], a[184:191], v1
  ds_read_b128 v[64:67], v6 offset:2752
  s_waitcnt lgkmcnt(7)
  v_mfma_f32_16x16x32_bf16 v[52:55], v[84:87], v[20:23], 0
  s_waitcnt vmcnt(7)
  v_mov_b32 v81, 0
  s_waitcnt lgkmcnt(6)
  v_mfma_f32_16x16x32_bf16 v[52:55], v[88:91], v[24:27], v[52:55]
  ds_read_b128 v[36:39], v4 offset:18432
  s_waitcnt lgkmcnt(6)
  v_mfma_f32_16x16x32_bf16 v[52:55], v[92:95], v[28:31], v[52:55]
  v_add_f32 v72, v72, v74
  v_add_f32 v73, v73, v75
  s_waitcnt lgkmcnt(5)
  v_mfma_f32_16x16x32_bf16 v[52:55], v[96:99], v[32:35], v[52:55]
  ds_read_b128 v[40:43], v4 offset:19456
  v_cvt_pk_bf16_f32 v72, v72, v73
  v_mov_b32 v73, 0
  v_mfma_f32_16x16x32_bf16 v[56:59], v[100:103], v[20:23], 0
  v_mov_b64 v[92:93], s[60:61]
  v_mov_b64 v[94:95], s[60:61]
  v_mfma_f32_16x16x32_bf16 v[56:59], v[104:107], v[24:27], v[56:59]
  ds_read_b128 v[44:47], v4 offset:22528
  v_exp_f32 v84, v52
  v_mfma_f32_16x16x32_bf16 v[56:59], v[108:111], v[28:31], v[56:59]
  v_exp_f32 v85, v53
  v_mfma_f32_16x16x32_bf16 v[56:59], v[112:115], v[32:35], v[56:59]
  ds_read_b128 v[48:51], v4 offset:23552
  v_exp_f32 v86, v54
  s_waitcnt lgkmcnt(7)
  v_mfma_f32_16x16x32_bf16 v[76:79], v[116:119], v[20:23], 0
  v_exp_f32 v87, v55
  s_waitcnt lgkmcnt(6)
  v_mfma_f32_16x16x32_bf16 v[76:79], v[120:123], v[24:27], v[76:79]
  v_cvt_pk_bf16_f32 v100, v84, v85
  v_cvt_pk_bf16_f32 v101, v86, v87
  s_waitcnt lgkmcnt(5)
  v_mfma_f32_16x16x32_bf16 v[76:79], v[60:63], v[28:31], v[76:79]
  v_exp_f32 v88, v56
  s_waitcnt lgkmcnt(4)
  v_mfma_f32_16x16x32_bf16 v[76:79], v[64:67], v[32:35], v[76:79]
  v_exp_f32 v89, v57
  v_exp_f32 v90, v58
  v_exp_f32 v91, v59
  v_cvt_pk_bf16_f32 v102, v88, v89
  v_cvt_pk_bf16_f32 v103, v90, v91
  s_nop 1
  v_mfma_f32_16x16x32_bf16 v[108:111], v[100:103], v[92:95], 0
  v_exp_f32 v104, v76
  s_waitcnt vmcnt(6)
  v_mfma_f32_16x16x32_bf16 v[84:87], v[100:103], v[124:127], 0
  ds_read_b128 v[20:23], v4 offset:26624
  v_exp_f32 v105, v77
  s_waitcnt vmcnt(5)
  v_mfma_f32_16x16x32_bf16 v[88:91], v[100:103], v[128:131], 0
  ds_read_b128 v[24:27], v4 offset:27648
  v_cvt_pk_bf16_f32 v80, v104, v105
  s_nop 1
  v_mfma_f32_16x16x16_bf16 v[108:111], v[80:81], v[92:93], v[108:111]
  ds_read_b128 v[28:31], v4 offset:30720
  v_mov_b64 v[60:61], 0
  v_mov_b64 v[62:63], 0
  v_mfma_f32_16x16x16_bf16 v[84:87], v[80:81], v[68:69], v[84:87]
  ds_read_b128 v[32:35], v4 offset:31744
  v_mov_b64 v[64:65], 0
  v_mov_b64 v[66:67], 0
  v_mfma_f32_16x16x16_bf16 v[88:91], v[80:81], v[72:73], v[88:91]
  v_rcp_f32 v134, v108
  v_rcp_f32 v135, v109
  v_max3_f32 v96, |v52|, |v53|, |v54|
  v_max3_f32 v96, v96, |v55|, |v56|
  v_max3_f32 v96, v96, |v57|, |v58|
  v_max3_f32 v96, v96, |v59|, |v76|
  v_max_f32_e64 v96, v96, |v77|
  v_cmp_nge_f32 vcc, 0x42200000, v96
  v_mul_f32 v84, v84, v134
  v_mul_f32 v85, v85, v135
  v_mul_f32 v88, v88, v134
  v_mul_f32 v89, v89, v135
  v_cvt_pk_bf16_f32 v134, v84, v88
  v_cvt_pk_bf16_f32 v135, v85, v89
  s_cbranch_vccnz L_sm_max_98
L_sm_done_99:
  ds_write2_b32 v13, v134, v135 offset0:0 offset1:80
  s_mov_b32 m0, s67
  s_nop 0
  buffer_load_dwordx4 v10, s[4:7], s53 offen sc1 lds
  buffer_load_dwordx4 v10, s[4:7], s53 offen offset:1024 sc1 lds
  v_mov_b64 v[52:53], 0
  v_mov_b64 v[54:55], 0
  v_mov_b64 v[56:57], 0
  v_mov_b64 v[58:59], 0
  s_waitcnt lgkmcnt(0)
  s_barrier
  ds_read_b128 v[116:119], v6 offset:5120
  ds_read_b128 v[120:123], v6 offset:5184
  ds_read_b128 v[124:127], v6 offset:5248
  ds_read_b128 v[128:131], v6 offset:5312
  s_waitcnt lgkmcnt(3)
  v_smfmac_f32_16x16x64_bf16 v[52:55], v[116:119], a[192:199], v1
  ds_read_b128 v[84:87], v4 offset:20480
  s_waitcnt lgkmcnt(3)
  v_smfmac_f32_16x16x64_bf16 v[52:55], v[120:123], a[200:207], v1
  ds_read_b128 v[88:91], v4 offset:21504
  s_waitcnt lgkmcnt(3)
  v_smfmac_f32_16x16x64_bf16 v[52:55], v[124:127], a[208:215], v1
  ds_read_b128 v[92:95], v4 offset:24576
  s_waitcnt lgkmcnt(3)
  v_smfmac_f32_16x16x64_bf16 v[52:55], v[128:131], a[216:223], v1
  ds_read_b128 v[96:99], v4 offset:25600
  v_smfmac_f32_16x16x64_bf16 v[56:59], v[116:119], a[224:231], v1
  ds_read_b128 v[100:103], v4 offset:28672
  v_smfmac_f32_16x16x64_bf16 v[56:59], v[120:123], a[232:239], v1
  ds_read_b128 v[104:107], v4 offset:29696
  v_cvt_pk_bf16_f32 v52, v52, v54
  v_cvt_pk_bf16_f32 v53, v53, v55
  v_smfmac_f32_16x16x64_bf16 v[56:59], v[124:127], a[240:247], v1
  ds_read_b128 v[108:111], v4 offset:32768
  v_and_or_b32 v53, v53, -2, s47
  v_smfmac_f32_16x16x64_bf16 v[56:59], v[128:131], a[248:255], v1
  buffer_store_dwordx2 v[52:53], v15, s[4:7], s68 offen
  ds_read_b128 v[112:115], v4 offset:33792
  v_smfmac_f32_16x16x64_bf16 v[60:63], v[116:119], v[36:43], v1
  v_smfmac_f32_16x16x64_bf16 v[60:63], v[120:123], v[44:51], v1
  v_cvt_pk_bf16_f32 v56, v56, v58
  v_cvt_pk_bf16_f32 v57, v57, v59
  v_smfmac_f32_16x16x64_bf16 v[60:63], v[124:127], v[20:27], v1
  v_and_or_b32 v57, v57, -2, s47
  v_smfmac_f32_16x16x64_bf16 v[60:63], v[128:131], v[28:35], v1
  buffer_store_dwordx2 v[56:57], v15, s[4:7], s69 offen
  s_waitcnt lgkmcnt(6)
  v_smfmac_f32_16x16x64_bf16 v[64:67], v[116:119], v[84:91], v1
  s_waitcnt lgkmcnt(4)
  v_smfmac_f32_16x16x64_bf16 v[64:67], v[120:123], v[92:99], v1
  ds_write2st64_b32 v16, v68, v72 offset0:0 offset1:5
  v_cvt_pk_bf16_f32 v60, v60, v62
  v_cvt_pk_bf16_f32 v61, v61, v63
  s_waitcnt lgkmcnt(3)
  v_smfmac_f32_16x16x64_bf16 v[64:67], v[124:127], v[100:107], v1
  v_and_or_b32 v61, v61, -2, s47
  s_waitcnt lgkmcnt(1)
  v_smfmac_f32_16x16x64_bf16 v[64:67], v[128:131], v[108:115], v1
  buffer_store_dwordx2 v[60:61], v15, s[4:7], s70 offen
  v_not_b32 v21, s46
  v_not_b32 v23, s46
  v_not_b32 v25, s46
  v_not_b32 v27, s46
  v_mov_b64 v[52:53], 0
  s_nop 1
  v_cvt_pk_bf16_f32 v64, v64, v66
  v_cvt_pk_bf16_f32 v65, v65, v67
  v_and_or_b32 v65, v65, -2, s47
  buffer_store_dwordx2 v[64:65], v15, s[4:7], s71 offen
  ds_read_b128 v[36:39], v6 offset:256
  v_mov_b64 v[54:55], 0
  v_mov_b64 v[56:57], 0
  v_mov_b64 v[58:59], 0
  v_mov_b64 v[60:61], 0
  v_mov_b64 v[62:63], 0
  v_mov_b64 v[64:65], 0
  v_mov_b64 v[66:67], 0
  v_mov_b32 v76, -1
  v_mov_b32 v77, -1
  v_mov_b32 v78, -1
  v_mov_b32 v79, -1
  v_mov_b32 v80, -1
  v_mov_b32 v81, -1
  v_mov_b32 v82, -1
  v_mov_b32 v83, -1
  s_waitcnt vmcnt(4)
  s_cmp_eq_u32 s77, 0
  s_cbranch_scc1 L_pi_go_100
  s_waitcnt vmcnt(3)
  s_cmp_eq_u32 s77, 1
  s_cbranch_scc1 L_pi_go_100
  s_waitcnt vmcnt(2)
  s_cmp_eq_u32 s77, 2
  s_cbranch_scc1 L_pi_go_100
  s_waitcnt vmcnt(1)
L_pi_go_100:
L_pi_top_101:
  buffer_load_dwordx4 v[20:23], v2, s[4:7], s76 offen sc1
  buffer_load_dwordx4 v[24:27], v2, s[4:7], s76 offen offset:1024 sc1
  s_sub_u32 s48, s48, 1
  s_cbranch_scc1 L_pi_expired_103
L_pi_wait_104:
  s_waitcnt vmcnt(2) lgkmcnt(0)
  v_bitop3_b32 v134, v21, v23, s46 bitop3:0x7e
  v_bitop3_b32 v135, v25, v27, s46 bitop3:0x7e
  v_mfma_f32_16x16x32_bf16 v[40:43], v[36:39], v[20:23], 0
  v_bitop3_b32 v134, v134, v135, 1 bitop3:0xa8
  v_mfma_f32_16x16x32_bf16 v[40:43], v[36:39], v[24:27], v[40:43]
  v_cmp_ne_u32 vcc, 0, v134
  s_cbranch_vccnz L_pi_top_101
L_pi_out_102:
  s_nop 5
  v_add_f32_dpp v40, v40, v40 row_ror:8 row_mask:0xf bank_mask:0xf
  v_add_f32_dpp v41, v41, v41 row_ror:8 row_mask:0xf bank_mask:0xf
  s_nop 0
  v_add_f32_dpp v40, v40, v40 row_ror:4 row_mask:0xf bank_mask:0xf
  v_add_f32_dpp v41, v41, v41 row_ror:4 row_mask:0xf bank_mask:0xf
  v_cvt_pk_bf16_f32 v40, v40, v41
  v_min_u32 v40, -2, v40
  buffer_store_dword v40, v17, s[4:7], s50 offen
  s_mov_b32 s78, s45
  s_mov_b32 s79, s51
  s_add_u32 s45, s45, 1
  s_add_u32 s49, s49, 8192
  s_add_u32 s50, s50, 8192
  s_add_u32 s51, s51, 65536
  s_add_u32 s53, s53, 0x40000
  s_add_u32 s54, s54, 0x40000
  s_xor_b32 s47, s47, 1
  s_not_b32 s46, s46
  s_cmp_lt_u32 s45, 63
  s_cbranch_scc1 L_step_88
  s_cmp_gt_u32 s77, 0
  s_cbranch_scc1 L_pm_now_106
  s_waitcnt vmcnt(0)
L_pm_now_106:
  buffer_load_dwordx4 v[76:79], v2, s[4:7], s49 offen sc1
  buffer_load_dwordx4 v[80:83], v2, s[4:7], s49 offen offset:1024 sc1
  v_mov_b64 v[68:69], 0
  v_mov_b64 v[70:71], 0
  v_mov_b64 v[72:73], 0
  v_mov_b64 v[74:75], 0
  s_nop 3
L_pmf_top_107:
  buffer_load_dwordx4 v[76:79], v2, s[4:7], s49 offen sc1
  buffer_load_dwordx4 v[80:83], v2, s[4:7], s49 offen offset:1024 sc1
  s_sub_u32 s48, s48, 1
  s_cbranch_scc1 L_pmf_expired_109
L_pmf_wait_110:
  s_waitcnt vmcnt(2)
  v_max3_u32 v133, v76, v77, v78
  v_max3_u32 v134, v79, v80, v81
  v_max3_u32 v133, v133, v82, v83
  v_max_u32 v133, v133, v134
  v_cmp_eq_u32 vcc, -1, v133
  s_cbranch_vccnz L_pmf_top_107
L_pmf_out_108:
L_pm_done_105:
  ds_write_b128 v2, v[76:79] offset:0
  ds_write_b128 v2, v[80:83] offset:1024
  ds_read_b128 v[20:23], v18
  v_smfmac_f32_16x16x64_bf16 v[60:63], v[76:79], v[192:199], v1
  v_smfmac_f32_16x16x64_bf16 v[64:67], v[76:79], v[200:207], v1
  s_waitcnt lgkmcnt(0)
  v_min_u32 v20, -2, v20
  v_min_u32 v21, -2, v21
  v_smfmac_f32_16x16x64_bf16 v[60:63], v[80:83], v[208:215], v1
  v_min_u32 v22, -2, v22
  v_min_u32 v23, -2, v23
  buffer_store_dwordx4 v[20:23], v19, s[4:7], s79 offen sc1
  v_smfmac_f32_16x16x64_bf16 v[64:67], v[80:83], v[216:223], v1
  s_waitcnt lgkmcnt(0)
  s_barrier
  ds_read_b128 v[28:31], v3 offset:0
  s_waitcnt lgkmcnt(0)
  v_smfmac_f32_16x16x64_bf16 v[60:63], v[28:31], v[224:231], v1
  ds_read_b128 v[32:35], v3 offset:1024
  v_mov_b32 v134, s78
  s_mov_b64 exec, s[72:73]
  buffer_store_dword v134, off, s[4:7], s56 sc1
  s_mov_b64 exec, -1
  v_smfmac_f32_16x16x64_bf16 v[64:67], v[28:31], v[232:239], v1
  ds_read_b128 v[36:39], v12 offset:0
  s_waitcnt lgkmcnt(1)
  v_smfmac_f32_16x16x64_bf16 v[60:63], v[32:35], v[240:247], v1
  ds_read_b128 v[40:43], v12 offset:1024
  v_smfmac_f32_16x16x64_bf16 v[64:67], v[32:35], v[248:255], v1
  ds_read_b128 v[44:47], v7 offset:0
  s_waitcnt lgkmcnt(2)
  v_smfmac_f32_16x16x64_bf16 v[60:63], v[36:39], a[0:7], v1
  ds_read_b128 v[48:51], v7 offset:1024
  v_smfmac_f32_16x16x64_bf16 v[64:67], v[36:39], a[8:15], v1
  s_waitcnt lgkmcnt(2)
  v_smfmac_f32_16x16x64_bf16 v[60:63], v[40:43], a[16:23], v1
  v_smfmac_f32_16x16x64_bf16 v[64:67], v[40:43], a[24:31], v1
  s_waitcnt lgkmcnt(1)
  v_smfmac_f32_16x16x64_bf16 v[60:63], v[44:47], a[32:39], v1
  v_smfmac_f32_16x16x64_bf16 v[64:67], v[44:47], a[40:47], v1
  s_waitcnt lgkmcnt(0)
  v_smfmac_f32_16x16x64_bf16 v[60:63], v[48:51], a[48:55], v1
  v_smfmac_f32_16x16x64_bf16 v[64:67], v[48:51], a[56:63], v1
  v_smfmac_f32_16x16x64_bf16 v[68:71], v[76:79], a[64:71], v1
  v_add_f32 v60, v60, v62
  v_smfmac_f32_16x16x64_bf16 v[72:75], v[76:79], a[72:79], v1
  v_add_f32 v64, v64, v66
  v_add_f32 v61, v61, v63
  v_add_f32 v65, v65, v67
  v_smfmac_f32_16x16x64_bf16 v[68:71], v[80:83], a[80:87], v1
  v_cvt_pk_bf16_f32 v134, v60, v64
  v_cvt_pk_bf16_f32 v135, v61, v65
  v_smfmac_f32_16x16x64_bf16 v[72:75], v[80:83], a[88:95], v1
  ds_write_b32 v5, v134 offset:2560
  ds_write_b32 v5, v135 offset:2880
  v_smfmac_f32_16x16x64_bf16 v[68:71], v[28:31], a[96:103], v1
  v_smfmac_f32_16x16x64_bf16 v[72:75], v[28:31], a[104:111], v1
  v_smfmac_f32_16x16x64_bf16 v[68:71], v[32:35], a[112:119], v1
  v_smfmac_f32_16x16x64_bf16 v[72:75], v[32:35], a[120:127], v1
  v_smfmac_f32_16x16x64_bf16 v[68:71], v[36:39], a[128:135], v1
  v_smfmac_f32_16x16x64_bf16 v[72:75], v[36:39], a[136:143], v1
  v_smfmac_f32_16x16x64_bf16 v[68:71], v[40:43], a[144:151], v1
  v_smfmac_f32_16x16x64_bf16 v[72:75], v[40:43], a[152:159], v1
  v_smfmac_f32_16x16x64_bf16 v[68:71], v[44:47], a[160:167], v1
  v_smfmac_f32_16x16x64_bf16 v[72:75], v[44:47], a[168:175], v1
  v_smfmac_f32_16x16x64_bf16 v[68:71], v[48:51], a[176:183], v1
  v_smfmac_f32_16x16x64_bf16 v[72:75], v[48:51], a[184:191], v1
  s_nop 3
  v_add_f32 v68, v68, v70
  s_nop 2
  v_add_f32 v72, v72, v74
  v_add_f32 v69, v69, v71
  v_add_f32 v73, v73, v75
  v_cvt_pk_bf16_f32 v68, v68, v69
  v_cvt_pk_bf16_f32 v72, v72, v73
  ds_write2st64_b32 v16, v68, v72 offset0:0 offset1:5
  ds_read_b128 v[20:23], v18
  s_waitcnt lgkmcnt(0)
  v_min_u32 v20, -2, v20
  v_min_u32 v21, -2, v21
  v_min_u32 v22, -2, v22
  v_min_u32 v23, -2, v23
  buffer_store_dwordx4 v[20:23], v19, s[4:7], s51 offen sc1
  s_branch L_roles_done_87
L_pmf_expired_96:
  s_mov_b32 s48, 0
  s_waitcnt vmcnt(0)
  s_branch L_pmf_out_95
L_sm_max_98:
  v_max3_f32 v134, v52, v53, v54
  v_max3_f32 v134, v134, v55, v56
  v_max3_f32 v134, v134, v57, v58
  v_max3_f32 v134, v134, v59, v76
  v_max_f32 v134, v134, v77
  s_waitcnt vmcnt(1)
  v_mov_b32 v133, v134
  s_nop 1
  v_permlane32_swap_b32 v134, v133
  v_max_f32 v134, v134, v133
  v_mov_b32 v133, v134
  s_nop 1
  v_permlane16_swap_b32 v134, v133
  v_max_f32 v134, v134, v133
  v_sub_f32 v84, v52, v134
  v_sub_f32 v85, v53, v134
  v_sub_f32 v86, v54, v134
  v_sub_f32 v87, v55, v134
  v_sub_f32 v88, v56, v134
  v_sub_f32 v89, v57, v134
  v_sub_f32 v90, v58, v134
  v_sub_f32 v91, v59, v134
  v_sub_f32 v104, v76, v134
  v_sub_f32 v105, v77, v134
  v_exp_f32 v84, v84
  v_exp_f32 v85, v85
  v_exp_f32 v86, v86
  v_exp_f32 v87, v87
  v_exp_f32 v88, v88
  v_exp_f32 v89, v89
  v_exp_f32 v90, v90
  v_exp_f32 v91, v91
  v_exp_f32 v104, v104
  v_exp_f32 v105, v105
  v_cvt_pk_bf16_f32 v100, v84, v85
  v_cvt_pk_bf16_f32 v101, v86, v87
  v_cvt_pk_bf16_f32 v102, v88, v89
  v_cvt_pk_bf16_f32 v103, v90, v91
  v_cvt_pk_bf16_f32 v80, v104, v105
  s_nop 0
  v_mfma_f32_16x16x32_bf16 v[108:111], v[100:103], v[92:95], 0
  v_mfma_f32_16x16x32_bf16 v[84:87], v[100:103], v[124:127], 0
  v_mfma_f32_16x16x32_bf16 v[88:91], v[100:103], v[128:131], 0
  v_mfma_f32_16x16x16_bf16 v[108:111], v[80:81], v[92:93], v[108:111]
  v_mfma_f32_16x16x16_bf16 v[84:87], v[80:81], v[68:69], v[84:87]
  v_mfma_f32_16x16x16_bf16 v[88:91], v[80:81], v[72:73], v[88:91]
  v_rcp_f32 v134, v108
  v_rcp_f32 v135, v109
  s_nop 1
  v_mul_f32 v84, v84, v134
  v_mul_f32 v85, v85, v135
  s_nop 1
  v_mul_f32 v88, v88, v134
  v_mul_f32 v89, v89, v135
  v_cvt_pk_bf16_f32 v134, v84, v88
  v_cvt_pk_bf16_f32 v135, v85, v89
  s_branch L_sm_done_99
L_pi_expired_103:
  s_mov_b32 s48, 0
  s_waitcnt vmcnt(0) lgkmcnt(0)
  s_branch L_pi_out_102
L_pmf_expired_109:
  s_mov_b32 s48, 0
  s_waitcnt vmcnt(0)
  s_branch L_pmf_out_108
L_roles_done_87:
  s_waitcnt vmcnt(0)
  s_barrier
  s_cmp_lg_u32 s14, 0
  s_cbranch_scc1 L_fin_111
  v_mov_b32 v134, 64
  v_mov_b32 v135, 0
  buffer_store_dword v134, v135, s[4:7], s56 offen sc1
L_fin_111:
  s_cmp_lg_u32 s14, 0
  s_cbranch_scc1 L_wb_skip_112
  s_cmp_lg_u32 s44, 0
  s_cbranch_scc1 L_wb_skip_112
  buffer_wbl2 sc1
  s_waitcnt vmcnt(0)
L_wb_skip_112:
  s_branch L_end
L_chain_agent:
  s_cmp_lg_u32 s85, 0
  s_cbranch_scc1 L_cb_ok_113
  s_mov_b32 s45, -1
  buffer_load_dword v132, v0, s[4:7], s55 offen sc1
  s_add_u32 s80, s45, 1
L_kvf_top_114:
  s_waitcnt vmcnt(0)
  v_cmp_le_u32 vcc, 4, v132
  s_bitcmp1_b64 vcc, s80
  s_cbranch_scc1 L_kvf_out_115
  buffer_load_dword v132, v0, s[4:7], s55 offen sc1
  s_waitcnt vmcnt(0)
  s_cmp_eq_u32 s48, 0
  s_cbranch_scc1 L_kvf_out_115
  s_sub_u32 s48, s48, 1
  s_branch L_kvf_top_114
L_kvf_out_115:
  s_mov_b32 s45, 0
  s_waitcnt vmcnt(0)
  s_mov_b32 m0, s67
  s_nop 0
  buffer_load_dwordx4 v10, s[4:7], s53 offen sc1 lds
  buffer_load_dwordx4 v10, s[4:7], s53 offen offset:1024 sc1 lds
  buffer_load_dwordx4 v[124:127], v11, s[4:7], s54 offen sc1
  buffer_load_dwordx4 v[128:131], v11, s[4:7], s54 offen offset:2048 sc1
  s_waitcnt vmcnt(0)
L_cb_ok_113:
  s_add_u32 s53, s53, 0x40000
  s_waitcnt lgkmcnt(0)
  ds_read_b128 v[124:127], v4 offset:0
  ds_read_b128 v[128:131], v4 offset:1024
  ds_read_b128 v[84:87], v4 offset:2048
  ds_read_b128 v[88:91], v4 offset:3072
  ds_read_b128 v[92:95], v4 offset:4096
  ds_read_b128 v[96:99], v4 offset:5120
  ds_read_b128 v[100:103], v4 offset:6144
  ds_read_b128 v[104:107], v4 offset:7168
  ds_read_b128 v[108:111], v4 offset:8192
  ds_read_b128 v[112:115], v4 offset:9216
  ds_read_b128 v[116:119], v4 offset:10240
  ds_read_b128 v[120:123], v4 offset:11264
  ds_read_b128 v[68:71], v4 offset:12288
  ds_read_b128 v[72:75], v4 offset:13312
  v_mov_b64 v[52:53], 0
  v_mov_b64 v[54:55], 0
  v_mov_b64 v[56:57], 0
  v_mov_b64 v[58:59], 0
  v_mov_b64 v[60:61], 0
  v_mov_b64 v[62:63], 0
  v_mov_b64 v[64:65], 0
  v_mov_b64 v[66:67], 0
  s_waitcnt lgkmcnt(0)
  s_add_u32 s80, s45, 1
L_kvf_top_116:
  v_cmp_le_u32 vcc, 4, v132
  s_bitcmp1_b64 vcc, s80
  s_cbranch_scc1 L_kvf_out_117
  buffer_load_dword v132, v0, s[4:7], s55 offen sc1
  s_waitcnt vmcnt(0)
  s_cmp_eq_u32 s48, 0
  s_cbranch_scc1 L_kvf_out_117
  s_sub_u32 s48, s48, 1
  s_branch L_kvf_top_116
L_kvf_out_117:
L_role_118:
  s_branch L_step_in_121
L_step_120:
  s_add_u32 s80, s45, 1
L_kvf_top_122:
  v_cmp_le_u32 vcc, 4, v132
  s_bitcmp1_b64 vcc, s80
  s_cbranch_scc1 L_kvf_out_123
  buffer_load_dword v132, v0, s[4:7], s55 offen sc1
  s_waitcnt vmcnt(0)
  s_cmp_eq_u32 s48, 0
  s_cbranch_scc1 L_kvf_out_123
  s_sub_u32 s48, s48, 1
  s_branch L_kvf_top_122
L_kvf_out_123:
  s_cmp_gt_u32 s77, 0
  s_cbranch_scc1 L_pm_now_125
  s_waitcnt vmcnt(0)
L_pm_now_125:
  buffer_load_dwordx4 v[76:79], v2, s[4:7], s49 offen sc1
  buffer_load_dwordx4 v[80:83], v2, s[4:7], s49 offen offset:1024 sc1
  ds_read_b128 v[124:127], v4 offset:0
  ds_read_b128 v[128:131], v4 offset:1024
  ds_read_b128 v[84:87], v4 offset:2048
  ds_read_b128 v[88:91], v4 offset:3072
  ds_read_b128 v[92:95], v4 offset:4096
  ds_read_b128 v[96:99], v4 offset:5120
  ds_read_b128 v[100:103], v4 offset:6144
  ds_read_b128 v[104:107], v4 offset:7168
  ds_read_b128 v[108:111], v4 offset:8192
  ds_read_b128 v[112:115], v4 offset:9216
  ds_read_b128 v[116:119], v4 offset:10240
  ds_read_b128 v[120:123], v4 offset:11264
  ds_read_b128 v[68:71], v4 offset:12288
  ds_read_b128 v[72:75], v4 offset:13312
  s_nop 3
L_pmf_top_126:
  buffer_load_dwordx4 v[76:79], v2, s[4:7], s49 offen sc1
  buffer_load_dwordx4 v[80:83], v2, s[4:7], s49 offen offset:1024 sc1
  s_sub_u32 s48, s48, 1
  s_cbranch_scc1 L_pmf_expired_128
L_pmf_wait_129:
  s_waitcnt vmcnt(2)
  v_max3_u32 v133, v76, v77, v78
  v_max3_u32 v134, v79, v80, v81
  v_max3_u32 v133, v133, v82, v83
  v_max_u32 v133, v133, v134
  v_cmp_eq_u32 vcc, -1, v133
  s_cbranch_vccnz L_pmf_top_126
L_pmf_out_127:
L_pm_done_124:
L_step_in_121:
  ds_write_b128 v2, v[76:79] offset:0
  ds_write_b128 v2, v[80:83] offset:1024
  s_waitcnt lgkmcnt(14)
  v_smfmac_f32_16x16x64_bf16 v[52:55], v[76:79], v[124:131], v1
  s_waitcnt lgkmcnt(12)
  v_smfmac_f32_16x16x64_bf16 v[56:59], v[76:79], v[84:91], v1
  buffer_load_dwordx4 v[124:127], v11, s[4:7], s54 offen sc1
  s_waitcnt lgkmcnt(10)
  v_smfmac_f32_16x16x64_bf16 v[52:55], v[80:83], v[92:99], v1
  buffer_load_dwordx4 v[128:131], v11, s[4:7], s54 offen offset:2048 sc1
  s_waitcnt lgkmcnt(8)
  v_smfmac_f32_16x16x64_bf16 v[56:59], v[80:83], v[100:107], v1
  s_waitcnt lgkmcnt(0)
  s_barrier
  ds_read_b128 v[28:31], v3 offset:0
  v_smfmac_f32_16x16x64_bf16 v[60:63], v[76:79], v[192:199], v1
  ds_read_b128 v[32:35], v3 offset:1024
  v_smfmac_f32_16x16x64_bf16 v[64:67], v[76:79], v[200:207], v1
  ds_read_b128 v[36:39], v12 offset:0
  s_mov_b32 m0, 24064
  v_smfmac_f32_16x16x64_bf16 v[60:63], v[80:83], v[208:215], v1
  ds_read_b128 v[40:43], v12 offset:1024
  buffer_load_dword v17, s[4:7], s50 offen lds
  v_smfmac_f32_16x16x64_bf16 v[64:67], v[80:83], v[216:223], v1
  ds_read_b128 v[44:47], v7 offset:0
  s_waitcnt lgkmcnt(4)
  v_smfmac_f32_16x16x64_bf16 v[52:55], v[28:31], v[108:115], v1
  ds_read_b128 v[48:51], v7 offset:1024
  v_smfmac_f32_16x16x64_bf16 v[56:59], v[28:31], v[116:123], v1
  s_waitcnt lgkmcnt(4)
  v_smfmac_f32_16x16x64_bf16 v[52:55], v[32:35], v[68:75], v1
  buffer_load_dword v132, v0, s[4:7], s55 offen sc1
  v_smfmac_f32_16x16x64_bf16 v[56:59], v[32:35], v[136:143], v1
  ds_read_b128 v[20:23], v18
  s_waitcnt lgkmcnt(4)
  v_smfmac_f32_16x16x64_bf16 v[52:55], v[36:39], v[144:151], v1
  ds_read_b128 v[84:87], v4 offset:14336
  v_mov_b32 v134, s78
  s_mov_b64 exec, s[72:73]
  buffer_store_dword v134, off, s[4:7], s56 sc1
  s_mov_b64 exec, -1
  v_smfmac_f32_16x16x64_bf16 v[56:59], v[36:39], v[152:159], v1
  ds_read_b128 v[88:91], v4 offset:15360
  s_waitcnt lgkmcnt(5)
  v_smfmac_f32_16x16x64_bf16 v[52:55], v[40:43], v[160:167], v1
  ds_read_b128 v[92:95], v4 offset:16384
  buffer_load_dword v133, v14, s[4:7], s53 offen
  v_smfmac_f32_16x16x64_bf16 v[56:59], v[40:43], v[168:175], v1
  ds_read_b128 v[96:99], v4 offset:17408
  s_waitcnt lgkmcnt(6)
  v_smfmac_f32_16x16x64_bf16 v[52:55], v[44:47], v[176:183], v1
  s_waitcnt lgkmcnt(4)
  v_min_u32 v20, -2, v20
  v_min_u32 v21, -2, v21
  v_smfmac_f32_16x16x64_bf16 v[56:59], v[44:47], v[184:191], v1
  v_mov_b64 v[68:69], 0
  v_min_u32 v22, -2, v22
  v_min_u32 v23, -2, v23
  s_waitcnt lgkmcnt(2)
  v_smfmac_f32_16x16x64_bf16 v[52:55], v[48:51], v[84:91], v1
  buffer_store_dwordx4 v[20:23], v19, s[4:7], s79 offen sc1
  v_mov_b64 v[70:71], 0
  s_waitcnt lgkmcnt(0)
  v_smfmac_f32_16x16x64_bf16 v[56:59], v[48:51], v[92:99], v1
  ds_read_b128 v[84:87], v8 offset:0
  v_mov_b64 v[72:73], 0
  v_smfmac_f32_16x16x64_bf16 v[60:63], v[28:31], v[224:231], v1
  ds_read_b128 v[88:91], v8 offset:2048
  v_mov_b64 v[74:75], 0
  v_smfmac_f32_16x16x64_bf16 v[64:67], v[28:31], v[232:239], v1
  ds_read_b128 v[92:95], v8 offset:4096
  v_add_f32 v52, v52, v54
  v_smfmac_f32_16x16x64_bf16 v[60:63], v[32:35], v[240:247], v1
  ds_read_b128 v[96:99], v8 offset:6144
  v_add_f32 v56, v56, v58
  v_smfmac_f32_16x16x64_bf16 v[64:67], v[32:35], v[248:255], v1
  ds_read_b128 v[100:103], v9 offset:0
  v_mul_f32 v52, s64, v52
  v_smfmac_f32_16x16x64_bf16 v[60:63], v[36:39], a[0:7], v1
  ds_read_b128 v[104:107], v9 offset:2048
  v_add_f32 v53, v53, v55
  v_smfmac_f32_16x16x64_bf16 v[64:67], v[36:39], a[8:15], v1
  ds_read_b128 v[108:111], v9 offset:4096
  v_add_f32 v57, v57, v59
  v_smfmac_f32_16x16x64_bf16 v[60:63], v[40:43], a[16:23], v1
  ds_read_b128 v[112:115], v9 offset:6144
  v_mul_f32 v56, s64, v56
  v_smfmac_f32_16x16x64_bf16 v[64:67], v[40:43], a[24:31], v1
  v_mul_f32 v53, s64, v53
  v_smfmac_f32_16x16x64_bf16 v[60:63], v[44:47], a[32:39], v1
  v_mul_f32 v57, s64, v57
  v_smfmac_f32_16x16x64_bf16 v[64:67], v[44:47], a[40:47], v1
  v_cvt_pk_bf16_f32 v54, v52, v56
  v_smfmac_f32_16x16x64_bf16 v[60:63], v[48:51], a[48:55], v1
  v_cvt_pk_bf16_f32 v55, v53, v57
  v_smfmac_f32_16x16x64_bf16 v[64:67], v[48:51], a[56:63], v1
  ds_write2_b32 v5, v54, v55 offset0:0 offset1:80
  v_smfmac_f32_16x16x64_bf16 v[68:71], v[76:79], a[64:71], v1
  v_add_f32 v60, v60, v62
  v_smfmac_f32_16x16x64_bf16 v[68:71], v[80:83], a[80:87], v1
  v_add_f32 v64, v64, v66
  v_add_f32 v61, v61, v63
  v_add_f32 v65, v65, v67
  v_smfmac_f32_16x16x64_bf16 v[68:71], v[28:31], a[96:103], v1
  v_cvt_pk_bf16_f32 v134, v60, v64
  v_cvt_pk_bf16_f32 v135, v61, v65
  v_smfmac_f32_16x16x64_bf16 v[68:71], v[32:35], a[112:119], v1
  ds_write_b32 v5, v134 offset:2560
  ds_write_b32 v5, v135 offset:2880
  v_smfmac_f32_16x16x64_bf16 v[68:71], v[36:39], a[128:135], v1
  v_smfmac_f32_16x16x64_bf16 v[68:71], v[40:43], a[144:151], v1
  v_smfmac_f32_16x16x64_bf16 v[68:71], v[44:47], a[160:167], v1
  v_smfmac_f32_16x16x64_bf16 v[68:71], v[48:51], a[176:183], v1
  s_waitcnt lgkmcnt(0)
  s_barrier
  v_smfmac_f32_16x16x64_bf16 v[72:75], v[76:79], a[72:79], v1
  ds_read_b128 v[20:23], v6 offset:0
  v_smfmac_f32_16x16x64_bf16 v[72:75], v[80:83], a[88:95], v1
  ds_read_b128 v[24:27], v6 offset:64
  v_smfmac_f32_16x16x64_bf16 v[72:75], v[28:31], a[104:111], v1
  ds_read_b128 v[28:31], v6 offset:128
  v_add_f32 v68, v68, v70
  v_smfmac_f32_16x16x64_bf16 v[72:75], v[32:35], a[120:127], v1
  ds_read_b128 v[32:35], v6 offset:192
  v_add_f32 v69, v69, v71
  v_smfmac_f32_16x16x64_bf16 v[72:75], v[36:39], a[136:143], v1
  ds_read_b128 v[116:119], v6 offset:2560
  v_cvt_pk_bf16_f32 v68, v68, v69
  v_smfmac_f32_16x16x64_bf16 v[72:75], v[40:43], a[152:159], v1
  ds_read_b128 v[120:123], v6 offset:2624
  v_mov_b32 v69, 0
  v_smfmac_f32_16x16x64_bf16 v[72:75], v[44:47], a[168:175], v1
  ds_read_b128 v[60:63], v6 offset:2688
  v_smfmac_f32_16x16x64_bf16 v[72:75], v[48:51], a[184:191], v1
  ds_read_b128 v[64:67], v6 offset:2752
  s_waitcnt lgkmcnt(7)
  v_mfma_f32_16x16x32_bf16 v[52:55], v[84:87], v[20:23], 0
  s_waitcnt vmcnt(7)
  v_mov_b32 v81, 0
  s_waitcnt lgkmcnt(6)
  v_mfma_f32_16x16x32_bf16 v[52:55], v[88:91], v[24:27], v[52:55]
  ds_read_b128 v[36:39], v4 offset:18432
  s_waitcnt lgkmcnt(6)
  v_mfma_f32_16x16x32_bf16 v[52:55], v[92:95], v[28:31], v[52:55]
  v_add_f32 v72, v72, v74
  v_add_f32 v73, v73, v75
  s_waitcnt lgkmcnt(5)
  v_mfma_f32_16x16x32_bf16 v[52:55], v[96:99], v[32:35], v[52:55]
  ds_read_b128 v[40:43], v4 offset:19456
  v_cvt_pk_bf16_f32 v72, v72, v73
  v_mov_b32 v73, 0
  v_mfma_f32_16x16x32_bf16 v[56:59], v[100:103], v[20:23], 0
  v_mov_b64 v[92:93], s[60:61]
  v_mov_b64 v[94:95], s[60:61]
  v_mfma_f32_16x16x32_bf16 v[56:59], v[104:107], v[24:27], v[56:59]
  ds_read_b128 v[44:47], v4 offset:22528
  v_exp_f32 v84, v52
  v_mfma_f32_16x16x32_bf16 v[56:59], v[108:111], v[28:31], v[56:59]
  v_exp_f32 v85, v53
  v_mfma_f32_16x16x32_bf16 v[56:59], v[112:115], v[32:35], v[56:59]
  ds_read_b128 v[48:51], v4 offset:23552
  v_exp_f32 v86, v54
  s_waitcnt lgkmcnt(7)
  v_mfma_f32_16x16x32_bf16 v[76:79], v[116:119], v[20:23], 0
  v_exp_f32 v87, v55
  s_waitcnt lgkmcnt(6)
  v_mfma_f32_16x16x32_bf16 v[76:79], v[120:123], v[24:27], v[76:79]
  v_cvt_pk_bf16_f32 v100, v84, v85
  v_cvt_pk_bf16_f32 v101, v86, v87
  s_waitcnt lgkmcnt(5)
  v_mfma_f32_16x16x32_bf16 v[76:79], v[60:63], v[28:31], v[76:79]
  v_exp_f32 v88, v56
  s_waitcnt lgkmcnt(4)
  v_mfma_f32_16x16x32_bf16 v[76:79], v[64:67], v[32:35], v[76:79]
  v_exp_f32 v89, v57
  v_exp_f32 v90, v58
  v_exp_f32 v91, v59
  v_cvt_pk_bf16_f32 v102, v88, v89
  v_cvt_pk_bf16_f32 v103, v90, v91
  s_nop 1
  v_mfma_f32_16x16x32_bf16 v[108:111], v[100:103], v[92:95], 0
  v_exp_f32 v104, v76
  s_waitcnt vmcnt(6)
  v_mfma_f32_16x16x32_bf16 v[84:87], v[100:103], v[124:127], 0
  ds_read_b128 v[20:23], v4 offset:26624
  v_exp_f32 v105, v77
  s_waitcnt vmcnt(5)
  v_mfma_f32_16x16x32_bf16 v[88:91], v[100:103], v[128:131], 0
  ds_read_b128 v[24:27], v4 offset:27648
  v_cvt_pk_bf16_f32 v80, v104, v105
  s_nop 1
  v_mfma_f32_16x16x16_bf16 v[108:111], v[80:81], v[92:93], v[108:111]
  ds_read_b128 v[28:31], v4 offset:30720
  v_mov_b64 v[60:61], 0
  v_mov_b64 v[62:63], 0
  v_mfma_f32_16x16x16_bf16 v[84:87], v[80:81], v[68:69], v[84:87]
  ds_read_b128 v[32:35], v4 offset:31744
  v_mov_b64 v[64:65], 0
  v_mov_b64 v[66:67], 0
  v_mfma_f32_16x16x16_bf16 v[88:91], v[80:81], v[72:73], v[88:91]
  v_rcp_f32 v134, v108
  v_rcp_f32 v135, v109
  v_max3_f32 v96, |v52|, |v53|, |v54|
  v_max3_f32 v96, v96, |v55|, |v56|
  v_max3_f32 v96, v96, |v57|, |v58|
  v_max3_f32 v96, v96, |v59|, |v76|
  v_max_f32_e64 v96, v96, |v77|
  v_cmp_nge_f32 vcc, 0x42200000, v96
  v_mul_f32 v84, v84, v134
  v_mul_f32 v85, v85, v135
  v_mul_f32 v88, v88, v134
  v_mul_f32 v89, v89, v135
  v_cvt_pk_bf16_f32 v134, v84, v88
  v_cvt_pk_bf16_f32 v135, v85, v89
  s_cbranch_vccnz L_sm_max_130
L_sm_done_131:
  ds_write2_b32 v13, v134, v135 offset0:0 offset1:80
  s_mov_b32 m0, s67
  s_nop 0
  buffer_load_dwordx4 v10, s[4:7], s53 offen sc1 lds
  buffer_load_dwordx4 v10, s[4:7], s53 offen offset:1024 sc1 lds
  v_mov_b64 v[52:53], 0
  v_mov_b64 v[54:55], 0
  v_mov_b64 v[56:57], 0
  v_mov_b64 v[58:59], 0
  s_waitcnt lgkmcnt(0)
  s_barrier
  ds_read_b128 v[116:119], v6 offset:5120
  ds_read_b128 v[120:123], v6 offset:5184
  ds_read_b128 v[124:127], v6 offset:5248
  ds_read_b128 v[128:131], v6 offset:5312
  s_waitcnt lgkmcnt(3)
  v_smfmac_f32_16x16x64_bf16 v[52:55], v[116:119], a[192:199], v1
  ds_read_b128 v[84:87], v4 offset:20480
  s_waitcnt lgkmcnt(3)
  v_smfmac_f32_16x16x64_bf16 v[52:55], v[120:123], a[200:207], v1
  ds_read_b128 v[88:91], v4 offset:21504
  s_waitcnt lgkmcnt(3)
  v_smfmac_f32_16x16x64_bf16 v[52:55], v[124:127], a[208:215], v1
  ds_read_b128 v[92:95], v4 offset:24576
  s_waitcnt lgkmcnt(3)
  v_smfmac_f32_16x16x64_bf16 v[52:55], v[128:131], a[216:223], v1
  ds_read_b128 v[96:99], v4 offset:25600
  v_smfmac_f32_16x16x64_bf16 v[56:59], v[116:119], a[224:231], v1
  ds_read_b128 v[100:103], v4 offset:28672
  v_smfmac_f32_16x16x64_bf16 v[56:59], v[120:123], a[232:239], v1
  ds_read_b128 v[104:107], v4 offset:29696
  v_cvt_pk_bf16_f32 v52, v52, v54
  v_cvt_pk_bf16_f32 v53, v53, v55
  v_smfmac_f32_16x16x64_bf16 v[56:59], v[124:127], a[240:247], v1
  ds_read_b128 v[108:111], v4 offset:32768
  v_and_or_b32 v53, v53, -2, s47
  v_smfmac_f32_16x16x64_bf16 v[56:59], v[128:131], a[248:255], v1
  buffer_store_dwordx2 v[52:53], v15, s[4:7], s68 offen sc1
  ds_read_b128 v[112:115], v4 offset:33792
  v_smfmac_f32_16x16x64_bf16 v[60:63], v[116:119], v[36:43], v1
  v_smfmac_f32_16x16x64_bf16 v[60:63], v[120:123], v[44:51], v1
  v_cvt_pk_bf16_f32 v56, v56, v58
  v_cvt_pk_bf16_f32 v57, v57, v59
  v_smfmac_f32_16x16x64_bf16 v[60:63], v[124:127], v[20:27], v1
  v_and_or_b32 v57, v57, -2, s47
  v_smfmac_f32_16x16x64_bf16 v[60:63], v[128:131], v[28:35], v1
  buffer_store_dwordx2 v[56:57], v15, s[4:7], s69 offen sc1
  s_waitcnt lgkmcnt(6)
  v_smfmac_f32_16x16x64_bf16 v[64:67], v[116:119], v[84:91], v1
  s_waitcnt lgkmcnt(4)
  v_smfmac_f32_16x16x64_bf16 v[64:67], v[120:123], v[92:99], v1
  ds_write2st64_b32 v16, v68, v72 offset0:0 offset1:5
  v_cvt_pk_bf16_f32 v60, v60, v62
  v_cvt_pk_bf16_f32 v61, v61, v63
  s_waitcnt lgkmcnt(3)
  v_smfmac_f32_16x16x64_bf16 v[64:67], v[124:127], v[100:107], v1
  v_and_or_b32 v61, v61, -2, s47
  s_waitcnt lgkmcnt(1)
  v_smfmac_f32_16x16x64_bf16 v[64:67], v[128:131], v[108:115], v1
  buffer_store_dwordx2 v[60:61], v15, s[4:7], s70 offen sc1
  v_not_b32 v21, s46
  v_not_b32 v23, s46
  v_not_b32 v25, s46
  v_not_b32 v27, s46
  v_mov_b64 v[52:53], 0
  s_nop 1
  v_cvt_pk_bf16_f32 v64, v64, v66
  v_cvt_pk_bf16_f32 v65, v65, v67
  v_and_or_b32 v65, v65, -2, s47
  buffer_store_dwordx2 v[64:65], v15, s[4:7], s71 offen sc1
  ds_read_b128 v[36:39], v6 offset:256
  v_mov_b64 v[54:55], 0
  v_mov_b64 v[56:57], 0
  v_mov_b64 v[58:59], 0
  v_mov_b64 v[60:61], 0
  v_mov_b64 v[62:63], 0
  v_mov_b64 v[64:65], 0
  v_mov_b64 v[66:67], 0
  v_mov_b32 v76, -1
  v_mov_b32 v77, -1
  v_mov_b32 v78, -1
  v_mov_b32 v79, -1
  v_mov_b32 v80, -1
  v_mov_b32 v81, -1
  v_mov_b32 v82, -1
  v_mov_b32 v83, -1
  s_waitcnt vmcnt(4)
  s_cmp_eq_u32 s77, 0
  s_cbranch_scc1 L_pi_go_132
  s_waitcnt vmcnt(3)
  s_cmp_eq_u32 s77, 1
  s_cbranch_scc1 L_pi_go_132
  s_waitcnt vmcnt(2)
  s_cmp_eq_u32 s77, 2
  s_cbranch_scc1 L_pi_go_132
  s_waitcnt vmcnt(1)
L_pi_go_132:
L_pi_top_133:
  buffer_load_dwordx4 v[20:23], v2, s[4:7], s76 offen sc1
  buffer_load_dwordx4 v[24:27], v2, s[4:7], s76 offen offset:1024 sc1
  s_sub_u32 s48, s48, 1
  s_cbranch_scc1 L_pi_expired_135
L_pi_wait_136:
  s_waitcnt vmcnt(2) lgkmcnt(0)
  v_bitop3_b32 v134, v21, v23, s46 bitop3:0x7e
  v_bitop3_b32 v135, v25, v27, s46 bitop3:0x7e
  v_mfma_f32_16x16x32_bf16 v[40:43], v[36:39], v[20:23], 0
  v_bitop3_b32 v134, v134, v135, 1 bitop3:0xa8
  v_mfma_f32_16x16x32_bf16 v[40:43], v[36:39], v[24:27], v[40:43]
  v_cmp_ne_u32 vcc, 0, v134
  s_cbranch_vccnz L_pi_top_133
L_pi_out_134:
  s_nop 5
  v_add_f32_dpp v40, v40, v40 row_ror:8 row_mask:0xf bank_mask:0xf
  v_add_f32_dpp v41, v41, v41 row_ror:8 row_mask:0xf bank_mask:0xf
  s_nop 0
  v_add_f32_dpp v40, v40, v40 row_ror:4 row_mask:0xf bank_mask:0xf
  v_add_f32_dpp v41, v41, v41 row_ror:4 row_mask:0xf bank_mask:0xf
  v_cvt_pk_bf16_f32 v40, v40, v41
  v_min_u32 v40, -2, v40
  buffer_store_dword v40, v17, s[4:7], s50 offen sc1
  s_mov_b32 s78, s45
  s_mov_b32 s79, s51
  s_add_u32 s45, s45, 1
  s_add_u32 s49, s49, 8192
  s_add_u32 s50, s50, 8192
  s_add_u32 s51, s51, 65536
  s_add_u32 s53, s53, 0x40000
  s_add_u32 s54, s54, 0x40000
  s_xor_b32 s47, s47, 1
  s_not_b32 s46, s46
  s_cmp_lt_u32 s45, 63
  s_cbranch_scc1 L_step_120
  s_cmp_gt_u32 s77, 0
  s_cbranch_scc1 L_pm_now_138
  s_waitcnt vmcnt(0)
L_pm_now_138:
  buffer_load_dwordx4 v[76:79], v2, s[4:7], s49 offen sc1
  buffer_load_dwordx4 v[80:83], v2, s[4:7], s49 offen offset:1024 sc1
  v_mov_b64 v[68:69], 0
  v_mov_b64 v[70:71], 0
  v_mov_b64 v[72:73], 0
  v_mov_b64 v[74:75], 0
  s_nop 3
L_pmf_top_139:
  buffer_load_dwordx4 v[76:79], v2, s[4:7], s49 offen sc1
  buffer_load_dwordx4 v[80:83], v2, s[4:7], s49 offen offset:1024 sc1
  s_sub_u32 s48, s48, 1
  s_cbranch_scc1 L_pmf_expired_141
L_pmf_wait_142:
  s_waitcnt vmcnt(2)
  v_max3_u32 v133, v76, v77, v78
  v_max3_u32 v134, v79, v80, v81
  v_max3_u32 v133, v133, v82, v83
  v_max_u32 v133, v133, v134
  v_cmp_eq_u32 vcc, -1, v133
  s_cbranch_vccnz L_pmf_top_139
L_pmf_out_140:
L_pm_done_137:
  ds_write_b128 v2, v[76:79] offset:0
  ds_write_b128 v2, v[80:83] offset:1024
  ds_read_b128 v[20:23], v18
  v_smfmac_f32_16x16x64_bf16 v[60:63], v[76:79], v[192:199], v1
  v_smfmac_f32_16x16x64_bf16 v[64:67], v[76:79], v[200:207], v1
  s_waitcnt lgkmcnt(0)
  v_min_u32 v20, -2, v20
  v_min_u32 v21, -2, v21
  v_smfmac_f32_16x16x64_bf16 v[60:63], v[80:83], v[208:215], v1
  v_min_u32 v22, -2, v22
  v_min_u32 v23, -2, v23
  buffer_store_dwordx4 v[20:23], v19, s[4:7], s79 offen sc1
  v_smfmac_f32_16x16x64_bf16 v[64:67], v[80:83], v[216:223], v1
  s_waitcnt lgkmcnt(0)
  s_barrier
  ds_read_b128 v[28:31], v3 offset:0
  s_waitcnt lgkmcnt(0)
  v_smfmac_f32_16x16x64_bf16 v[60:63], v[28:31], v[224:231], v1
  ds_read_b128 v[32:35], v3 offset:1024
  v_mov_b32 v134, s78
  s_mov_b64 exec, s[72:73]
  buffer_store_dword v134, off, s[4:7], s56 sc1
  s_mov_b64 exec, -1
  v_smfmac_f32_16x16x64_bf16 v[64:67], v[28:31], v[232:239], v1
  ds_read_b128 v[36:39], v12 offset:0
  s_waitcnt lgkmcnt(1)
  v_smfmac_f32_16x16x64_bf16 v[60:63], v[32:35], v[240:247], v1
  ds_read_b128 v[40:43], v12 offset:1024
  v_smfmac_f32_16x16x64_bf16 v[64:67], v[32:35], v[248:255], v1
  ds_read_b128 v[44:47], v7 offset:0
  s_waitcnt lgkmcnt(2)
  v_smfmac_f32_16x16x64_bf16 v[60:63], v[36:39], a[0:7], v1
  ds_read_b128 v[48:51], v7 offset:1024
  v_smfmac_f32_16x16x64_bf16 v[64:67], v[36:39], a[8:15], v1
  s_waitcnt lgkmcnt(2)
  v_smfmac_f32_16x16x64_bf16 v[60:63], v[40:43], a[16:23], v1
  v_smfmac_f32_16x16x64_bf16 v[64:67], v[40:43], a[24:31], v1
  s_waitcnt lgkmcnt(1)
  v_smfmac_f32_16x16x64_bf16 v[60:63], v[44:47], a[32:39], v1
  v_smfmac_f32_16x16x64_bf16 v[64:67], v[44:47], a[40:47], v1
  s_waitcnt lgkmcnt(0)
  v_smfmac_f32_16x16x64_bf16 v[60:63], v[48:51], a[48:55], v1
  v_smfmac_f32_16x16x64_bf16 v[64:67], v[48:51], a[56:63], v1
  v_smfmac_f32_16x16x64_bf16 v[68:71], v[76:79], a[64:71], v1
  v_add_f32 v60, v60, v62
  v_smfmac_f32_16x16x64_bf16 v[72:75], v[76:79], a[72:79], v1
  v_add_f32 v64, v64, v66
  v_add_f32 v61, v61, v63
  v_add_f32 v65, v65, v67
  v_smfmac_f32_16x16x64_bf16 v[68:71], v[80:83], a[80:87], v1
  v_cvt_pk_bf16_f32 v134, v60, v64
  v_cvt_pk_bf16_f32 v135, v61, v65
  v_smfmac_f32_16x16x64_bf16 v[72:75], v[80:83], a[88:95], v1
  ds_write_b32 v5, v134 offset:2560
  ds_write_b32 v5, v135 offset:2880
  v_smfmac_f32_16x16x64_bf16 v[68:71], v[28:31], a[96:103], v1
  v_smfmac_f32_16x16x64_bf16 v[72:75], v[28:31], a[104:111], v1
  v_smfmac_f32_16x16x64_bf16 v[68:71], v[32:35], a[112:119], v1
  v_smfmac_f32_16x16x64_bf16 v[72:75], v[32:35], a[120:127], v1
  v_smfmac_f32_16x16x64_bf16 v[68:71], v[36:39], a[128:135], v1
  v_smfmac_f32_16x16x64_bf16 v[72:75], v[36:39], a[136:143], v1
  v_smfmac_f32_16x16x64_bf16 v[68:71], v[40:43], a[144:151], v1
  v_smfmac_f32_16x16x64_bf16 v[72:75], v[40:43], a[152:159], v1
  v_smfmac_f32_16x16x64_bf16 v[68:71], v[44:47], a[160:167], v1
  v_smfmac_f32_16x16x64_bf16 v[72:75], v[44:47], a[168:175], v1
  v_smfmac_f32_16x16x64_bf16 v[68:71], v[48:51], a[176:183], v1
  v_smfmac_f32_16x16x64_bf16 v[72:75], v[48:51], a[184:191], v1
  s_nop 3
  v_add_f32 v68, v68, v70
  s_nop 2
  v_add_f32 v72, v72, v74
  v_add_f32 v69, v69, v71
  v_add_f32 v73, v73, v75
  v_cvt_pk_bf16_f32 v68, v68, v69
  v_cvt_pk_bf16_f32 v72, v72, v73
  ds_write2st64_b32 v16, v68, v72 offset0:0 offset1:5
  ds_read_b128 v[20:23], v18
  s_waitcnt lgkmcnt(0)
  v_min_u32 v20, -2, v20
  v_min_u32 v21, -2, v21
  v_min_u32 v22, -2, v22
  v_min_u32 v23, -2, v23
  buffer_store_dwordx4 v[20:23], v19, s[4:7], s51 offen sc1
  s_branch L_roles_done_119
L_pmf_expired_128:
  s_mov_b32 s48, 0
  s_waitcnt vmcnt(0)
  s_branch L_pmf_out_127
L_sm_max_130:
  v_max3_f32 v134, v52, v53, v54
  v_max3_f32 v134, v134, v55, v56
  v_max3_f32 v134, v134, v57, v58
  v_max3_f32 v134, v134, v59, v76
  v_max_f32 v134, v134, v77
  s_waitcnt vmcnt(1)
  v_mov_b32 v133, v134
  s_nop 1
  v_permlane32_swap_b32 v134, v133
  v_max_f32 v134, v134, v133
  v_mov_b32 v133, v134
  s_nop 1
  v_permlane16_swap_b32 v134, v133
  v_max_f32 v134, v134, v133
  v_sub_f32 v84, v52, v134
  v_sub_f32 v85, v53, v134
  v_sub_f32 v86, v54, v134
  v_sub_f32 v87, v55, v134
  v_sub_f32 v88, v56, v134
  v_sub_f32 v89, v57, v134
  v_sub_f32 v90, v58, v134
  v_sub_f32 v91, v59, v134
  v_sub_f32 v104, v76, v134
  v_sub_f32 v105, v77, v134
  v_exp_f32 v84, v84
  v_exp_f32 v85, v85
  v_exp_f32 v86, v86
  v_exp_f32 v87, v87
  v_exp_f32 v88, v88
  v_exp_f32 v89, v89
  v_exp_f32 v90, v90
  v_exp_f32 v91, v91
  v_exp_f32 v104, v104
  v_exp_f32 v105, v105
  v_cvt_pk_bf16_f32 v100, v84, v85
  v_cvt_pk_bf16_f32 v101, v86, v87
  v_cvt_pk_bf16_f32 v102, v88, v89
  v_cvt_pk_bf16_f32 v103, v90, v91
  v_cvt_pk_bf16_f32 v80, v104, v105
  s_nop 0
  v_mfma_f32_16x16x32_bf16 v[108:111], v[100:103], v[92:95], 0
  v_mfma_f32_16x16x32_bf16 v[84:87], v[100:103], v[124:127], 0
  v_mfma_f32_16x16x32_bf16 v[88:91], v[100:103], v[128:131], 0
  v_mfma_f32_16x16x16_bf16 v[108:111], v[80:81], v[92:93], v[108:111]
  v_mfma_f32_16x16x16_bf16 v[84:87], v[80:81], v[68:69], v[84:87]
  v_mfma_f32_16x16x16_bf16 v[88:91], v[80:81], v[72:73], v[88:91]
  v_rcp_f32 v134, v108
  v_rcp_f32 v135, v109
  s_nop 1
  v_mul_f32 v84, v84, v134
  v_mul_f32 v85, v85, v135
  s_nop 1
  v_mul_f32 v88, v88, v134
  v_mul_f32 v89, v89, v135
  v_cvt_pk_bf16_f32 v134, v84, v88
  v_cvt_pk_bf16_f32 v135, v85, v89
  s_branch L_sm_done_131
L_pi_expired_135:
  s_mov_b32 s48, 0
  s_waitcnt vmcnt(0) lgkmcnt(0)
  s_branch L_pi_out_134
L_pmf_expired_141:
  s_mov_b32 s48, 0
  s_waitcnt vmcnt(0)
  s_branch L_pmf_out_140
L_roles_done_119:
  s_waitcnt vmcnt(0)
  s_barrier
  s_cmp_lg_u32 s14, 0
  s_cbranch_scc1 L_fin_143
  v_mov_b32 v134, 64
  v_mov_b32 v135, 0
  buffer_store_dword v134, v135, s[4:7], s56 offen sc1
L_fin_143:
  s_branch L_end
L_h:
  s_load_dwordx2 s[24:25], s[0:1], 16
  s_mov_b32 s26, 0x400000
  s_mov_b32 s27, 0x20000
  s_load_dwordx2 s[28:29], s[0:1], 24
  s_mov_b32 s30, 0x400000
  s_mov_b32 s31, 0x20000
  s_load_dwordx2 s[32:33], s[0:1], 32
  s_mov_b32 s34, 0x400000
  s_mov_b32 s35, 0x20000
  s_load_dwordx2 s[36:37], s[0:1], 0
  s_mov_b32 s38, 0x200000
  s_mov_b32 s39, 0x20000
  s_sub_u32 s42, s20, 32
  s_mul_i32 s44, s42, 0xaaab
  s_lshr_b32 s44, s44, 17
  s_mul_i32 s43, s44, 3
  s_sub_u32 s45, s42, s43
  v_mov_b32 v1, 0x0
  v_bfe_u32 v12, v0, 0, 4
  v_mad_i32_i24 v1, v12, 16, v1
  v_bfe_u32 v12, v0, 4, 2
  s_mov_b32 s42, 0x2040
  v_mad_i32_i24 v1, v12, s42, v1
  v_bfe_u32 v12, v0, 2, 1
  v_bfe_u32 v13, v0, 4, 1
  v_and_b32 v12, v12, v13
  s_mov_b32 s42, 0xffffff80
  v_mad_i32_i24 v1, v12, s42, v1
  v_bfe_u32 v12, v0, 3, 1
  v_bfe_u32 v13, v0, 5, 1
  v_and_b32 v12, v12, v13
  s_mov_b32 s42, 0xffffff00
  v_mad_i32_i24 v1, v12, s42, v1
  v_mov_b32 v2, 0x0
  v_bfe_u32 v12, v0, 0, 1
  v_mad_i32_i24 v2, v12, 16, v2
  v_bfe_u32 v12, v0, 1, 1
  v_mad_i32_i24 v2, v12, 8, v2
  v_bfe_u32 v12, v0, 2, 2
  s_mov_b32 s42, 0x140
  v_mad_i32_i24 v2, v12, s42, v2
  v_bfe_u32 v12, v0, 4, 1
  v_mad_i32_i24 v2, v12, 32, v2
  v_bfe_u32 v12, v0, 5, 1
  s_mov_b32 s42, 0x800
  v_mad_i32_i24 v2, v12, s42, v2
  v_bfe_u32 v12, v0, 6, 2
  v_mad_i32_i24 v2, v12, 64, v2
  v_bfe_u32 v12, v0, 2, 1
  v_bfe_u32 v13, v0, 6, 1
  v_and_b32 v12, v12, v13
  s_mov_b32 s42, 0xffffff80
  v_mad_i32_i24 v2, v12, s42, v2
  v_bfe_u32 v12, v0, 3, 1
  v_bfe_u32 v13, v0, 7, 1
  v_and_b32 v12, v12, v13
  s_mov_b32 s42, 0xffffff00
  v_mad_i32_i24 v2, v12, s42, v2
  v_mov_b32 v4, 0x0
  v_bfe_u32 v12, v0, 0, 2
  v_mad_i32_i24 v4, v12, 8, v4
  v_bfe_u32 v12, v0, 2, 2
  s_mov_b32 s42, 0x140
  v_mad_i32_i24 v4, v12, s42, v4
  v_bfe_u32 v12, v0, 4, 1
  v_mad_i32_i24 v4, v12, 32, v4
  v_bfe_u32 v12, v0, 5, 1
  s_mov_b32 s42, 0x800
  v_mad_i32_i24 v4, v12, s42, v4
  v_bfe_u32 v12, v0, 6, 2
  v_mad_i32_i24 v4, v12, 64, v4
  v_bfe_u32 v12, v0, 2, 1
  v_bfe_u32 v13, v0, 6, 1
  v_and_b32 v12, v12, v13
  s_mov_b32 s42, 0xffffff80
  v_mad_i32_i24 v4, v12, s42, v4
  v_bfe_u32 v12, v0, 3, 1
  v_bfe_u32 v13, v0, 7, 1
  v_and_b32 v12, v12, v13
  s_mov_b32 s42, 0xffffff00
  v_mad_i32_i24 v4, v12, s42, v4
  v_add_u32 v3, 0x10000, v2
  v_add_u32 v5, 0x10000, v4
  s_lshl_b32 s41, s14, 13
  v_mov_b32 v6, 0x0
  v_bfe_u32 v12, v0, 0, 6
  v_mad_i32_i24 v6, v12, 16, v6
  v_mov_b32 v7, 0x0
  v_bfe_u32 v12, v0, 0, 5
  s_mov_b32 s42, 0x410
  v_mad_i32_i24 v7, v12, s42, v7
  v_bfe_u32 v12, v0, 5, 1
  v_mad_i32_i24 v7, v12, 16, v7
  v_and_b32 v12, 63, v0
  v_mov_b32 v13, 0x40000000
  v_cmp_ne_u32 vcc, 0, v12
  s_nop 1
  v_cndmask_b32 v10, v12, v13, vcc
  v_mov_b32 v11, 1
  v_mov_b32 v8, 0x0
  v_bfe_u32 v12, v0, 0, 6
  v_mad_i32_i24 v8, v12, 16, v8
  v_bfe_u32 v12, v0, 6, 2
  s_mov_b32 s42, 0x800
  v_mad_i32_i24 v8, v12, s42, v8
  v_mov_b32 v9, 0x0
  v_bfe_u32 v12, v0, 0, 1
  s_mov_b32 s42, 0x800
  v_mad_i32_i24 v9, v12, s42, v9
  v_bfe_u32 v12, v0, 1, 4
  v_mad_i32_i24 v9, v12, 16, v9
  v_bfe_u32 v12, v0, 5, 1
  s_mov_b32 s42, 0x200
  v_mad_i32_i24 v9, v12, s42, v9
  v_bfe_u32 v12, v0, 6, 1
  s_mov_b32 s42, 0x100
  v_mad_i32_i24 v9, v12, s42, v9
  v_bfe_u32 v12, v0, 7, 1
  s_mov_b32 s42, 0x1000
  v_mad_i32_i24 v9, v12, s42, v9
  s_lshl_b32 s40, s14, 18
  s_lshl_b32 s42, s44, 8
  s_add_u32 s40, s40, s42
  s_lshl_b32 s47, s45, 15
  s_lshl_b32 s42, s14, 13
  s_add_u32 s47, s47, s42
  s_mul_i32 s48, s14, 8320
  s_add_u32 s48, s48, 99328
  s_waitcnt lgkmcnt(0)
  s_add_u32 s42, s40, 0x0
  s_add_u32 m0, s41, 0
  s_nop 0
  buffer_load_dwordx4 v1, s[28:31], s42 offen lds
  s_add_u32 s42, s40, 0x8000
  s_add_u32 m0, s41, 1024
  s_nop 0
  buffer_load_dwordx4 v1, s[28:31], s42 offen lds
  s_add_u32 s42, s40, 0x10000
  s_add_u32 m0, s41, 2048
  s_nop 0
  buffer_load_dwordx4 v1, s[28:31], s42 offen lds
  s_add_u32 s42, s40, 0x18000
  s_add_u32 m0, s41, 3072
  s_nop 0
  buffer_load_dwordx4 v1, s[28:31], s42 offen lds
  s_add_u32 s42, s40, 0x20000
  s_add_u32 m0, s41, 4096
  s_nop 0
  buffer_load_dwordx4 v1, s[28:31], s42 offen lds
  s_add_u32 s42, s40, 0x28000
  s_add_u32 m0, s41, 5120
  s_nop 0
  buffer_load_dwordx4 v1, s[28:31], s42 offen lds
  s_add_u32 s42, s40, 0x30000
  s_add_u32 m0, s41, 6144
  s_nop 0
  buffer_load_dwordx4 v1, s[28:31], s42 offen lds
  s_add_u32 s42, s40, 0x38000
  s_add_u32 m0, s41, 7168
  s_nop 0
  buffer_load_dwordx4 v1, s[28:31], s42 offen lds
  s_add_u32 s42, s40, 0x100000
  s_add_u32 m0, s41, 32768
  s_nop 0
  buffer_load_dwordx4 v1, s[28:31], s42 offen lds
  s_add_u32 s42, s40, 0x108000
  s_add_u32 m0, s41, 33792
  s_nop 0
  buffer_load_dwordx4 v1, s[28:31], s42 offen lds
  s_add_u32 s42, s40, 0x110000
  s_add_u32 m0, s41, 34816
  s_nop 0
  buffer_load_dwordx4 v1, s[28:31], s42 offen lds
  s_add_u32 s42, s40, 0x118000
  s_add_u32 m0, s41, 35840
  s_nop 0
  buffer_load_dwordx4 v1, s[28:31], s42 offen lds
  s_add_u32 s42, s40, 0x120000
  s_add_u32 m0, s41, 36864
  s_nop 0
  buffer_load_dwordx4 v1, s[28:31], s42 offen lds
  s_add_u32 s42, s40, 0x128000
  s_add_u32 m0, s41, 37888
  s_nop 0
  buffer_load_dwordx4 v1, s[28:31], s42 offen lds
  s_add_u32 s42, s40, 0x130000
  s_add_u32 m0, s41, 38912
  s_nop 0
  buffer_load_dwordx4 v1, s[28:31], s42 offen lds
  s_add_u32 s42, s40, 0x138000
  s_add_u32 m0, s41, 39936
  s_nop 0
  buffer_load_dwordx4 v1, s[28:31], s42 offen lds
  s_add_u32 m0, s48, 0
  s_nop 0
  buffer_load_dwordx4 v6, s[36:39], s47 offen offset:0 lds
  s_add_u32 m0, s48, 16
  s_nop 0
  buffer_load_dwordx4 v6, s[36:39], s47 offen offset:1024 lds
  s_add_u32 m0, s48, 32
  s_nop 0
  buffer_load_dwordx4 v6, s[36:39], s47 offen offset:2048 lds
  s_add_u32 m0, s48, 48
  s_nop 0
  buffer_load_dwordx4 v6, s[36:39], s47 offen offset:3072 lds
  s_add_u32 s42, s47, 4096
  s_add_u32 m0, s48, 4160
  s_nop 0
  buffer_load_dwordx4 v6, s[36:39], s42 offen offset:0 lds
  s_add_u32 m0, s48, 4176
  s_nop 0
  buffer_load_dwordx4 v6, s[36:39], s42 offen offset:1024 lds
  s_add_u32 m0, s48, 4192
  s_nop 0
  buffer_load_dwordx4 v6, s[36:39], s42 offen offset:2048 lds
  s_add_u32 m0, s48, 4208
  s_nop 0
  buffer_load_dwordx4 v6, s[36:39], s42 offen offset:3072 lds
  s_waitcnt vmcnt(16)
  s_waitcnt lgkmcnt(0)
  s_barrier
  s_add_u32 s42, s40, 0x200000
  s_add_u32 m0, s41, 65536
  s_nop 0
  buffer_load_dwordx4 v1, s[28:31], s42 offen lds
  s_add_u32 s42, s40, 0x208000
  s_add_u32 m0, s41, 66560
  s_nop 0
  buffer_load_dwordx4 v1, s[28:31], s42 offen lds
  s_add_u32 s42, s40, 0x210000
  s_add_u32 m0, s41, 67584
  s_nop 0
  buffer_load_dwordx4 v1, s[28:31], s42 offen lds
  s_add_u32 s42, s40, 0x218000
  s_add_u32 m0, s41, 68608
  s_nop 0
  buffer_load_dwordx4 v1, s[28:31], s42 offen lds
  s_add_u32 s42, s40, 0x220000
  s_add_u32 m0, s41, 69632
  s_nop 0
  buffer_load_dwordx4 v1, s[28:31], s42 offen lds
  s_add_u32 s42, s40, 0x228000
  s_add_u32 m0, s41, 70656
  s_nop 0
  buffer_load_dwordx4 v1, s[28:31], s42 offen lds
  s_add_u32 s42, s40, 0x230000
  s_add_u32 m0, s41, 71680
  s_nop 0
  buffer_load_dwordx4 v1, s[28:31], s42 offen lds
  s_add_u32 s42, s40, 0x238000
  s_add_u32 m0, s41, 72704
  s_nop 0
  buffer_load_dwordx4 v1, s[28:31], s42 offen lds
  s_cmp_eq_u32 s22, 0
  s_cbranch_scc1 L_rf_skip_144
  s_barrier
  s_mov_b32 s22, 0
  s_cmp_lg_u32 s14, 0
  s_cbranch_scc1 L_rf_w_145
  v_mov_b32 v20, 1
  v_mov_b32 v21, 0x40000000
  v_cmp_eq_u32 vcc, 0, v0
  s_nop 1
  v_cndmask_b32 v21, v21, 0, vcc
  buffer_atomic_add v20, v21, s[8:11], 0 offen offset:32 sc1
L_rf_w_145:
L_rf_skip_144:
  ds_read_b64_tr_b16 a[128:129], v2 offset:0
  ds_read_b64_tr_b16 a[130:131], v2 offset:1024
  ds_read_b64_tr_b16 a[132:133], v2 offset:4096
  ds_read_b64_tr_b16 a[134:135], v2 offset:5120
  ds_read_b64_tr_b16 a[136:137], v2 offset:8192
  ds_read_b64_tr_b16 a[138:139], v2 offset:9216
  ds_read_b64_tr_b16 a[140:141], v2 offset:12288
  ds_read_b64_tr_b16 a[142:143], v2 offset:13312
  ds_read_b64_tr_b16 a[144:145], v2 offset:16384
  ds_read_b64_tr_b16 a[146:147], v2 offset:17408
  ds_read_b64_tr_b16 a[148:149], v2 offset:20480
  ds_read_b64_tr_b16 a[150:151], v2 offset:21504
  ds_read_b64_tr_b16 a[152:153], v2 offset:24576
  ds_read_b64_tr_b16 a[154:155], v2 offset:25600
  ds_read_b64_tr_b16 a[156:157], v2 offset:28672
  ds_read_b64_tr_b16 a[158:159], v2 offset:29696
  s_waitcnt vmcnt(16)
  s_waitcnt lgkmcnt(0)
  s_barrier
  s_add_u32 s42, s40, 0x300000
  s_add_u32 m0, s41, 0
  s_nop 0
  buffer_load_dwordx4 v1, s[28:31], s42 offen lds
  s_add_u32 s42, s40, 0x308000
  s_add_u32 m0, s41, 1024
  s_nop 0
  buffer_load_dwordx4 v1, s[28:31], s42 offen lds
  s_add_u32 s42, s40, 0x310000
  s_add_u32 m0, s41, 2048
  s_nop 0
  buffer_load_dwordx4 v1, s[28:31], s42 offen lds
  s_add_u32 s42, s40, 0x318000
  s_add_u32 m0, s41, 3072
  s_nop 0
  buffer_load_dwordx4 v1, s[28:31], s42 offen lds
  s_add_u32 s42, s40, 0x320000
  s_add_u32 m0, s41, 4096
  s_nop 0
  buffer_load_dwordx4 v1, s[28:31], s42 offen lds
  s_add_u32 s42, s40, 0x328000
  s_add_u32 m0, s41, 5120
  s_nop 0
  buffer_load_dwordx4 v1, s[28:31], s42 offen lds
  s_add_u32 s42, s40, 0x330000
  s_add_u32 m0, s41, 6144
  s_nop 0
  buffer_load_dwordx4 v1, s[28:31], s42 offen lds
  s_add_u32 s42, s40, 0x338000
  s_add_u32 m0, s41, 7168
  s_nop 0
  buffer_load_dwordx4 v1, s[28:31], s42 offen lds
  ds_read_b64_tr_b16 a[160:161], v2 offset:32768
  ds_read_b64_tr_b16 a[162:163], v2 offset:33792
  ds_read_b64_tr_b16 a[164:165], v2 offset:36864
  ds_read_b64_tr_b16 a[166:167], v2 offset:37888
  ds_read_b64_tr_b16 a[168:169], v2 offset:40960
  ds_read_b64_tr_b16 a[170:171], v2 offset:41984
  ds_read_b64_tr_b16 a[172:173], v2 offset:45056
  ds_read_b64_tr_b16 a[174:175], v2 offset:46080
  ds_read_b64_tr_b16 a[176:177], v2 offset:49152
  ds_read_b64_tr_b16 a[178:179], v2 offset:50176
  ds_read_b64_tr_b16 a[180:181], v2 offset:53248
  ds_read_b64_tr_b16 a[182:183], v2 offset:54272
  ds_read_b64_tr_b16 a[184:185], v2 offset:57344
  ds_read_b64_tr_b16 a[186:187], v2 offset:58368
  ds_read_b64_tr_b16 a[188:189], v2 offset:61440
  ds_read_b64_tr_b16 a[190:191], v2 offset:62464
  s_waitcnt vmcnt(8)
  s_waitcnt lgkmcnt(0)
  s_barrier
  s_add_u32 s42, s40, 0x0
  s_add_u32 m0, s41, 32768
  s_nop 0
  buffer_load_dwordx4 v1, s[32:35], s42 offen lds
  s_add_u32 s42, s40, 0x8000
  s_add_u32 m0, s41, 33792
  s_nop 0
  buffer_load_dwordx4 v1, s[32:35], s42 offen lds
  s_add_u32 s42, s40, 0x10000
  s_add_u32 m0, s41, 34816
  s_nop 0
  buffer_load_dwordx4 v1, s[32:35], s42 offen lds
  s_add_u32 s42, s40, 0x18000
  s_add_u32 m0, s41, 35840
  s_nop 0
  buffer_load_dwordx4 v1, s[32:35], s42 offen lds
  s_add_u32 s42, s40, 0x20000
  s_add_u32 m0, s41, 36864
  s_nop 0
  buffer_load_dwordx4 v1, s[32:35], s42 offen lds
  s_add_u32 s42, s40, 0x28000
  s_add_u32 m0, s41, 37888
  s_nop 0
  buffer_load_dwordx4 v1, s[32:35], s42 offen lds
  s_add_u32 s42, s40, 0x30000
  s_add_u32 m0, s41, 38912
  s_nop 0
  buffer_load_dwordx4 v1, s[32:35], s42 offen lds
  s_add_u32 s42, s40, 0x38000
  s_add_u32 m0, s41, 39936
  s_nop 0
  buffer_load_dwordx4 v1, s[32:35], s42 offen lds
  ds_read_b64_tr_b16 a[192:193], v3 offset:0
  ds_read_b64_tr_b16 a[194:195], v3 offset:1024
  ds_read_b64_tr_b16 a[196:197], v3 offset:4096
  ds_read_b64_tr_b16 a[198:199], v3 offset:5120
  ds_read_b64_tr_b16 a[200:201], v3 offset:8192
  ds_read_b64_tr_b16 a[202:203], v3 offset:9216
  ds_read_b64_tr_b16 a[204:205], v3 offset:12288
  ds_read_b64_tr_b16 a[206:207], v3 offset:13312
  ds_read_b64_tr_b16 a[208:209], v3 offset:16384
  ds_read_b64_tr_b16 a[210:211], v3 offset:17408
  ds_read_b64_tr_b16 a[212:213], v3 offset:20480
  ds_read_b64_tr_b16 a[214:215], v3 offset:21504
  ds_read_b64_tr_b16 a[216:217], v3 offset:24576
  ds_read_b64_tr_b16 a[218:219], v3 offset:25600
  ds_read_b64_tr_b16 a[220:221], v3 offset:28672
  ds_read_b64_tr_b16 a[222:223], v3 offset:29696
  s_waitcnt vmcnt(8)
  s_waitcnt lgkmcnt(0)
  s_barrier
  s_add_u32 s42, s40, 0x100000
  s_add_u32 m0, s41, 65536
  s_nop 0
  buffer_load_dwordx4 v1, s[32:35], s42 offen lds
  s_add_u32 s42, s40, 0x108000
  s_add_u32 m0, s41, 66560
  s_nop 0
  buffer_load_dwordx4 v1, s[32:35], s42 offen lds
  s_add_u32 s42, s40, 0x110000
  s_add_u32 m0, s41, 67584
  s_nop 0
  buffer_load_dwordx4 v1, s[32:35], s42 offen lds
  s_add_u32 s42, s40, 0x118000
  s_add_u32 m0, s41, 68608
  s_nop 0
  buffer_load_dwordx4 v1, s[32:35], s42 offen lds
  s_add_u32 s42, s40, 0x120000
  s_add_u32 m0, s41, 69632
  s_nop 0
  buffer_load_dwordx4 v1, s[32:35], s42 offen lds
  s_add_u32 s42, s40, 0x128000
  s_add_u32 m0, s41, 70656
  s_nop 0
  buffer_load_dwordx4 v1, s[32:35], s42 offen lds
  s_add_u32 s42, s40, 0x130000
  s_add_u32 m0, s41, 71680
  s_nop 0
  buffer_load_dwordx4 v1, s[32:35], s42 offen lds
  s_add_u32 s42, s40, 0x138000
  s_add_u32 m0, s41, 72704
  s_nop 0
  buffer_load_dwordx4 v1, s[32:35], s42 offen lds
  ds_read_b64_tr_b16 a[224:225], v2 offset:0
  ds_read_b64_tr_b16 a[226:227], v2 offset:1024
  ds_read_b64_tr_b16 a[228:229], v2 offset:4096
  ds_read_b64_tr_b16 a[230:231], v2 offset:5120
  ds_read_b64_tr_b16 a[232:233], v2 offset:8192
  ds_read_b64_tr_b16 a[234:235], v2 offset:9216
  ds_read_b64_tr_b16 a[236:237], v2 offset:12288
  ds_read_b64_tr_b16 a[238:239], v2 offset:13312
  ds_read_b64_tr_b16 a[240:241], v2 offset:16384
  ds_read_b64_tr_b16 a[242:243], v2 offset:17408
  ds_read_b64_tr_b16 a[244:245], v2 offset:20480
  ds_read_b64_tr_b16 a[246:247], v2 offset:21504
  ds_read_b64_tr_b16 a[248:249], v2 offset:24576
  ds_read_b64_tr_b16 a[250:251], v2 offset:25600
  ds_read_b64_tr_b16 a[252:253], v2 offset:28672
  ds_read_b64_tr_b16 a[254:255], v2 offset:29696
  s_waitcnt vmcnt(8)
  s_waitcnt lgkmcnt(0)
  s_barrier
  s_add_u32 s42, s40, 0x200000
  s_add_u32 m0, s41, 0
  s_nop 0
  buffer_load_dwordx4 v1, s[32:35], s42 offen lds
  s_add_u32 s42, s40, 0x208000
  s_add_u32 m0, s41, 1024
  s_nop 0
  buffer_load_dwordx4 v1, s[32:35], s42 offen lds
  s_add_u32 s42, s40, 0x210000
  s_add_u32 m0, s41, 2048
  s_nop 0
  buffer_load_dwordx4 v1, s[32:35], s42 offen lds
  s_add_u32 s42, s40, 0x218000
  s_add_u32 m0, s41, 3072
  s_nop 0
  buffer_load_dwordx4 v1, s[32:35], s42 offen lds
  s_add_u32 s42, s40, 0x220000
  s_add_u32 m0, s41, 4096
  s_nop 0
  buffer_load_dwordx4 v1, s[32:35], s42 offen lds
  s_add_u32 s42, s40, 0x228000
  s_add_u32 m0, s41, 5120
  s_nop 0
  buffer_load_dwordx4 v1, s[32:35], s42 offen lds
  s_add_u32 s42, s40, 0x230000
  s_add_u32 m0, s41, 6144
  s_nop 0
  buffer_load_dwordx4 v1, s[32:35], s42 offen lds
  s_add_u32 s42, s40, 0x238000
  s_add_u32 m0, s41, 7168
  s_nop 0
  buffer_load_dwordx4 v1, s[32:35], s42 offen lds
  ds_read_b64_tr_b16 v[128:129], v4 offset:32768
  ds_read_b64_tr_b16 v[130:131], v4 offset:33792
  ds_read_b64_tr_b16 v[132:133], v4 offset:36864
  ds_read_b64_tr_b16 v[134:135], v4 offset:37888
  ds_read_b64_tr_b16 v[136:137], v4 offset:40960
  ds_read_b64_tr_b16 v[138:139], v4 offset:41984
  ds_read_b64_tr_b16 v[140:141], v4 offset:45056
  ds_read_b64_tr_b16 v[142:143], v4 offset:46080
  ds_read_b64_tr_b16 v[144:145], v4 offset:49152
  ds_read_b64_tr_b16 v[146:147], v4 offset:50176
  ds_read_b64_tr_b16 v[148:149], v4 offset:53248
  ds_read_b64_tr_b16 v[150:151], v4 offset:54272
  ds_read_b64_tr_b16 v[152:153], v4 offset:57344
  ds_read_b64_tr_b16 v[154:155], v4 offset:58368
  ds_read_b64_tr_b16 v[156:157], v4 offset:61440
  ds_read_b64_tr_b16 v[158:159], v4 offset:62464
  s_waitcnt vmcnt(8)
  s_waitcnt lgkmcnt(0)
  s_barrier
  s_add_u32 s42, s40, 0x300000
  s_add_u32 m0, s41, 32768
  s_nop 0
  buffer_load_dwordx4 v1, s[32:35], s42 offen lds
  s_add_u32 s42, s40, 0x308000
  s_add_u32 m0, s41, 33792
  s_nop 0
  buffer_load_dwordx4 v1, s[32:35], s42 offen lds
  s_add_u32 s42, s40, 0x310000
  s_add_u32 m0, s41, 34816
  s_nop 0
  buffer_load_dwordx4 v1, s[32:35], s42 offen lds
  s_add_u32 s42, s40, 0x318000
  s_add_u32 m0, s41, 35840
  s_nop 0
  buffer_load_dwordx4 v1, s[32:35], s42 offen lds
  s_add_u32 s42, s40, 0x320000
  s_add_u32 m0, s41, 36864
  s_nop 0
  buffer_load_dwordx4 v1, s[32:35], s42 offen lds
  s_add_u32 s42, s40, 0x328000
  s_add_u32 m0, s41, 37888
  s_nop 0
  buffer_load_dwordx4 v1, s[32:35], s42 offen lds
  s_add_u32 s42, s40, 0x330000
  s_add_u32 m0, s41, 38912
  s_nop 0
  buffer_load_dwordx4 v1, s[32:35], s42 offen lds
  s_add_u32 s42, s40, 0x338000
  s_add_u32 m0, s41, 39936
  s_nop 0
  buffer_load_dwordx4 v1, s[32:35], s42 offen lds
  v_and_b32 v21, 63, v0
  v_lshlrev_b32 v21, 2, v21
  buffer_load_dword v20, v21, s[8:11], 0 offen sc1
  ds_read_b64_tr_b16 v[160:161], v5 offset:0
  ds_read_b64_tr_b16 v[162:163], v5 offset:1024
  ds_read_b64_tr_b16 v[164:165], v5 offset:4096
  ds_read_b64_tr_b16 v[166:167], v5 offset:5120
  ds_read_b64_tr_b16 v[168:169], v5 offset:8192
  ds_read_b64_tr_b16 v[170:171], v5 offset:9216
  ds_read_b64_tr_b16 v[172:173], v5 offset:12288
  ds_read_b64_tr_b16 v[174:175], v5 offset:13312
  ds_read_b64_tr_b16 v[176:177], v5 offset:16384
  ds_read_b64_tr_b16 v[178:179], v5 offset:17408
  ds_read_b64_tr_b16 v[180:181], v5 offset:20480
  ds_read_b64_tr_b16 v[182:183], v5 offset:21504
  ds_read_b64_tr_b16 v[184:185], v5 offset:24576
  ds_read_b64_tr_b16 v[186:187], v5 offset:25600
  ds_read_b64_tr_b16 v[188:189], v5 offset:28672
  ds_read_b64_tr_b16 v[190:191], v5 offset:29696
  s_waitcnt vmcnt(9)
  s_waitcnt lgkmcnt(0)
  s_barrier
  s_add_u32 s42, s40, 0x0
  s_add_u32 m0, s41, 65536
  s_nop 0
  buffer_load_dwordx4 v1, s[24:27], s42 offen lds
  s_add_u32 s42, s40, 0x8000
  s_add_u32 m0, s41, 66560
  s_nop 0
  buffer_load_dwordx4 v1, s[24:27], s42 offen lds
  s_add_u32 s42, s40, 0x10000
  s_add_u32 m0, s41, 67584
  s_nop 0
  buffer_load_dwordx4 v1, s[24:27], s42 offen lds
  s_add_u32 s42, s40, 0x18000
  s_add_u32 m0, s41, 68608
  s_nop 0
  buffer_load_dwordx4 v1, s[24:27], s42 offen lds
  s_add_u32 s42, s40, 0x20000
  s_add_u32 m0, s41, 69632
  s_nop 0
  buffer_load_dwordx4 v1, s[24:27], s42 offen lds
  s_add_u32 s42, s40, 0x28000
  s_add_u32 m0, s41, 70656
  s_nop 0
  buffer_load_dwordx4 v1, s[24:27], s42 offen lds
  s_add_u32 s42, s40, 0x30000
  s_add_u32 m0, s41, 71680
  s_nop 0
  buffer_load_dwordx4 v1, s[24:27], s42 offen lds
  s_add_u32 s42, s40, 0x38000
  s_add_u32 m0, s41, 72704
  s_nop 0
  buffer_load_dwordx4 v1, s[24:27], s42 offen lds
  ds_read_b64_tr_b16 v[192:193], v4 offset:0
  ds_read_b64_tr_b16 v[194:195], v4 offset:1024
  ds_read_b64_tr_b16 v[196:197], v4 offset:4096
  ds_read_b64_tr_b16 v[198:199], v4 offset:5120
  ds_read_b64_tr_b16 v[200:201], v4 offset:8192
  ds_read_b64_tr_b16 v[202:203], v4 offset:9216
  ds_read_b64_tr_b16 v[204:205], v4 offset:12288
  ds_read_b64_tr_b16 v[206:207], v4 offset:13312
  ds_read_b64_tr_b16 v[208:209], v4 offset:16384
  ds_read_b64_tr_b16 v[210:211], v4 offset:17408
  ds_read_b64_tr_b16 v[212:213], v4 offset:20480
  ds_read_b64_tr_b16 v[214:215], v4 offset:21504
  ds_read_b64_tr_b16 v[216:217], v4 offset:24576
  ds_read_b64_tr_b16 v[218:219], v4 offset:25600
  ds_read_b64_tr_b16 v[220:221], v4 offset:28672
  ds_read_b64_tr_b16 v[222:223], v4 offset:29696
  s_waitcnt vmcnt(9)
  s_waitcnt lgkmcnt(0)
  s_barrier
  s_add_u32 s42, s40, 0x100000
  s_add_u32 m0, s41, 0
  s_nop 0
  buffer_load_dwordx4 v1, s[24:27], s42 offen lds
  s_add_u32 s42, s40, 0x108000
  s_add_u32 m0, s41, 1024
  s_nop 0
  buffer_load_dwordx4 v1, s[24:27], s42 offen lds
  s_add_u32 s42, s40, 0x110000
  s_add_u32 m0, s41, 2048
  s_nop 0
  buffer_load_dwordx4 v1, s[24:27], s42 offen lds
  s_add_u32 s42, s40, 0x118000
  s_add_u32 m0, s41, 3072
  s_nop 0
  buffer_load_dwordx4 v1, s[24:27], s42 offen lds
  s_add_u32 s42, s40, 0x120000
  s_add_u32 m0, s41, 4096
  s_nop 0
  buffer_load_dwordx4 v1, s[24:27], s42 offen lds
  s_add_u32 s42, s40, 0x128000
  s_add_u32 m0, s41, 5120
  s_nop 0
  buffer_load_dwordx4 v1, s[24:27], s42 offen lds
  s_add_u32 s42, s40, 0x130000
  s_add_u32 m0, s41, 6144
  s_nop 0
  buffer_load_dwordx4 v1, s[24:27], s42 offen lds
  s_add_u32 s42, s40, 0x138000
  s_add_u32 m0, s41, 7168
  s_nop 0
  buffer_load_dwordx4 v1, s[24:27], s42 offen lds
  ds_read_b64_tr_b16 v[224:225], v4 offset:32768
  ds_read_b64_tr_b16 v[226:227], v4 offset:33792
  ds_read_b64_tr_b16 v[228:229], v4 offset:36864
  ds_read_b64_tr_b16 v[230:231], v4 offset:37888
  ds_read_b64_tr_b16 v[232:233], v4 offset:40960
  ds_read_b64_tr_b16 v[234:235], v4 offset:41984
  ds_read_b64_tr_b16 v[236:237], v4 offset:45056
  ds_read_b64_tr_b16 v[238:239], v4 offset:46080
  ds_read_b64_tr_b16 v[240:241], v4 offset:49152
  ds_read_b64_tr_b16 v[242:243], v4 offset:50176
  ds_read_b64_tr_b16 v[244:245], v4 offset:53248
  ds_read_b64_tr_b16 v[246:247], v4 offset:54272
  ds_read_b64_tr_b16 v[248:249], v4 offset:57344
  ds_read_b64_tr_b16 v[250:251], v4 offset:58368
  ds_read_b64_tr_b16 v[252:253], v4 offset:61440
  ds_read_b64_tr_b16 v[254:255], v4 offset:62464
  s_waitcnt vmcnt(8)
  s_waitcnt lgkmcnt(0)
  s_barrier
  s_add_u32 s42, s40, 0x200000
  s_add_u32 m0, s41, 32768
  s_nop 0
  buffer_load_dwordx4 v1, s[24:27], s42 offen lds
  s_add_u32 s42, s40, 0x208000
  s_add_u32 m0, s41, 33792
  s_nop 0
  buffer_load_dwordx4 v1, s[24:27], s42 offen lds
  s_add_u32 s42, s40, 0x210000
  s_add_u32 m0, s41, 34816
  s_nop 0
  buffer_load_dwordx4 v1, s[24:27], s42 offen lds
  s_add_u32 s42, s40, 0x218000
  s_add_u32 m0, s41, 35840
  s_nop 0
  buffer_load_dwordx4 v1, s[24:27], s42 offen lds
  s_add_u32 s42, s40, 0x220000
  s_add_u32 m0, s41, 36864
  s_nop 0
  buffer_load_dwordx4 v1, s[24:27], s42 offen lds
  s_add_u32 s42, s40, 0x228000
  s_add_u32 m0, s41, 37888
  s_nop 0
  buffer_load_dwordx4 v1, s[24:27], s42 offen lds
  s_add_u32 s42, s40, 0x230000
  s_add_u32 m0, s41, 38912
  s_nop 0
  buffer_load_dwordx4 v1, s[24:27], s42 offen lds
  s_add_u32 s42, s40, 0x238000
  s_add_u32 m0, s41, 39936
  s_nop 0
  buffer_load_dwordx4 v1, s[24:27], s42 offen lds
  v_add_u32 v7, 99328, v7
  ds_read_b128 v[80:83], v7 offset:0
  ds_read_b128 v[84:87], v7 offset:32
  ds_read_b128 v[88:91], v7 offset:64
  ds_read_b128 v[92:95], v7 offset:96
  s_waitcnt lgkmcnt(3)
  v_mfma_f32_32x32x16_bf16 v[48:63], a[128:131], v[80:83], 0
  ds_read_b128 v[96:99], v7 offset:128
  v_mfma_f32_32x32x16_bf16 v[64:79], v[80:83], v[128:131], 0
  s_waitcnt lgkmcnt(3)
  v_mfma_f32_32x32x16_bf16 v[48:63], a[132:135], v[84:87], v[48:63]
  ds_read_b128 v[100:103], v7 offset:160
  v_mfma_f32_32x32x16_bf16 v[64:79], v[84:87], v[132:135], v[64:79]
  s_waitcnt lgkmcnt(3)
  v_mfma_f32_32x32x16_bf16 v[48:63], a[136:139], v[88:91], v[48:63]
  ds_read_b128 v[104:107], v7 offset:192
  v_mfma_f32_32x32x16_bf16 v[64:79], v[88:91], v[136:139], v[64:79]
  s_waitcnt lgkmcnt(3)
  v_mfma_f32_32x32x16_bf16 v[48:63], a[140:143], v[92:95], v[48:63]
  ds_read_b128 v[108:111], v7 offset:224
  v_mfma_f32_32x32x16_bf16 v[64:79], v[92:95], v[140:143], v[64:79]
  s_waitcnt lgkmcnt(3)
  v_mfma_f32_32x32x16_bf16 v[48:63], a[144:147], v[96:99], v[48:63]
  ds_read_b128 v[80:83], v7 offset:256
  v_mfma_f32_32x32x16_bf16 v[64:79], v[96:99], v[144:147], v[64:79]
  s_waitcnt lgkmcnt(3)
  v_mfma_f32_32x32x16_bf16 v[48:63], a[148:151], v[100:103], v[48:63]
  ds_read_b128 v[84:87], v7 offset:288
  v_mfma_f32_32x32x16_bf16 v[64:79], v[100:103], v[148:151], v[64:79]
  s_waitcnt lgkmcnt(3)
  v_mfma_f32_32x32x16_bf16 v[48:63], a[152:155], v[104:107], v[48:63]
  ds_read_b128 v[88:91], v7 offset:320
  v_mfma_f32_32x32x16_bf16 v[64:79], v[104:107], v[152:155], v[64:79]
  s_waitcnt lgkmcnt(3)
  v_mfma_f32_32x32x16_bf16 v[48:63], a[156:159], v[108:111], v[48:63]
  ds_read_b128 v[92:95], v7 offset:352
  v_mfma_f32_32x32x16_bf16 v[64:79], v[108:111], v[156:159], v[64:79]
  s_waitcnt lgkmcnt(3)
  v_mfma_f32_32x32x16_bf16 v[48:63], a[160:163], v[80:83], v[48:63]
  ds_read_b128 v[96:99], v7 offset:384
  v_mfma_f32_32x32x16_bf16 v[64:79], v[80:83], v[160:163], v[64:79]
  s_waitcnt lgkmcnt(3)
  v_mfma_f32_32x32x16_bf16 v[48:63], a[164:167], v[84:87], v[48:63]
  ds_read_b128 v[100:103], v7 offset:416
  v_mfma_f32_32x32x16_bf16 v[64:79], v[84:87], v[164:167], v[64:79]
  s_waitcnt lgkmcnt(3)
  v_mfma_f32_32x32x16_bf16 v[48:63], a[168:171], v[88:91], v[48:63]
  ds_read_b128 v[104:107], v7 offset:448
  v_mfma_f32_32x32x16_bf16 v[64:79], v[88:91], v[168:171], v[64:79]
  s_waitcnt lgkmcnt(3)
  v_mfma_f32_32x32x16_bf16 v[48:63], a[172:175], v[92:95], v[48:63]
  ds_read_b128 v[108:111], v7 offset:480
  v_mfma_f32_32x32x16_bf16 v[64:79], v[92:95], v[172:175], v[64:79]
  s_waitcnt lgkmcnt(3)
  v_mfma_f32_32x32x16_bf16 v[48:63], a[176:179], v[96:99], v[48:63]
  ds_read_b128 v[80:83], v7 offset:512
  v_mfma_f32_32x32x16_bf16 v[64:79], v[96:99], v[176:179], v[64:79]
  s_waitcnt lgkmcnt(3)
  v_mfma_f32_32x32x16_bf16 v[48:63], a[180:183], v[100:103], v[48:63]
  ds_read_b128 v[84:87], v7 offset:544
  v_mfma_f32_32x32x16_bf16 v[64:79], v[100:103], v[180:183], v[64:79]
  s_waitcnt lgkmcnt(3)
  v_mfma_f32_32x32x16_bf16 v[48:63], a[184:187], v[104:107], v[48:63]
  ds_read_b128 v[88:91], v7 offset:576
  v_mfma_f32_32x32x16_bf16 v[64:79], v[104:107], v[184:187], v[64:79]
  s_waitcnt lgkmcnt(3)
  v_mfma_f32_32x32x16_bf16 v[48:63], a[188:191], v[108:111], v[48:63]
  ds_read_b128 v[92:95], v7 offset:608
  v_mfma_f32_32x32x16_bf16 v[64:79], v[108:111], v[188:191], v[64:79]
  s_waitcnt lgkmcnt(3)
  v_mfma_f32_32x32x16_bf16 v[48:63], a[192:195], v[80:83], v[48:63]
  ds_read_b128 v[96:99], v7 offset:640
  v_mfma_f32_32x32x16_bf16 v[64:79], v[80:83], v[192:195], v[64:79]
  s_waitcnt lgkmcnt(3)
  v_mfma_f32_32x32x16_bf16 v[48:63], a[196:199], v[84:87], v[48:63]
  ds_read_b128 v[100:103], v7 offset:672
  v_mfma_f32_32x32x16_bf16 v[64:79], v[84:87], v[196:199], v[64:79]
  s_waitcnt lgkmcnt(3)
  v_mfma_f32_32x32x16_bf16 v[48:63], a[200:203], v[88:91], v[48:63]
  ds_read_b128 v[104:107], v7 offset:704
  v_mfma_f32_32x32x16_bf16 v[64:79], v[88:91], v[200:203], v[64:79]
  s_waitcnt lgkmcnt(3)
  v_mfma_f32_32x32x16_bf16 v[48:63], a[204:207], v[92:95], v[48:63]
  ds_read_b128 v[108:111], v7 offset:736
  v_mfma_f32_32x32x16_bf16 v[64:79], v[92:95], v[204:207], v[64:79]
  s_waitcnt lgkmcnt(3)
  v_mfma_f32_32x32x16_bf16 v[48:63], a[208:211], v[96:99], v[48:63]
  ds_read_b128 v[80:83], v7 offset:768
  v_mfma_f32_32x32x16_bf16 v[64:79], v[96:99], v[208:211], v[64:79]
  s_waitcnt lgkmcnt(3)
  v_mfma_f32_32x32x16_bf16 v[48:63], a[212:215], v[100:103], v[48:63]
  ds_read_b128 v[84:87], v7 offset:800
  v_mfma_f32_32x32x16_bf16 v[64:79], v[100:103], v[212:215], v[64:79]
  s_waitcnt lgkmcnt(3)
  v_mfma_f32_32x32x16_bf16 v[48:63], a[216:219], v[104:107], v[48:63]
  ds_read_b128 v[88:91], v7 offset:832
  v_mfma_f32_32x32x16_bf16 v[64:79], v[104:107], v[216:219], v[64:79]
  s_waitcnt lgkmcnt(3)
  v_mfma_f32_32x32x16_bf16 v[48:63], a[220:223], v[108:111], v[48:63]
  ds_read_b128 v[92:95], v7 offset:864
  v_mfma_f32_32x32x16_bf16 v[64:79], v[108:111], v[220:223], v[64:79]
  s_waitcnt lgkmcnt(3)
  v_mfma_f32_32x32x16_bf16 v[48:63], a[224:227], v[80:83], v[48:63]
  ds_read_b128 v[96:99], v7 offset:896
  v_mfma_f32_32x32x16_bf16 v[64:79], v[80:83], v[224:227], v[64:79]
  s_waitcnt lgkmcnt(3)
  v_mfma_f32_32x32x16_bf16 v[48:63], a[228:231], v[84:87], v[48:63]
  ds_read_b128 v[100:103], v7 offset:928
  v_mfma_f32_32x32x16_bf16 v[64:79], v[84:87], v[228:231], v[64:79]
  s_waitcnt lgkmcnt(3)
  v_mfma_f32_32x32x16_bf16 v[48:63], a[232:235], v[88:91], v[48:63]
  ds_read_b128 v[104:107], v7 offset:960
  v_mfma_f32_32x32x16_bf16 v[64:79], v[88:91], v[232:235], v[64:79]
  s_waitcnt lgkmcnt(3)
  v_mfma_f32_32x32x16_bf16 v[48:63], a[236:239], v[92:95], v[48:63]
  ds_read_b128 v[108:111], v7 offset:992
  v_mfma_f32_32x32x16_bf16 v[64:79], v[92:95], v[236:239], v[64:79]
  s_waitcnt lgkmcnt(3)
  v_mfma_f32_32x32x16_bf16 v[48:63], a[240:243], v[96:99], v[48:63]
  v_mfma_f32_32x32x16_bf16 v[64:79], v[96:99], v[240:243], v[64:79]
  s_waitcnt lgkmcnt(2)
  v_mfma_f32_32x32x16_bf16 v[48:63], a[244:247], v[100:103], v[48:63]
  v_mfma_f32_32x32x16_bf16 v[64:79], v[100:103], v[244:247], v[64:79]
  s_waitcnt lgkmcnt(1)
  v_mfma_f32_32x32x16_bf16 v[48:63], a[248:251], v[104:107], v[48:63]
  v_mfma_f32_32x32x16_bf16 v[64:79], v[104:107], v[248:251], v[64:79]
  s_waitcnt lgkmcnt(0)
  v_mfma_f32_32x32x16_bf16 v[48:63], a[252:255], v[108:111], v[48:63]
  v_mfma_f32_32x32x16_bf16 v[64:79], v[108:111], v[252:255], v[64:79]
  s_cmp_lg_u32 s21, 0
  s_cbranch_scc1 L_e3_ok_146
  v_readlane_b32 s43, v20, 8
  v_readlane_b32 s17, v20, 36
  s_add_u32 s43, s43, s17
  v_readlane_b32 s17, v20, 37
  s_add_u32 s43, s43, s17
  v_readlane_b32 s17, v20, 38
  s_add_u32 s43, s43, s17
  v_readlane_b32 s17, v20, 39
  s_add_u32 s43, s43, s17
  s_cmp_lt_u32 s43, 256
  s_cbranch_scc1 L_e3_slow_147
  v_cmp_ne_u32 vcc, 32, v20
  s_and_b32 s43, vcc_hi, 0xfe
  s_and_b32 vcc_lo, vcc_lo, 1
  s_or_b32 s43, s43, vcc_lo
  s_cmp_eq_u32 s43, 0
  s_cbranch_scc1 L_e3_ok_146
L_e3_slow_147:
  s_cmp_lg_u32 s21, 0
  s_cbranch_scc1 L_mode_ok_148
  s_mov_b32 s15, 200000
  v_and_b32 v21, 63, v0
  v_lshlrev_b32 v21, 2, v21
L_rdy_top_149:
  buffer_load_dword v20, v21, s[8:11], 0 offen sc1
  s_waitcnt vmcnt(0)
  v_readlane_b32 s16, v20, 8
  v_readlane_b32 s17, v20, 36
  s_add_u32 s16, s16, s17
  v_readlane_b32 s17, v20, 37
  s_add_u32 s16, s16, s17
  v_readlane_b32 s17, v20, 38
  s_add_u32 s16, s16, s17
  v_readlane_b32 s17, v20, 39
  s_add_u32 s16, s16, s17
  s_cmp_ge_u32 s16, 256
  s_cbranch_scc1 L_rdy_out_150
  s_sub_u32 s15, s15, 1
  s_cmp_lg_u32 s15, 0
  s_cbranch_scc1 L_rdy_top_149
L_rdy_out_150:
  buffer_load_dword v20, v21, s[8:11], 0 offen sc1
  s_waitcnt vmcnt(0)
  v_cmp_ne_u32 vcc, 32, v20
  s_and_b32 s15, vcc_hi, 0xfe
  s_and_b32 vcc_lo, vcc_lo, 1
  s_or_b32 s15, s15, vcc_lo
  s_cmp_lg_u32 s15, 0
  s_cbranch_scc1 L_fallback
L_mode_ok_148:
L_e3_ok_146:
  s_lshl_b32 s42, s45, 5
  s_add_u32 s42, s42, s44
  s_lshl_b32 s42, s42, 13
  s_add_u32 s52, s42, 0x0
  s_add_u32 s53, s42, 0x1000000
  s_lshl_b32 s42, s44, 8
  s_lshl_b32 s43, s45, 2
  s_add_u32 s42, s42, s43
  s_add_u32 s50, s42, 0x4000000
  v_cvt_pk_bf16_f32 v48, v48, v49
  v_cvt_pk_bf16_f32 v49, v50, v51
  v_cvt_pk_bf16_f32 v50, v52, v53
  v_cvt_pk_bf16_f32 v51, v54, v55
  v_cvt_pk_bf16_f32 v52, v56, v57
  v_cvt_pk_bf16_f32 v53, v58, v59
  v_cvt_pk_bf16_f32 v54, v60, v61
  v_cvt_pk_bf16_f32 v55, v62, v63
  buffer_store_dwordx4 v[48:51], v8, s[4:7], s52 offen offset:0 sc1
  buffer_store_dwordx4 v[52:55], v8, s[4:7], s52 offen offset:1024 sc1
  v_cvt_pk_bf16_f32 v64, v64, v65
  v_cvt_pk_bf16_f32 v65, v66, v67
  v_cvt_pk_bf16_f32 v66, v68, v69
  v_cvt_pk_bf16_f32 v67, v70, v71
  v_cvt_pk_bf16_f32 v68, v72, v73
  v_cvt_pk_bf16_f32 v69, v74, v75
  v_cvt_pk_bf16_f32 v70, v76, v77
  v_cvt_pk_bf16_f32 v71, v78, v79
  buffer_store_dwordx4 v[64:67], v9, s[4:7], s53 offen offset:0 sc1
  buffer_store_dwordx4 v[68:71], v9, s[4:7], s53 offen offset:1024 sc1
  ds_read_b64_tr_b16 a[0:1], v3 offset:0
  ds_read_b64_tr_b16 a[2:3], v3 offset:1024
  ds_read_b64_tr_b16 a[4:5], v3 offset:4096
  ds_read_b64_tr_b16 a[6:7], v3 offset:5120
  ds_read_b64_tr_b16 a[8:9], v3 offset:8192
  ds_read_b64_tr_b16 a[10:11], v3 offset:9216
  ds_read_b64_tr_b16 a[12:13], v3 offset:12288
  ds_read_b64_tr_b16 a[14:15], v3 offset:13312
  ds_read_b64_tr_b16 a[16:17], v3 offset:16384
  ds_read_b64_tr_b16 a[18:19], v3 offset:17408
  ds_read_b64_tr_b16 a[20:21], v3 offset:20480
  ds_read_b64_tr_b16 a[22:23], v3 offset:21504
  ds_read_b64_tr_b16 a[24:25], v3 offset:24576
  ds_read_b64_tr_b16 a[26:27], v3 offset:25600
  ds_read_b64_tr_b16 a[28:29], v3 offset:28672
  ds_read_b64_tr_b16 a[30:31], v3 offset:29696
  s_waitcnt vmcnt(12)
  s_waitcnt lgkmcnt(0)
  s_barrier
  s_add_u32 s42, s40, 0x300000
  s_add_u32 m0, s41, 65536
  s_nop 0
  buffer_load_dwordx4 v1, s[24:27], s42 offen lds
  s_add_u32 s42, s40, 0x308000
  s_add_u32 m0, s41, 66560
  s_nop 0
  buffer_load_dwordx4 v1, s[24:27], s42 offen lds
  s_add_u32 s42, s40, 0x310000
  s_add_u32 m0, s41, 67584
  s_nop 0
  buffer_load_dwordx4 v1, s[24:27], s42 offen lds
  s_add_u32 s42, s40, 0x318000
  s_add_u32 m0, s41, 68608
  s_nop 0
  buffer_load_dwordx4 v1, s[24:27], s42 offen lds
  s_add_u32 s42, s40, 0x320000
  s_add_u32 m0, s41, 69632
  s_nop 0
  buffer_load_dwordx4 v1, s[24:27], s42 offen lds
  s_add_u32 s42, s40, 0x328000
  s_add_u32 m0, s41, 70656
  s_nop 0
  buffer_load_dwordx4 v1, s[24:27], s42 offen lds
  s_add_u32 s42, s40, 0x330000
  s_add_u32 m0, s41, 71680
  s_nop 0
  buffer_load_dwordx4 v1, s[24:27], s42 offen lds
  s_add_u32 s42, s40, 0x338000
  s_add_u32 m0, s41, 72704
  s_nop 0
  buffer_load_dwordx4 v1, s[24:27], s42 offen lds
  ds_read_b64_tr_b16 a[32:33], v2 offset:0
  ds_read_b64_tr_b16 a[34:35], v2 offset:1024
  ds_read_b64_tr_b16 a[36:37], v2 offset:4096
  ds_read_b64_tr_b16 a[38:39], v2 offset:5120
  ds_read_b64_tr_b16 a[40:41], v2 offset:8192
  ds_read_b64_tr_b16 a[42:43], v2 offset:9216
  ds_read_b64_tr_b16 a[44:45], v2 offset:12288
  ds_read_b64_tr_b16 a[46:47], v2 offset:13312
  ds_read_b64_tr_b16 a[48:49], v2 offset:16384
  ds_read_b64_tr_b16 a[50:51], v2 offset:17408
  ds_read_b64_tr_b16 a[52:53], v2 offset:20480
  ds_read_b64_tr_b16 a[54:55], v2 offset:21504
  ds_read_b64_tr_b16 a[56:57], v2 offset:24576
  ds_read_b64_tr_b16 a[58:59], v2 offset:25600
  ds_read_b64_tr_b16 a[60:61], v2 offset:28672
  ds_read_b64_tr_b16 a[62:63], v2 offset:29696
  s_waitcnt vmcnt(12)
  s_waitcnt lgkmcnt(0)
  s_barrier
  s_waitcnt vmcnt(8)
  buffer_atomic_add v11, v10, s[4:7], s50 offen sc1
  ds_read_b64_tr_b16 a[64:65], v2 offset:32768
  ds_read_b64_tr_b16 a[66:67], v2 offset:33792
  ds_read_b64_tr_b16 a[68:69], v2 offset:36864
  ds_read_b64_tr_b16 a[70:71], v2 offset:37888
  ds_read_b64_tr_b16 a[72:73], v2 offset:40960
  ds_read_b64_tr_b16 a[74:75], v2 offset:41984
  ds_read_b64_tr_b16 a[76:77], v2 offset:45056
  ds_read_b64_tr_b16 a[78:79], v2 offset:46080
  ds_read_b64_tr_b16 a[80:81], v2 offset:49152
  ds_read_b64_tr_b16 a[82:83], v2 offset:50176
  ds_read_b64_tr_b16 a[84:85], v2 offset:53248
  ds_read_b64_tr_b16 a[86:87], v2 offset:54272
  ds_read_b64_tr_b16 a[88:89], v2 offset:57344
  ds_read_b64_tr_b16 a[90:91], v2 offset:58368
  ds_read_b64_tr_b16 a[92:93], v2 offset:61440
  ds_read_b64_tr_b16 a[94:95], v2 offset:62464
  s_waitcnt vmcnt(1)
  s_waitcnt lgkmcnt(0)
  s_barrier
  ds_read_b64_tr_b16 a[96:97], v3 offset:0
  ds_read_b64_tr_b16 a[98:99], v3 offset:1024
  ds_read_b64_tr_b16 a[100:101], v3 offset:4096
  ds_read_b64_tr_b16 a[102:103], v3 offset:5120
  ds_read_b64_tr_b16 a[104:105], v3 offset:8192
  ds_read_b64_tr_b16 a[106:107], v3 offset:9216
  ds_read_b64_tr_b16 a[108:109], v3 offset:12288
  ds_read_b64_tr_b16 a[110:111], v3 offset:13312
  ds_read_b64_tr_b16 a[112:113], v3 offset:16384
  ds_read_b64_tr_b16 a[114:115], v3 offset:17408
  ds_read_b64_tr_b16 a[116:117], v3 offset:20480
  ds_read_b64_tr_b16 a[118:119], v3 offset:21504
  ds_read_b64_tr_b16 a[120:121], v3 offset:24576
  ds_read_b64_tr_b16 a[122:123], v3 offset:25600
  ds_read_b64_tr_b16 a[124:125], v3 offset:28672
  ds_read_b64_tr_b16 a[126:127], v3 offset:29696
  s_waitcnt lgkmcnt(0)
  s_mov_b32 s46, s45
  s_cmp_eq_u32 s45, 0
  s_cselect_b32 s54, 22, 21
  v_mov_b32 v23, v10
  s_mov_b32 s49, -99328
  v_mov_b32 v15, 0x40000000
  s_barrier
  s_add_u32 s48, s48, s49
  s_add_u32 s43, s46, 3
  s_min_u32 s43, s43, 63
  s_lshl_b32 s47, s43, 15
  s_lshl_b32 s43, s14, 13
  s_add_u32 s47, s47, s43
  s_add_u32 m0, s48, 0
  s_nop 0
  buffer_load_dwordx4 v6, s[36:39], s47 offen offset:0 lds
  s_add_u32 m0, s48, 16
  s_nop 0
  buffer_load_dwordx4 v6, s[36:39], s47 offen offset:1024 lds
  s_add_u32 m0, s48, 32
  s_nop 0
  buffer_load_dwordx4 v6, s[36:39], s47 offen offset:2048 lds
  s_add_u32 m0, s48, 48
  s_nop 0
  buffer_load_dwordx4 v6, s[36:39], s47 offen offset:3072 lds
  s_add_u32 s42, s47, 4096
  s_add_u32 m0, s48, 4160
  s_nop 0
  buffer_load_dwordx4 v6, s[36:39], s42 offen offset:0 lds
  s_add_u32 m0, s48, 4176
  s_nop 0
  buffer_load_dwordx4 v6, s[36:39], s42 offen offset:1024 lds
  s_add_u32 m0, s48, 4192
  s_nop 0
  buffer_load_dwordx4 v6, s[36:39], s42 offen offset:2048 lds
  s_add_u32 m0, s48, 4208
  s_nop 0
  buffer_load_dwordx4 v6, s[36:39], s42 offen offset:3072 lds
  s_lshl_b32 s42, s46, 5
  s_add_u32 s42, s42, s44
  s_lshl_b32 s42, s42, 13
  s_add_u32 s51, s42, 0x5000000
  s_lshl_b32 s42, s44, 8
  s_lshl_b32 s43, s46, 2
  s_add_u32 s42, s42, s43
  s_add_u32 s50, s42, 0x4000000
  ds_read_b128 v[80:83], v7 offset:0
  ds_read_b128 v[84:87], v7 offset:32
  ds_read_b128 v[88:91], v7 offset:64
  s_waitcnt lgkmcnt(2)
  v_mfma_f32_32x32x16_bf16 v[32:47], a[0:3], v[80:83], 0
  ds_read_b128 v[92:95], v7 offset:96
  s_waitcnt lgkmcnt(2)
  v_mfma_f32_32x32x16_bf16 v[32:47], a[4:7], v[84:87], v[32:47]
  ds_read_b128 v[96:99], v7 offset:128
  s_waitcnt lgkmcnt(2)
  v_mfma_f32_32x32x16_bf16 v[32:47], a[8:11], v[88:91], v[32:47]
  ds_read_b128 v[100:103], v7 offset:160
  s_waitcnt lgkmcnt(2)
  v_mfma_f32_32x32x16_bf16 v[32:47], a[12:15], v[92:95], v[32:47]
  ds_read_b128 v[104:107], v7 offset:192
  s_waitcnt lgkmcnt(2)
  v_mfma_f32_32x32x16_bf16 v[32:47], a[16:19], v[96:99], v[32:47]
  ds_read_b128 v[108:111], v7 offset:224
  s_waitcnt lgkmcnt(2)
  v_mfma_f32_32x32x16_bf16 v[32:47], a[20:23], v[100:103], v[32:47]
  ds_read_b128 v[80:83], v7 offset:256
  s_waitcnt lgkmcnt(2)
  v_mfma_f32_32x32x16_bf16 v[32:47], a[24:27], v[104:107], v[32:47]
  ds_read_b128 v[84:87], v7 offset:288
  s_waitcnt lgkmcnt(2)
  v_mfma_f32_32x32x16_bf16 v[32:47], a[28:31], v[108:111], v[32:47]
  ds_read_b128 v[88:91], v7 offset:320
  s_waitcnt lgkmcnt(2)
  v_mfma_f32_32x32x16_bf16 v[32:47], a[32:35], v[80:83], v[32:47]
  ds_read_b128 v[92:95], v7 offset:352
  s_waitcnt lgkmcnt(2)
  v_mfma_f32_32x32x16_bf16 v[32:47], a[36:39], v[84:87], v[32:47]
  ds_read_b128 v[96:99], v7 offset:384
  s_waitcnt lgkmcnt(2)
  v_mfma_f32_32x32x16_bf16 v[32:47], a[40:43], v[88:91], v[32:47]
  ds_read_b128 v[100:103], v7 offset:416
  s_waitcnt lgkmcnt(2)
  v_mfma_f32_32x32x16_bf16 v[32:47], a[44:47], v[92:95], v[32:47]
  ds_read_b128 v[104:107], v7 offset:448
  s_waitcnt lgkmcnt(2)
  v_mfma_f32_32x32x16_bf16 v[32:47], a[48:51], v[96:99], v[32:47]
  ds_read_b128 v[108:111], v7 offset:480
  s_waitcnt lgkmcnt(2)
  v_mfma_f32_32x32x16_bf16 v[32:47], a[52:55], v[100:103], v[32:47]
  ds_read_b128 v[80:83], v7 offset:512
  s_waitcnt lgkmcnt(2)
  v_mfma_f32_32x32x16_bf16 v[32:47], a[56:59], v[104:107], v[32:47]
  ds_read_b128 v[84:87], v7 offset:544
  s_waitcnt lgkmcnt(2)
  v_mfma_f32_32x32x16_bf16 v[32:47], a[60:63], v[108:111], v[32:47]
  ds_read_b128 v[88:91], v7 offset:576
  s_waitcnt lgkmcnt(2)
  v_mfma_f32_32x32x16_bf16 v[32:47], a[64:67], v[80:83], v[32:47]
  ds_read_b128 v[92:95], v7 offset:608
  s_waitcnt lgkmcnt(2)
  v_mfma_f32_32x32x16_bf16 v[32:47], a[68:71], v[84:87], v[32:47]
  ds_read_b128 v[96:99], v7 offset:640
  s_waitcnt lgkmcnt(2)
  v_mfma_f32_32x32x16_bf16 v[32:47], a[72:75], v[88:91], v[32:47]
  ds_read_b128 v[100:103], v7 offset:672
  s_waitcnt lgkmcnt(2)
  v_mfma_f32_32x32x16_bf16 v[32:47], a[76:79], v[92:95], v[32:47]
  ds_read_b128 v[104:107], v7 offset:704
  s_waitcnt lgkmcnt(2)
  v_mfma_f32_32x32x16_bf16 v[32:47], a[80:83], v[96:99], v[32:47]
  ds_read_b128 v[108:111], v7 offset:736
  s_waitcnt lgkmcnt(2)
  v_mfma_f32_32x32x16_bf16 v[32:47], a[84:87], v[100:103], v[32:47]
  ds_read_b128 v[80:83], v7 offset:768
  s_waitcnt lgkmcnt(2)
  v_mfma_f32_32x32x16_bf16 v[32:47], a[88:91], v[104:107], v[32:47]
  ds_read_b128 v[84:87], v7 offset:800
  s_waitcnt lgkmcnt(2)
  v_mfma_f32_32x32x16_bf16 v[32:47], a[92:95], v[108:111], v[32:47]
  ds_read_b128 v[88:91], v7 offset:832
  s_waitcnt lgkmcnt(2)
  v_mfma_f32_32x32x16_bf16 v[32:47], a[96:99], v[80:83], v[32:47]
  ds_read_b128 v[92:95], v7 offset:864
  s_waitcnt lgkmcnt(2)
  v_mfma_f32_32x32x16_bf16 v[32:47], a[100:103], v[84:87], v[32:47]
  ds_read_b128 v[96:99], v7 offset:896
  s_waitcnt lgkmcnt(2)
  v_mfma_f32_32x32x16_bf16 v[32:47], a[104:107], v[88:91], v[32:47]
  ds_read_b128 v[100:103], v7 offset:928
  s_waitcnt lgkmcnt(2)
  v_mfma_f32_32x32x16_bf16 v[32:47], a[108:111], v[92:95], v[32:47]
  ds_read_b128 v[104:107], v7 offset:960
  s_waitcnt lgkmcnt(2)
  v_mfma_f32_32x32x16_bf16 v[32:47], a[112:115], v[96:99], v[32:47]
  ds_read_b128 v[108:111], v7 offset:992
  s_waitcnt lgkmcnt(2)
  v_mfma_f32_32x32x16_bf16 v[32:47], a[116:119], v[100:103], v[32:47]
  s_waitcnt lgkmcnt(0)
  s_waitcnt vmcnt(0)
  s_barrier
  v_add_u32 v7, s49, v7
  s_sub_u32 s49, 0, s49
  ds_read_b128 v[80:83], v7 offset:0
  ds_read_b128 v[84:87], v7 offset:32
  ds_read_b128 v[88:91], v7 offset:64
  s_add_u32 s46, s46, 3
  s_sub_u32 s54, s54, 1
L_hp1s_151:
  s_waitcnt lgkmcnt(2)
  v_mfma_f32_32x32x16_bf16 v[48:63], a[128:131], v[80:83], 0
  ds_read_b128 v[92:95], v7 offset:96
  v_cvt_pk_bf16_f32 v64, v64, v65
  v_cvt_pk_bf16_f32 v65, v66, v67
  v_cvt_pk_bf16_f32 v66, v68, v69
  v_cvt_pk_bf16_f32 v67, v70, v71
  v_mfma_f32_32x32x16_bf16 v[32:47], a[120:123], v[104:107], v[32:47]
  v_cvt_pk_bf16_f32 v68, v72, v73
  v_cvt_pk_bf16_f32 v69, v74, v75
  v_cvt_pk_bf16_f32 v70, v76, v77
  v_cvt_pk_bf16_f32 v71, v78, v79
  s_waitcnt lgkmcnt(2)
  v_mfma_f32_32x32x16_bf16 v[48:63], a[132:135], v[84:87], v[48:63]
  ds_read_b128 v[96:99], v7 offset:128
  buffer_store_dwordx4 v[64:67], v15, s[4:7], s53 offen offset:0 sc1
  v_mfma_f32_32x32x16_bf16 v[32:47], a[124:127], v[108:111], v[32:47]
  buffer_store_dwordx4 v[68:71], v15, s[4:7], s53 offen offset:1024 sc1
  v_mov_b32 v15, v9
  s_waitcnt lgkmcnt(2)
  v_mfma_f32_32x32x16_bf16 v[48:63], a[136:139], v[88:91], v[48:63]
  ds_read_b128 v[100:103], v7 offset:160
  v_mfma_f32_32x32x16_bf16 v[64:79], v[80:83], v[128:131], 0
  v_cvt_pk_bf16_f32 v32, v32, v33
  v_cvt_pk_bf16_f32 v33, v34, v35
  v_cvt_pk_bf16_f32 v34, v36, v37
  v_cvt_pk_bf16_f32 v35, v38, v39
  s_waitcnt lgkmcnt(2)
  v_mfma_f32_32x32x16_bf16 v[48:63], a[140:143], v[92:95], v[48:63]
  ds_read_b128 v[104:107], v7 offset:192
  v_cvt_pk_bf16_f32 v36, v40, v41
  v_cvt_pk_bf16_f32 v37, v42, v43
  v_cvt_pk_bf16_f32 v38, v44, v45
  v_cvt_pk_bf16_f32 v39, v46, v47
  v_mfma_f32_32x32x16_bf16 v[64:79], v[84:87], v[132:135], v[64:79]
  buffer_store_dwordx4 v[32:35], v8, s[4:7], s51 offen offset:0 sc1
  s_waitcnt lgkmcnt(2)
  v_mfma_f32_32x32x16_bf16 v[48:63], a[144:147], v[96:99], v[48:63]
  ds_read_b128 v[108:111], v7 offset:224
  buffer_store_dwordx4 v[36:39], v8, s[4:7], s51 offen offset:1024 sc1
  v_mfma_f32_32x32x16_bf16 v[64:79], v[88:91], v[136:139], v[64:79]
  s_add_u32 s48, s48, s49
  s_add_u32 s43, s46, 3
  s_min_u32 s43, s43, 63
  s_lshl_b32 s47, s43, 15
  s_lshl_b32 s43, s14, 13
  s_add_u32 s47, s47, s43
  v_mfma_f32_32x32x16_bf16 v[32:47], a[0:3], v[80:83], 0
  s_waitcnt lgkmcnt(2)
  v_mfma_f32_32x32x16_bf16 v[48:63], a[148:151], v[100:103], v[48:63]
  ds_read_b128 v[80:83], v7 offset:256
  v_mfma_f32_32x32x16_bf16 v[64:79], v[92:95], v[140:143], v[64:79]
  v_mfma_f32_32x32x16_bf16 v[32:47], a[4:7], v[84:87], v[32:47]
  s_waitcnt lgkmcnt(2)
  v_mfma_f32_32x32x16_bf16 v[48:63], a[152:155], v[104:107], v[48:63]
  ds_read_b128 v[84:87], v7 offset:288
  v_mfma_f32_32x32x16_bf16 v[64:79], v[96:99], v[144:147], v[64:79]
  v_mfma_f32_32x32x16_bf16 v[32:47], a[8:11], v[88:91], v[32:47]
  s_waitcnt lgkmcnt(2)
  v_mfma_f32_32x32x16_bf16 v[48:63], a[156:159], v[108:111], v[48:63]
  ds_read_b128 v[88:91], v7 offset:320
  v_mfma_f32_32x32x16_bf16 v[64:79], v[100:103], v[148:151], v[64:79]
  v_mfma_f32_32x32x16_bf16 v[32:47], a[12:15], v[92:95], v[32:47]
  s_waitcnt lgkmcnt(2)
  v_mfma_f32_32x32x16_bf16 v[48:63], a[160:163], v[80:83], v[48:63]
  ds_read_b128 v[92:95], v7 offset:352
  s_add_u32 m0, s48, 0
  s_nop 0
  buffer_load_dwordx4 v6, s[36:39], s47 offen offset:0 lds
  v_mfma_f32_32x32x16_bf16 v[64:79], v[104:107], v[152:155], v[64:79]
  v_mfma_f32_32x32x16_bf16 v[32:47], a[16:19], v[96:99], v[32:47]
  s_waitcnt lgkmcnt(2)
  v_mfma_f32_32x32x16_bf16 v[48:63], a[164:167], v[84:87], v[48:63]
  ds_read_b128 v[96:99], v7 offset:384
  s_add_u32 m0, s48, 16
  s_nop 0
  buffer_load_dwordx4 v6, s[36:39], s47 offen offset:1024 lds
  v_mfma_f32_32x32x16_bf16 v[64:79], v[108:111], v[156:159], v[64:79]
  v_mfma_f32_32x32x16_bf16 v[32:47], a[20:23], v[100:103], v[32:47]
  s_waitcnt lgkmcnt(2)
  v_mfma_f32_32x32x16_bf16 v[48:63], a[168:171], v[88:91], v[48:63]
  ds_read_b128 v[100:103], v7 offset:416
  s_add_u32 m0, s48, 32
  s_nop 0
  buffer_load_dwordx4 v6, s[36:39], s47 offen offset:2048 lds
  v_mfma_f32_32x32x16_bf16 v[64:79], v[80:83], v[160:163], v[64:79]
  v_mfma_f32_32x32x16_bf16 v[32:47], a[24:27], v[104:107], v[32:47]
  s_waitcnt lgkmcnt(2)
  v_mfma_f32_32x32x16_bf16 v[48:63], a[172:175], v[92:95], v[48:63]
  ds_read_b128 v[104:107], v7 offset:448
  s_add_u32 m0, s48, 48
  s_nop 0
  buffer_load_dwordx4 v6, s[36:39], s47 offen offset:3072 lds
  v_mfma_f32_32x32x16_bf16 v[64:79], v[84:87], v[164:167], v[64:79]
  v_mfma_f32_32x32x16_bf16 v[32:47], a[28:31], v[108:111], v[32:47]
  s_waitcnt lgkmcnt(2)
  v_mfma_f32_32x32x16_bf16 v[48:63], a[176:179], v[96:99], v[48:63]
  ds_read_b128 v[108:111], v7 offset:480
  s_add_u32 s47, s47, 4096
  s_add_u32 m0, s48, 4160
  s_nop 0
  buffer_load_dwordx4 v6, s[36:39], s47 offen offset:0 lds
  v_mfma_f32_32x32x16_bf16 v[64:79], v[88:91], v[168:171], v[64:79]
  v_mfma_f32_32x32x16_bf16 v[32:47], a[32:35], v[80:83], v[32:47]
  s_waitcnt lgkmcnt(2)
  v_mfma_f32_32x32x16_bf16 v[48:63], a[180:183], v[100:103], v[48:63]
  ds_read_b128 v[80:83], v7 offset:512
  s_add_u32 m0, s48, 4176
  s_nop 0
  buffer_load_dwordx4 v6, s[36:39], s47 offen offset:1024 lds
  v_mfma_f32_32x32x16_bf16 v[64:79], v[92:95], v[172:175], v[64:79]
  v_mfma_f32_32x32x16_bf16 v[32:47], a[36:39], v[84:87], v[32:47]
  s_waitcnt lgkmcnt(2)
  v_mfma_f32_32x32x16_bf16 v[48:63], a[184:187], v[104:107], v[48:63]
  ds_read_b128 v[84:87], v7 offset:544
  s_add_u32 m0, s48, 4192
  s_nop 0
  buffer_load_dwordx4 v6, s[36:39], s47 offen offset:2048 lds
  v_mfma_f32_32x32x16_bf16 v[64:79], v[96:99], v[176:179], v[64:79]
  v_mfma_f32_32x32x16_bf16 v[32:47], a[40:43], v[88:91], v[32:47]
  s_waitcnt lgkmcnt(2)
  v_mfma_f32_32x32x16_bf16 v[48:63], a[188:191], v[108:111], v[48:63]
  ds_read_b128 v[88:91], v7 offset:576
  s_add_u32 m0, s48, 4208
  s_nop 0
  buffer_load_dwordx4 v6, s[36:39], s47 offen offset:3072 lds
  v_mfma_f32_32x32x16_bf16 v[64:79], v[100:103], v[180:183], v[64:79]
  v_mfma_f32_32x32x16_bf16 v[32:47], a[44:47], v[92:95], v[32:47]
  s_waitcnt lgkmcnt(2)
  v_mfma_f32_32x32x16_bf16 v[48:63], a[192:195], v[80:83], v[48:63]
  ds_read_b128 v[92:95], v7 offset:608
  v_mfma_f32_32x32x16_bf16 v[64:79], v[104:107], v[184:187], v[64:79]
  v_mfma_f32_32x32x16_bf16 v[32:47], a[48:51], v[96:99], v[32:47]
  s_waitcnt lgkmcnt(2)
  v_mfma_f32_32x32x16_bf16 v[48:63], a[196:199], v[84:87], v[48:63]
  ds_read_b128 v[96:99], v7 offset:640
  v_mfma_f32_32x32x16_bf16 v[64:79], v[108:111], v[188:191], v[64:79]
  v_mfma_f32_32x32x16_bf16 v[32:47], a[52:55], v[100:103], v[32:47]
  s_waitcnt lgkmcnt(2)
  v_mfma_f32_32x32x16_bf16 v[48:63], a[200:203], v[88:91], v[48:63]
  ds_read_b128 v[100:103], v7 offset:672
  s_waitcnt vmcnt(8)
  buffer_atomic_add v11, v23, s[4:7], s50 offen sc1
  v_mov_b32 v23, v10
  v_mfma_f32_32x32x16_bf16 v[64:79], v[80:83], v[192:195], v[64:79]
  v_mfma_f32_32x32x16_bf16 v[32:47], a[56:59], v[104:107], v[32:47]
  s_waitcnt lgkmcnt(2)
  v_mfma_f32_32x32x16_bf16 v[48:63], a[204:207], v[92:95], v[48:63]
  ds_read_b128 v[104:107], v7 offset:704
  v_mfma_f32_32x32x16_bf16 v[64:79], v[84:87], v[196:199], v[64:79]
  v_mfma_f32_32x32x16_bf16 v[32:47], a[60:63], v[108:111], v[32:47]
  s_waitcnt lgkmcnt(2)
  v_mfma_f32_32x32x16_bf16 v[48:63], a[208:211], v[96:99], v[48:63]
  ds_read_b128 v[108:111], v7 offset:736
  s_lshl_b32 s42, s46, 5
  s_add_u32 s42, s42, s44
  s_lshl_b32 s42, s42, 13
  s_add_u32 s52, s42, 0x0
  s_add_u32 s53, s42, 0x1000000
  s_add_u32 s51, s42, 0x5000000
  s_lshl_b32 s42, s44, 8
  s_lshl_b32 s43, s46, 2
  s_add_u32 s42, s42, s43
  s_add_u32 s50, s42, 0x4000000
  v_mfma_f32_32x32x16_bf16 v[64:79], v[88:91], v[200:203], v[64:79]
  v_mfma_f32_32x32x16_bf16 v[32:47], a[64:67], v[80:83], v[32:47]
  s_waitcnt lgkmcnt(2)
  v_mfma_f32_32x32x16_bf16 v[48:63], a[212:215], v[100:103], v[48:63]
  ds_read_b128 v[80:83], v7 offset:768
  v_mfma_f32_32x32x16_bf16 v[64:79], v[92:95], v[204:207], v[64:79]
  v_mfma_f32_32x32x16_bf16 v[32:47], a[68:71], v[84:87], v[32:47]
  s_waitcnt lgkmcnt(2)
  v_mfma_f32_32x32x16_bf16 v[48:63], a[216:219], v[104:107], v[48:63]
  ds_read_b128 v[84:87], v7 offset:800
  v_mfma_f32_32x32x16_bf16 v[64:79], v[96:99], v[208:211], v[64:79]
  v_mfma_f32_32x32x16_bf16 v[32:47], a[72:75], v[88:91], v[32:47]
  s_waitcnt lgkmcnt(2)
  v_mfma_f32_32x32x16_bf16 v[48:63], a[220:223], v[108:111], v[48:63]
  ds_read_b128 v[88:91], v7 offset:832
  v_mfma_f32_32x32x16_bf16 v[64:79], v[100:103], v[212:215], v[64:79]
  v_mfma_f32_32x32x16_bf16 v[32:47], a[76:79], v[92:95], v[32:47]
  s_waitcnt lgkmcnt(2)
  v_mfma_f32_32x32x16_bf16 v[48:63], a[224:227], v[80:83], v[48:63]
  ds_read_b128 v[92:95], v7 offset:864
  v_mfma_f32_32x32x16_bf16 v[64:79], v[104:107], v[216:219], v[64:79]
  v_mfma_f32_32x32x16_bf16 v[32:47], a[80:83], v[96:99], v[32:47]
  s_waitcnt lgkmcnt(2)
  v_mfma_f32_32x32x16_bf16 v[48:63], a[228:231], v[84:87], v[48:63]
  ds_read_b128 v[96:99], v7 offset:896
  v_mfma_f32_32x32x16_bf16 v[64:79], v[108:111], v[220:223], v[64:79]
  v_mfma_f32_32x32x16_bf16 v[32:47], a[84:87], v[100:103], v[32:47]
  s_waitcnt lgkmcnt(2)
  v_mfma_f32_32x32x16_bf16 v[48:63], a[232:235], v[88:91], v[48:63]
  ds_read_b128 v[100:103], v7 offset:928
  v_mfma_f32_32x32x16_bf16 v[64:79], v[80:83], v[224:227], v[64:79]
  v_mfma_f32_32x32x16_bf16 v[32:47], a[88:91], v[104:107], v[32:47]
  s_waitcnt lgkmcnt(2)
  v_mfma_f32_32x32x16_bf16 v[48:63], a[236:239], v[92:95], v[48:63]
  ds_read_b128 v[104:107], v7 offset:960
  v_mfma_f32_32x32x16_bf16 v[64:79], v[84:87], v[228:231], v[64:79]
  v_mfma_f32_32x32x16_bf16 v[32:47], a[92:95], v[108:111], v[32:47]
  s_waitcnt lgkmcnt(2)
  v_mfma_f32_32x32x16_bf16 v[48:63], a[240:243], v[96:99], v[48:63]
  ds_read_b128 v[108:111], v7 offset:992
  v_mfma_f32_32x32x16_bf16 v[64:79], v[88:91], v[232:235], v[64:79]
  v_mfma_f32_32x32x16_bf16 v[32:47], a[96:99], v[80:83], v[32:47]
  s_waitcnt lgkmcnt(2)
  v_mfma_f32_32x32x16_bf16 v[48:63], a[244:247], v[100:103], v[48:63]
  v_mfma_f32_32x32x16_bf16 v[64:79], v[92:95], v[236:239], v[64:79]
  s_waitcnt lgkmcnt(0)
  s_waitcnt vmcnt(1)
  s_barrier
  v_add_u32 v7, s49, v7
  s_sub_u32 s49, 0, s49
  ds_read_b128 v[80:83], v7 offset:0
  v_mfma_f32_32x32x16_bf16 v[32:47], a[100:103], v[84:87], v[32:47]
  v_mfma_f32_32x32x16_bf16 v[48:63], a[248:251], v[104:107], v[48:63]
  ds_read_b128 v[84:87], v7 offset:32
  v_mfma_f32_32x32x16_bf16 v[64:79], v[96:99], v[240:243], v[64:79]
  v_mfma_f32_32x32x16_bf16 v[32:47], a[104:107], v[88:91], v[32:47]
  v_mfma_f32_32x32x16_bf16 v[48:63], a[252:255], v[108:111], v[48:63]
  ds_read_b128 v[88:91], v7 offset:64
  v_mfma_f32_32x32x16_bf16 v[64:79], v[100:103], v[244:247], v[64:79]
  v_mfma_f32_32x32x16_bf16 v[32:47], a[108:111], v[92:95], v[32:47]
  v_cvt_pk_bf16_f32 v48, v48, v49
  v_cvt_pk_bf16_f32 v49, v50, v51
  v_cvt_pk_bf16_f32 v50, v52, v53
  v_cvt_pk_bf16_f32 v51, v54, v55
  v_mfma_f32_32x32x16_bf16 v[64:79], v[104:107], v[248:251], v[64:79]
  v_cvt_pk_bf16_f32 v52, v56, v57
  v_cvt_pk_bf16_f32 v53, v58, v59
  v_cvt_pk_bf16_f32 v54, v60, v61
  v_cvt_pk_bf16_f32 v55, v62, v63
  v_mfma_f32_32x32x16_bf16 v[32:47], a[112:115], v[96:99], v[32:47]
  buffer_store_dwordx4 v[48:51], v8, s[4:7], s52 offen offset:0 sc1
  v_mfma_f32_32x32x16_bf16 v[64:79], v[108:111], v[252:255], v[64:79]
  buffer_store_dwordx4 v[52:55], v8, s[4:7], s52 offen offset:1024 sc1
  v_mfma_f32_32x32x16_bf16 v[32:47], a[116:119], v[100:103], v[32:47]
  s_add_u32 s46, s46, 3
  s_sub_u32 s54, s54, 1
  s_cmp_lg_u32 s54, 0
  s_cbranch_scc1 L_hp1s_151
  s_nop 7
  v_cvt_pk_bf16_f32 v64, v64, v65
  v_cvt_pk_bf16_f32 v65, v66, v67
  v_cvt_pk_bf16_f32 v66, v68, v69
  v_cvt_pk_bf16_f32 v67, v70, v71
  v_mfma_f32_32x32x16_bf16 v[32:47], a[120:123], v[104:107], v[32:47]
  v_cvt_pk_bf16_f32 v68, v72, v73
  v_cvt_pk_bf16_f32 v69, v74, v75
  v_cvt_pk_bf16_f32 v70, v76, v77
  v_cvt_pk_bf16_f32 v71, v78, v79
  buffer_store_dwordx4 v[64:67], v15, s[4:7], s53 offen offset:0 sc1
  v_mfma_f32_32x32x16_bf16 v[32:47], a[124:127], v[108:111], v[32:47]
  buffer_store_dwordx4 v[68:71], v15, s[4:7], s53 offen offset:1024 sc1
  s_nop 10
  v_cvt_pk_bf16_f32 v32, v32, v33
  v_cvt_pk_bf16_f32 v33, v34, v35
  v_cvt_pk_bf16_f32 v34, v36, v37
  v_cvt_pk_bf16_f32 v35, v38, v39
  v_cvt_pk_bf16_f32 v36, v40, v41
  v_cvt_pk_bf16_f32 v37, v42, v43
  v_cvt_pk_bf16_f32 v38, v44, v45
  v_cvt_pk_bf16_f32 v39, v46, v47
  buffer_store_dwordx4 v[32:35], v8, s[4:7], s51 offen offset:0 sc1
  buffer_store_dwordx4 v[36:39], v8, s[4:7], s51 offen offset:1024 sc1
  s_waitcnt vmcnt(0)
  buffer_atomic_add v11, v10, s[4:7], s50 offen sc1
  v_mov_b32 v14, 0x0
  v_bfe_u32 v12, v0, 0, 6
  v_mad_i32_i24 v14, v12, 16, v14
  v_mov_b32 v15, 0x0
  v_bfe_u32 v12, v0, 0, 3
  s_mov_b32 s42, 0x100
  v_mad_i32_i24 v15, v12, s42, v15
  v_bfe_u32 v12, v0, 3, 1
  s_mov_b32 s42, 0x40000000
  v_mul_lo_u32 v13, v12, s42
  v_add_u32 v15, v15, v13
  v_bfe_u32 v12, v0, 4, 1
  s_mov_b32 s42, 0x40000000
  v_mul_lo_u32 v13, v12, s42
  v_add_u32 v15, v15, v13
  v_bfe_u32 v12, v0, 5, 1
  v_mad_i32_i24 v15, v12, 16, v15
  v_bfe_u32 v12, v0, 0, 1
  v_bfe_u32 v13, v0, 3, 1
  v_and_b32 v12, v12, v13
  s_mov_b32 s42, 0xffffff00
  v_mad_i32_i24 v15, v12, s42, v15
  v_bfe_u32 v12, v0, 1, 1
  v_bfe_u32 v13, v0, 3, 1
  v_and_b32 v12, v12, v13
  s_mov_b32 s42, 0xfffffe00
  v_mad_i32_i24 v15, v12, s42, v15
  v_bfe_u32 v12, v0, 2, 1
  v_bfe_u32 v13, v0, 3, 1
  v_and_b32 v12, v12, v13
  s_mov_b32 s42, 0xfffffc00
  v_mad_i32_i24 v15, v12, s42, v15
  v_bfe_u32 v12, v0, 0, 1
  v_bfe_u32 v13, v0, 4, 1
  v_and_b32 v12, v12, v13
  s_mov_b32 s42, 0xffffff00
  v_mad_i32_i24 v15, v12, s42, v15
  v_bfe_u32 v12, v0, 1, 1
  v_bfe_u32 v13, v0, 4, 1
  v_and_b32 v12, v12, v13
  s_mov_b32 s42, 0xfffffe00
  v_mad_i32_i24 v15, v12, s42, v15
  v_bfe_u32 v12, v0, 2, 1
  v_bfe_u32 v13, v0, 4, 1
  v_and_b32 v12, v12, v13
  s_mov_b32 s42, 0xfffffc00
  v_mad_i32_i24 v15, v12, s42, v15
  v_bfe_u32 v12, v0, 3, 1
  v_bfe_u32 v13, v0, 4, 1
  v_and_b32 v12, v12, v13
  s_mov_b32 s42, 0xc0000000
  v_mul_lo_u32 v13, v12, s42
  v_add_u32 v15, v15, v13
  v_bfe_u32 v12, v0, 0, 1
  v_bfe_u32 v13, v0, 3, 1
  v_and_b32 v12, v12, v13
  v_bfe_u32 v13, v0, 4, 1
  v_and_b32 v12, v12, v13
  s_mov_b32 s42, 0x100
  v_mad_i32_i24 v15, v12, s42, v15
  v_bfe_u32 v12, v0, 1, 1
  v_bfe_u32 v13, v0, 3, 1
  v_and_b32 v12, v12, v13
  v_bfe_u32 v13, v0, 4, 1
  v_and_b32 v12, v12, v13
  s_mov_b32 s42, 0x200
  v_mad_i32_i24 v15, v12, s42, v15
  v_bfe_u32 v12, v0, 2, 1
  v_bfe_u32 v13, v0, 3, 1
  v_and_b32 v12, v12, v13
  v_bfe_u32 v13, v0, 4, 1
  v_and_b32 v12, v12, v13
  s_mov_b32 s42, 0x400
  v_mad_i32_i24 v15, v12, s42, v15
  v_bfe_u32 v12, v0, 3, 1
  v_bfe_u32 v13, v0, 5, 1
  v_and_b32 v12, v12, v13
  v_mad_i32_i24 v15, v12, -16, v15
  v_bfe_u32 v12, v0, 4, 1
  v_bfe_u32 v13, v0, 5, 1
  v_and_b32 v12, v12, v13
  v_mad_i32_i24 v15, v12, -16, v15
  v_bfe_u32 v12, v0, 3, 1
  v_bfe_u32 v13, v0, 4, 1
  v_and_b32 v12, v12, v13
  v_bfe_u32 v13, v0, 5, 1
  v_and_b32 v12, v12, v13
  v_mad_i32_i24 v15, v12, 16, v15
  v_mov_b32 v16, 0x0
  v_bfe_u32 v12, v0, 0, 5
  v_mad_i32_i24 v16, v12, 16, v16
  v_bfe_u32 v12, v0, 5, 1
  v_mad_i32_i24 v16, v12, 8, v16
  v_and_b32 v12, 31, v0
  v_bfe_u32 v13, v0, 5, 1
  v_lshlrev_b32 v13, 2, v13
  v_sub_u32 v19, v12, v13
  v_mov_b32 v12, 0
  v_mov_b32 v13, 0xf149f2ca
  v_cmp_le_i32 vcc, 0, v19
  s_nop 1
  v_cndmask_b32 v144, v13, v12, vcc
  v_cmp_le_i32 vcc, 1, v19
  s_nop 1
  v_cndmask_b32 v145, v13, v12, vcc
  v_cmp_le_i32 vcc, 2, v19
  s_nop 1
  v_cndmask_b32 v146, v13, v12, vcc
  v_cmp_le_i32 vcc, 3, v19
  s_nop 1
  v_cndmask_b32 v147, v13, v12, vcc
  v_cmp_le_i32 vcc, 8, v19
  s_nop 1
  v_cndmask_b32 v148, v13, v12, vcc
  v_cmp_le_i32 vcc, 9, v19
  s_nop 1
  v_cndmask_b32 v149, v13, v12, vcc
  v_cmp_le_i32 vcc, 10, v19
  s_nop 1
  v_cndmask_b32 v150, v13, v12, vcc
  v_cmp_le_i32 vcc, 11, v19
  s_nop 1
  v_cndmask_b32 v151, v13, v12, vcc
  v_cmp_le_i32 vcc, 16, v19
  s_nop 1
  v_cndmask_b32 v152, v13, v12, vcc
  v_cmp_le_i32 vcc, 17, v19
  s_nop 1
  v_cndmask_b32 v153, v13, v12, vcc
  v_cmp_le_i32 vcc, 18, v19
  s_nop 1
  v_cndmask_b32 v154, v13, v12, vcc
  v_cmp_le_i32 vcc, 19, v19
  s_nop 1
  v_cndmask_b32 v155, v13, v12, vcc
  v_cmp_le_i32 vcc, 24, v19
  s_nop 1
  v_cndmask_b32 v156, v13, v12, vcc
  v_cmp_le_i32 vcc, 25, v19
  s_nop 1
  v_cndmask_b32 v157, v13, v12, vcc
  v_cmp_le_i32 vcc, 26, v19
  s_nop 1
  v_cndmask_b32 v158, v13, v12, vcc
  v_cmp_le_i32 vcc, 27, v19
  s_nop 1
  v_cndmask_b32 v159, v13, v12, vcc
  v_mov_b32 v210, 0
  v_mov_b32 v211, 0
  v_mov_b32 v238, 0
  v_mov_b32 v239, 0
  v_mov_b32 v214, 0
  v_mov_b32 v215, 0
  v_mov_b32 v242, 0
  v_mov_b32 v243, 0
  v_mov_b32 v218, 0
  v_mov_b32 v219, 0
  v_mov_b32 v246, 0
  v_mov_b32 v247, 0
  v_mov_b32 v222, 0
  v_mov_b32 v223, 0
  v_mov_b32 v250, 0
  v_mov_b32 v251, 0
  v_mov_b32 v234, 0
  v_mov_b32 v235, 0
  s_mov_b32 s64, 0x3e0293ee
  s_lshl_b32 s46, s45, 2
  s_add_u32 s46, s46, s14
L_hp2_152:
  s_cmp_ge_u32 s46, 64
  s_cbranch_scc1 L_hp2_done_153
  s_lshl_b32 s42, s44, 8
  s_lshl_b32 s43, s46, 2
  s_add_u32 s56, s42, s43
  s_add_u32 s56, s56, 0x4000000
  s_add_u32 s63, s42, 0x4002000
  s_lshl_b32 s42, s46, 5
  s_add_u32 s42, s42, s44
  s_lshl_b32 s43, s42, 13
  s_add_u32 s57, s43, 0x5000000
  s_add_u32 s58, s43, 0x0
  s_add_u32 s59, s43, 0x1000000
  s_add_u32 s62, s43, 0x2800000
  s_lshl_b32 s43, s42, 11
  s_add_u32 s60, s43, 0x2000000
  s_add_u32 s61, s43, 0x2400000
  s_cmp_lt_u32 s46, 3
  s_cselect_b32 s65, 8, 4
  s_mov_b32 s15, 0x400000
L_poll_154:
  buffer_load_dword v19, off, s[4:7], s56 sc1
  s_waitcnt vmcnt(0)
  v_readfirstlane_b32 s16, v19
  s_cmp_ge_u32 s16, s65
  s_cbranch_scc1 L_poll_out_155
  s_sub_u32 s15, s15, 1
  s_cmp_lg_u32 s15, 0
  s_cbranch_scc1 L_poll_154
L_poll_out_155:
  buffer_load_dwordx4 v[64:67], v14, s[4:7], s58 offen offset:0 sc1
  buffer_load_dwordx4 v[68:71], v14, s[4:7], s58 offen offset:1024 sc1
  buffer_load_dwordx4 v[72:75], v14, s[4:7], s58 offen offset:2048 sc1
  buffer_load_dwordx4 v[76:79], v14, s[4:7], s58 offen offset:3072 sc1
  s_add_u32 s42, s58, 4096
  s_waitcnt lgkmcnt(2)
  buffer_load_dwordx4 v[80:83], v14, s[4:7], s42 offen offset:0 sc1
  s_waitcnt lgkmcnt(1)
  buffer_load_dwordx4 v[84:87], v14, s[4:7], s42 offen offset:1024 sc1
  s_waitcnt lgkmcnt(0)
  buffer_load_dwordx4 v[88:91], v14, s[4:7], s42 offen offset:2048 sc1
  buffer_load_dwordx4 v[92:95], v14, s[4:7], s42 offen offset:3072 sc1
  buffer_load_dwordx4 v[32:35], v14, s[4:7], s57 offen offset:0 sc1
  buffer_load_dwordx4 v[36:39], v14, s[4:7], s57 offen offset:1024 sc1
  buffer_load_dwordx4 v[40:43], v14, s[4:7], s57 offen offset:2048 sc1
  buffer_load_dwordx4 v[44:47], v14, s[4:7], s57 offen offset:3072 sc1
  s_add_u32 s42, s57, 4096
  buffer_load_dwordx4 v[48:51], v14, s[4:7], s42 offen offset:0 sc1
  buffer_load_dwordx4 v[52:55], v14, s[4:7], s42 offen offset:1024 sc1
  buffer_load_dwordx4 v[56:59], v14, s[4:7], s42 offen offset:2048 sc1
  buffer_load_dwordx4 v[60:63], v14, s[4:7], s42 offen offset:3072 sc1
  buffer_load_dwordx4 v[96:99], v14, s[4:7], s59 offen offset:0 sc1
  buffer_load_dwordx4 v[100:103], v14, s[4:7], s59 offen offset:1024 sc1
  buffer_load_dwordx4 v[104:107], v14, s[4:7], s59 offen offset:2048 sc1
  buffer_load_dwordx4 v[108:111], v14, s[4:7], s59 offen offset:3072 sc1
  s_add_u32 s42, s59, 4096
  buffer_load_dwordx4 v[112:115], v14, s[4:7], s42 offen offset:0 sc1
  buffer_load_dwordx4 v[116:119], v14, s[4:7], s42 offen offset:1024 sc1
  buffer_load_dwordx4 v[120:123], v14, s[4:7], s42 offen offset:2048 sc1
  buffer_load_dwordx4 v[124:127], v14, s[4:7], s42 offen offset:3072 sc1
  s_waitcnt vmcnt(15)
  v_mfma_f32_32x32x16_bf16 v[128:143], v[64:67], v[32:35], v[144:159]
  s_waitcnt vmcnt(14)
  v_mfma_f32_32x32x16_bf16 v[128:143], v[68:71], v[36:39], v[128:143]
  s_waitcnt vmcnt(13)
  v_mfma_f32_32x32x16_bf16 v[128:143], v[72:75], v[40:43], v[128:143]
  s_waitcnt vmcnt(12)
  v_mfma_f32_32x32x16_bf16 v[128:143], v[76:79], v[44:47], v[128:143]
  s_waitcnt vmcnt(11)
  v_mfma_f32_32x32x16_bf16 v[128:143], v[80:83], v[48:51], v[128:143]
  s_waitcnt vmcnt(10)
  v_mfma_f32_32x32x16_bf16 v[128:143], v[84:87], v[52:55], v[128:143]
  s_waitcnt vmcnt(9)
  v_mfma_f32_32x32x16_bf16 v[128:143], v[88:91], v[56:59], v[128:143]
  s_waitcnt vmcnt(8)
  v_mfma_f32_32x32x16_bf16 v[128:143], v[92:95], v[60:63], v[128:143]
  s_nop 11
  v_max3_f32 v17, v128, v129, v130
  v_max3_f32 v17, v17, v131, v132
  v_max3_f32 v17, v17, v133, v134
  v_max3_f32 v17, v17, v135, v136
  v_max3_f32 v17, v17, v137, v138
  v_max3_f32 v17, v17, v139, v140
  v_max3_f32 v17, v17, v141, v142
  v_max_f32 v17, v17, v143
  s_cmp_eq_u32 s46, 61
  s_cselect_b32 s65, 59, 60
  s_cmp_ge_u32 s46, 61
  s_cselect_b32 s65, s65, s46
  s_mov_b32 s15, 0x400000
L_poll_156:
  buffer_load_dword v19, off, s[4:7], s63 sc1
  s_waitcnt vmcnt(0)
  v_readfirstlane_b32 s16, v19
  s_cmp_gt_u32 s16, s65
  s_cbranch_scc1 L_poll_out_157
  s_sub_u32 s15, s15, 1
  s_cmp_lg_u32 s15, 0
  s_cbranch_scc1 L_poll_156
L_poll_out_157:
  s_mov_b32 s15, 0x200000
  buffer_load_dwordx4 v[176:179], v15, s[4:7], s60 offen offset:0 sc1
  buffer_load_dwordx4 v[180:183], v15, s[4:7], s60 offen offset:32 sc1
  buffer_load_dwordx4 v[184:187], v15, s[4:7], s60 offen offset:64 sc1
  buffer_load_dwordx4 v[188:191], v15, s[4:7], s60 offen offset:96 sc1
  buffer_load_dwordx4 v[192:195], v15, s[4:7], s60 offen offset:128 sc1
  buffer_load_dwordx4 v[196:199], v15, s[4:7], s60 offen offset:160 sc1
  buffer_load_dwordx4 v[200:203], v15, s[4:7], s60 offen offset:192 sc1
  buffer_load_dwordx4 v[204:207], v15, s[4:7], s60 offen offset:224 sc1
  buffer_load_dwordx2 v[208:209], v16, s[4:7], s61 offen offset:0 sc1
  buffer_load_dwordx2 v[212:213], v16, s[4:7], s61 offen offset:512 sc1
  buffer_load_dwordx2 v[216:217], v16, s[4:7], s61 offen offset:1024 sc1
  buffer_load_dwordx2 v[220:221], v16, s[4:7], s61 offen offset:1536 sc1
  s_cmp_lt_u32 s46, 61
  s_cbranch_scc1 L_hp2_settle_160
  s_sleep 8
L_hp2_again_158:
  buffer_load_dwordx4 v[64:67], v15, s[4:7], s60 offen offset:0 sc1
  buffer_load_dwordx4 v[68:71], v15, s[4:7], s60 offen offset:32 sc1
  buffer_load_dwordx4 v[72:75], v15, s[4:7], s60 offen offset:64 sc1
  buffer_load_dwordx4 v[76:79], v15, s[4:7], s60 offen offset:96 sc1
  buffer_load_dwordx4 v[80:83], v15, s[4:7], s60 offen offset:128 sc1
  buffer_load_dwordx4 v[84:87], v15, s[4:7], s60 offen offset:160 sc1
  buffer_load_dwordx4 v[88:91], v15, s[4:7], s60 offen offset:192 sc1
  buffer_load_dwordx4 v[92:95], v15, s[4:7], s60 offen offset:224 sc1
  buffer_load_dwordx2 v[236:237], v16, s[4:7], s61 offen offset:0 sc1
  buffer_load_dwordx2 v[240:241], v16, s[4:7], s61 offen offset:512 sc1
  buffer_load_dwordx2 v[244:245], v16, s[4:7], s61 offen offset:1024 sc1
  buffer_load_dwordx2 v[248:249], v16, s[4:7], s61 offen offset:1536 sc1
  s_waitcnt vmcnt(12)
  v_max3_u32 v19, v176, v177, v178
  v_max3_u32 v18, v179, v180, v181
  v_max3_u32 v19, v19, v182, v183
  v_max3_u32 v18, v18, v184, v185
  v_max3_u32 v19, v19, v186, v187
  v_max3_u32 v18, v18, v188, v189
  v_max3_u32 v19, v19, v190, v191
  v_max3_u32 v18, v18, v192, v193
  v_max3_u32 v19, v19, v194, v195
  v_max3_u32 v18, v18, v196, v197
  v_max3_u32 v19, v19, v198, v199
  v_max3_u32 v18, v18, v200, v201
  v_max3_u32 v19, v19, v202, v203
  v_max3_u32 v18, v18, v204, v205
  v_max3_u32 v19, v19, v206, v207
  v_max3_u32 v18, v18, v208, v209
  v_max3_u32 v19, v19, v212, v213
  v_max3_u32 v18, v18, v216, v217
  v_max3_u32 v19, v19, v220, v221
  v_max_u32 v19, v19, v18
  v_cmp_eq_u32 vcc, -1, v19
  s_cbranch_vccz L_hp2_have_159
  buffer_load_dwordx4 v[176:179], v15, s[4:7], s60 offen offset:0 sc1
  buffer_load_dwordx4 v[180:183], v15, s[4:7], s60 offen offset:32 sc1
  buffer_load_dwordx4 v[184:187], v15, s[4:7], s60 offen offset:64 sc1
  buffer_load_dwordx4 v[188:191], v15, s[4:7], s60 offen offset:96 sc1
  buffer_load_dwordx4 v[192:195], v15, s[4:7], s60 offen offset:128 sc1
  buffer_load_dwordx4 v[196:199], v15, s[4:7], s60 offen offset:160 sc1
  buffer_load_dwordx4 v[200:203], v15, s[4:7], s60 offen offset:192 sc1
  buffer_load_dwordx4 v[204:207], v15, s[4:7], s60 offen offset:224 sc1
  buffer_load_dwordx2 v[208:209], v16, s[4:7], s61 offen offset:0 sc1
  buffer_load_dwordx2 v[212:213], v16, s[4:7], s61 offen offset:512 sc1
  buffer_load_dwordx2 v[216:217], v16, s[4:7], s61 offen offset:1024 sc1
  buffer_load_dwordx2 v[220:221], v16, s[4:7], s61 offen offset:1536 sc1
  s_waitcnt vmcnt(12)
  v_max3_u32 v19, v64, v65, v66
  v_max3_u32 v18, v67, v68, v69
  v_max3_u32 v19, v19, v70, v71
  v_max3_u32 v18, v18, v72, v73
  v_max3_u32 v19, v19, v74, v75
  v_max3_u32 v18, v18, v76, v77
  v_max3_u32 v19, v19, v78, v79
  v_max3_u32 v18, v18, v80, v81
  v_max3_u32 v19, v19, v82, v83
  v_max3_u32 v18, v18, v84, v85
  v_max3_u32 v19, v19, v86, v87
  v_max3_u32 v18, v18, v88, v89
  v_max3_u32 v19, v19, v90, v91
  v_max3_u32 v18, v18, v92, v93
  v_max3_u32 v19, v19, v94, v95
  v_max3_u32 v18, v18, v236, v237
  v_max3_u32 v19, v19, v240, v241
  v_max3_u32 v18, v18, v244, v245
  v_max3_u32 v19, v19, v248, v249
  v_max_u32 v19, v19, v18
  v_cmp_eq_u32 vcc, -1, v19
  s_cbranch_vccz L_hp2_other_161
  s_sub_u32 s15, s15, 1
  s_cbranch_scc0 L_hp2_again_158
L_hp2_settle_160:
  s_waitcnt vmcnt(0)
L_hp2_have_159:
  v_mfma_f32_32x32x16_bf16 v[160:175], v[176:179], v[32:35], 0
  v_mfma_f32_32x32x16_bf16 v[160:175], v[180:183], v[36:39], v[160:175]
  v_mfma_f32_32x32x16_bf16 v[160:175], v[184:187], v[40:43], v[160:175]
  v_mfma_f32_32x32x16_bf16 v[160:175], v[188:191], v[44:47], v[160:175]
  v_mfma_f32_32x32x16_bf16 v[160:175], v[192:195], v[48:51], v[160:175]
  v_mfma_f32_32x32x16_bf16 v[160:175], v[196:199], v[52:55], v[160:175]
  v_mfma_f32_32x32x16_bf16 v[160:175], v[200:203], v[56:59], v[160:175]
  v_mfma_f32_32x32x16_bf16 v[160:175], v[204:207], v[60:63], v[160:175]
  s_nop 11
  v_max3_f32 v17, v17, v160, v161
  v_max3_f32 v17, v17, v162, v163
  v_mov_b32 v19, v17
  s_nop 1
  v_permlane32_swap_b32 v17, v19
  v_max_f32 v17, v17, v19
  v_mul_f32 v17, s64, v17
  v_fma_f32 v128, v128, s64, -v17
  v_fma_f32 v129, v129, s64, -v17
  v_fma_f32 v130, v130, s64, -v17
  v_fma_f32 v131, v131, s64, -v17
  v_fma_f32 v132, v132, s64, -v17
  v_fma_f32 v133, v133, s64, -v17
  v_fma_f32 v134, v134, s64, -v17
  v_fma_f32 v135, v135, s64, -v17
  v_fma_f32 v136, v136, s64, -v17
  v_fma_f32 v137, v137, s64, -v17
  v_fma_f32 v138, v138, s64, -v17
  v_fma_f32 v139, v139, s64, -v17
  v_fma_f32 v140, v140, s64, -v17
  v_fma_f32 v141, v141, s64, -v17
  v_fma_f32 v142, v142, s64, -v17
  v_fma_f32 v143, v143, s64, -v17
  v_fma_f32 v160, v160, s64, -v17
  v_fma_f32 v161, v161, s64, -v17
  v_fma_f32 v162, v162, s64, -v17
  v_fma_f32 v163, v163, s64, -v17
  v_exp_f32 v128, v128
  v_exp_f32 v129, v129
  v_exp_f32 v130, v130
  v_exp_f32 v131, v131
  v_exp_f32 v132, v132
  v_exp_f32 v133, v133
  v_exp_f32 v134, v134
  v_exp_f32 v135, v135
  v_exp_f32 v136, v136
  v_exp_f32 v137, v137
  v_exp_f32 v138, v138
  v_exp_f32 v139, v139
  v_exp_f32 v140, v140
  v_exp_f32 v141, v141
  v_exp_f32 v142, v142
  v_exp_f32 v143, v143
  v_exp_f32 v160, v160
  v_exp_f32 v161, v161
  v_exp_f32 v162, v162
  v_exp_f32 v163, v163
  v_add_f32 v18, v128, v129
  v_add_f32 v19, v130, v131
  v_add_f32 v18, v18, v132
  v_add_f32 v19, v19, v133
  v_add_f32 v18, v18, v134
  v_add_f32 v19, v19, v135
  v_add_f32 v18, v18, v136
  v_add_f32 v19, v19, v137
  v_add_f32 v18, v18, v138
  v_add_f32 v19, v19, v139
  v_add_f32 v18, v18, v140
  v_add_f32 v19, v19, v141
  v_add_f32 v18, v18, v142
  v_add_f32 v19, v19, v143
  v_add_f32 v18, v18, v160
  v_add_f32 v19, v19, v161
  v_add_f32 v18, v18, v162
  v_add_f32 v19, v19, v163
  v_add_f32 v18, v18, v19
  v_mov_b32 v19, v18
  s_nop 1
  v_permlane32_swap_b32 v18, v19
  v_add_f32 v18, v18, v19
  v_rcp_f32 v18, v18
  s_nop 0
  v_mul_f32 v128, v128, v18
  v_mul_f32 v129, v129, v18
  v_mul_f32 v130, v130, v18
  v_mul_f32 v131, v131, v18
  v_mul_f32 v132, v132, v18
  v_mul_f32 v133, v133, v18
  v_mul_f32 v134, v134, v18
  v_mul_f32 v135, v135, v18
  v_mul_f32 v136, v136, v18
  v_mul_f32 v137, v137, v18
  v_mul_f32 v138, v138, v18
  v_mul_f32 v139, v139, v18
  v_mul_f32 v140, v140, v18
  v_mul_f32 v141, v141, v18
  v_mul_f32 v142, v142, v18
  v_mul_f32 v143, v143, v18
  v_mul_f32 v160, v160, v18
  v_mul_f32 v161, v161, v18
  v_mul_f32 v162, v162, v18
  v_mul_f32 v163, v163, v18
  v_cvt_pk_bf16_f32 v224, v128, v129
  v_cvt_pk_bf16_f32 v225, v130, v131
  v_cvt_pk_bf16_f32 v226, v132, v133
  v_cvt_pk_bf16_f32 v227, v134, v135
  v_cvt_pk_bf16_f32 v228, v136, v137
  v_cvt_pk_bf16_f32 v229, v138, v139
  v_cvt_pk_bf16_f32 v230, v140, v141
  v_cvt_pk_bf16_f32 v231, v142, v143
  v_cvt_pk_bf16_f32 v232, v160, v161
  v_cvt_pk_bf16_f32 v233, v162, v163
  s_add_u32 s43, s62, 4096
  v_mfma_f32_32x32x16_bf16 v[32:47], v[96:99], v[224:227], 0
  v_mfma_f32_32x32x16_bf16 v[32:47], v[100:103], v[228:231], v[32:47]
  v_mfma_f32_32x32x16_bf16 v[32:47], v[208:211], v[232:235], v[32:47]
  v_mfma_f32_32x32x16_bf16 v[48:63], v[104:107], v[224:227], 0
  v_mfma_f32_32x32x16_bf16 v[48:63], v[108:111], v[228:231], v[48:63]
  v_cvt_pk_bf16_f32 v32, v32, v33
  v_cvt_pk_bf16_f32 v33, v34, v35
  v_cvt_pk_bf16_f32 v34, v36, v37
  v_cvt_pk_bf16_f32 v35, v38, v39
  v_cvt_pk_bf16_f32 v36, v40, v41
  v_cvt_pk_bf16_f32 v37, v42, v43
  v_cvt_pk_bf16_f32 v38, v44, v45
  v_cvt_pk_bf16_f32 v39, v46, v47
  v_mfma_f32_32x32x16_bf16 v[48:63], v[212:215], v[232:235], v[48:63]
  buffer_store_dwordx4 v[32:35], v14, s[4:7], s62 offen offset:0 sc1
  buffer_store_dwordx4 v[36:39], v14, s[4:7], s62 offen offset:1024 sc1
  s_waitcnt vmcnt(10)
  v_mfma_f32_32x32x16_bf16 v[64:79], v[112:115], v[224:227], 0
  v_mfma_f32_32x32x16_bf16 v[64:79], v[116:119], v[228:231], v[64:79]
  v_cvt_pk_bf16_f32 v48, v48, v49
  v_cvt_pk_bf16_f32 v49, v50, v51
  v_cvt_pk_bf16_f32 v50, v52, v53
  v_cvt_pk_bf16_f32 v51, v54, v55
  v_cvt_pk_bf16_f32 v52, v56, v57
  v_cvt_pk_bf16_f32 v53, v58, v59
  v_cvt_pk_bf16_f32 v54, v60, v61
  v_cvt_pk_bf16_f32 v55, v62, v63
  v_mfma_f32_32x32x16_bf16 v[64:79], v[216:219], v[232:235], v[64:79]
  buffer_store_dwordx4 v[48:51], v14, s[4:7], s62 offen offset:2048 sc1
  buffer_store_dwordx4 v[52:55], v14, s[4:7], s62 offen offset:3072 sc1
  s_waitcnt vmcnt(8)
  v_mfma_f32_32x32x16_bf16 v[80:95], v[120:123], v[224:227], 0
  v_mfma_f32_32x32x16_bf16 v[80:95], v[124:127], v[228:231], v[80:95]
  v_cvt_pk_bf16_f32 v64, v64, v65
  v_cvt_pk_bf16_f32 v65, v66, v67
  v_cvt_pk_bf16_f32 v66, v68, v69
  v_cvt_pk_bf16_f32 v67, v70, v71
  v_cvt_pk_bf16_f32 v68, v72, v73
  v_cvt_pk_bf16_f32 v69, v74, v75
  v_cvt_pk_bf16_f32 v70, v76, v77
  v_cvt_pk_bf16_f32 v71, v78, v79
  v_mfma_f32_32x32x16_bf16 v[80:95], v[220:223], v[232:235], v[80:95]
  buffer_store_dwordx4 v[64:67], v14, s[4:7], s43 offen offset:0 sc1
  buffer_store_dwordx4 v[68:71], v14, s[4:7], s43 offen offset:1024 sc1
  s_nop 9
  v_cvt_pk_bf16_f32 v80, v80, v81
  v_cvt_pk_bf16_f32 v81, v82, v83
  v_cvt_pk_bf16_f32 v82, v84, v85
  v_cvt_pk_bf16_f32 v83, v86, v87
  buffer_store_dwordx4 v[80:83], v14, s[4:7], s43 offen offset:2048 sc1
  v_cvt_pk_bf16_f32 v84, v88, v89
  v_cvt_pk_bf16_f32 v85, v90, v91
  v_cvt_pk_bf16_f32 v86, v92, v93
  v_cvt_pk_bf16_f32 v87, v94, v95
  buffer_store_dwordx4 v[84:87], v14, s[4:7], s43 offen offset:3072 sc1
  s_branch L_hp2_joined_162
L_hp2_other_161:
  v_mfma_f32_32x32x16_bf16 v[160:175], v[64:67], v[32:35], 0
  v_mfma_f32_32x32x16_bf16 v[160:175], v[68:71], v[36:39], v[160:175]
  v_mfma_f32_32x32x16_bf16 v[160:175], v[72:75], v[40:43], v[160:175]
  v_mfma_f32_32x32x16_bf16 v[160:175], v[76:79], v[44:47], v[160:175]
  v_mfma_f32_32x32x16_bf16 v[160:175], v[80:83], v[48:51], v[160:175]
  v_mfma_f32_32x32x16_bf16 v[160:175], v[84:87], v[52:55], v[160:175]
  v_mfma_f32_32x32x16_bf16 v[160:175], v[88:91], v[56:59], v[160:175]
  v_mfma_f32_32x32x16_bf16 v[160:175], v[92:95], v[60:63], v[160:175]
  s_nop 11
  v_max3_f32 v17, v17, v160, v161
  v_max3_f32 v17, v17, v162, v163
  v_mov_b32 v19, v17
  s_nop 1
  v_permlane32_swap_b32 v17, v19
  v_max_f32 v17, v17, v19
  v_mul_f32 v17, s64, v17
  v_fma_f32 v128, v128, s64, -v17
  v_fma_f32 v129, v129, s64, -v17
  v_fma_f32 v130, v130, s64, -v17
  v_fma_f32 v131, v131, s64, -v17
  v_fma_f32 v132, v132, s64, -v17
  v_fma_f32 v133, v133, s64, -v17
  v_fma_f32 v134, v134, s64, -v17
  v_fma_f32 v135, v135, s64, -v17
  v_fma_f32 v136, v136, s64, -v17
  v_fma_f32 v137, v137, s64, -v17
  v_fma_f32 v138, v138, s64, -v17
  v_fma_f32 v139, v139, s64, -v17
  v_fma_f32 v140, v140, s64, -v17
  v_fma_f32 v141, v141, s64, -v17
  v_fma_f32 v142, v142, s64, -v17
  v_fma_f32 v143, v143, s64, -v17
  v_fma_f32 v160, v160, s64, -v17
  v_fma_f32 v161, v161, s64, -v17
  v_fma_f32 v162, v162, s64, -v17
  v_fma_f32 v163, v163, s64, -v17
  v_exp_f32 v128, v128
  v_exp_f32 v129, v129
  v_exp_f32 v130, v130
  v_exp_f32 v131, v131
  v_exp_f32 v132, v132
  v_exp_f32 v133, v133
  v_exp_f32 v134, v134
  v_exp_f32 v135, v135
  v_exp_f32 v136, v136
  v_exp_f32 v137, v137
  v_exp_f32 v138, v138
  v_exp_f32 v139, v139
  v_exp_f32 v140, v140
  v_exp_f32 v141, v141
  v_exp_f32 v142, v142
  v_exp_f32 v143, v143
  v_exp_f32 v160, v160
  v_exp_f32 v161, v161
  v_exp_f32 v162, v162
  v_exp_f32 v163, v163
  v_add_f32 v18, v128, v129
  v_add_f32 v19, v130, v131
  v_add_f32 v18, v18, v132
  v_add_f32 v19, v19, v133
  v_add_f32 v18, v18, v134
  v_add_f32 v19, v19, v135
  v_add_f32 v18, v18, v136
  v_add_f32 v19, v19, v137
  v_add_f32 v18, v18, v138
  v_add_f32 v19, v19, v139
  v_add_f32 v18, v18, v140
  v_add_f32 v19, v19, v141
  v_add_f32 v18, v18, v142
  v_add_f32 v19, v19, v143
  v_add_f32 v18, v18, v160
  v_add_f32 v19, v19, v161
  v_add_f32 v18, v18, v162
  v_add_f32 v19, v19, v163
  v_add_f32 v18, v18, v19
  v_mov_b32 v19, v18
  s_nop 1
  v_permlane32_swap_b32 v18, v19
  v_add_f32 v18, v18, v19
  v_rcp_f32 v18, v18
  s_nop 0
  v_mul_f32 v128, v128, v18
  v_mul_f32 v129, v129, v18
  v_mul_f32 v130, v130, v18
  v_mul_f32 v131, v131, v18
  v_mul_f32 v132, v132, v18
  v_mul_f32 v133, v133, v18
  v_mul_f32 v134, v134, v18
  v_mul_f32 v135, v135, v18
  v_mul_f32 v136, v136, v18
  v_mul_f32 v137, v137, v18
  v_mul_f32 v138, v138, v18
  v_mul_f32 v139, v139, v18
  v_mul_f32 v140, v140, v18
  v_mul_f32 v141, v141, v18
  v_mul_f32 v142, v142, v18
  v_mul_f32 v143, v143, v18
  v_mul_f32 v160, v160, v18
  v_mul_f32 v161, v161, v18
  v_mul_f32 v162, v162, v18
  v_mul_f32 v163, v163, v18
  v_cvt_pk_bf16_f32 v224, v128, v129
  v_cvt_pk_bf16_f32 v225, v130, v131
  v_cvt_pk_bf16_f32 v226, v132, v133
  v_cvt_pk_bf16_f32 v227, v134, v135
  v_cvt_pk_bf16_f32 v228, v136, v137
  v_cvt_pk_bf16_f32 v229, v138, v139
  v_cvt_pk_bf16_f32 v230, v140, v141
  v_cvt_pk_bf16_f32 v231, v142, v143
  v_cvt_pk_bf16_f32 v232, v160, v161
  v_cvt_pk_bf16_f32 v233, v162, v163
  s_add_u32 s43, s62, 4096
  v_mfma_f32_32x32x16_bf16 v[32:47], v[96:99], v[224:227], 0
  v_mfma_f32_32x32x16_bf16 v[32:47], v[100:103], v[228:231], v[32:47]
  v_mfma_f32_32x32x16_bf16 v[32:47], v[236:239], v[232:235], v[32:47]
  v_mfma_f32_32x32x16_bf16 v[48:63], v[104:107], v[224:227], 0
  v_mfma_f32_32x32x16_bf16 v[48:63], v[108:111], v[228:231], v[48:63]
  v_cvt_pk_bf16_f32 v32, v32, v33
  v_cvt_pk_bf16_f32 v33, v34, v35
  v_cvt_pk_bf16_f32 v34, v36, v37
  v_cvt_pk_bf16_f32 v35, v38, v39
  v_cvt_pk_bf16_f32 v36, v40, v41
  v_cvt_pk_bf16_f32 v37, v42, v43
  v_cvt_pk_bf16_f32 v38, v44, v45
  v_cvt_pk_bf16_f32 v39, v46, v47
  v_mfma_f32_32x32x16_bf16 v[48:63], v[240:243], v[232:235], v[48:63]
  buffer_store_dwordx4 v[32:35], v14, s[4:7], s62 offen offset:0 sc1
  buffer_store_dwordx4 v[36:39], v14, s[4:7], s62 offen offset:1024 sc1
  v_mfma_f32_32x32x16_bf16 v[64:79], v[112:115], v[224:227], 0
  v_mfma_f32_32x32x16_bf16 v[64:79], v[116:119], v[228:231], v[64:79]
  v_cvt_pk_bf16_f32 v48, v48, v49
  v_cvt_pk_bf16_f32 v49, v50, v51
  v_cvt_pk_bf16_f32 v50, v52, v53
  v_cvt_pk_bf16_f32 v51, v54, v55
  v_cvt_pk_bf16_f32 v52, v56, v57
  v_cvt_pk_bf16_f32 v53, v58, v59
  v_cvt_pk_bf16_f32 v54, v60, v61
  v_cvt_pk_bf16_f32 v55, v62, v63
  v_mfma_f32_32x32x16_bf16 v[64:79], v[244:247], v[232:235], v[64:79]
  buffer_store_dwordx4 v[48:51], v14, s[4:7], s62 offen offset:2048 sc1
  buffer_store_dwordx4 v[52:55], v14, s[4:7], s62 offen offset:3072 sc1
  v_mfma_f32_32x32x16_bf16 v[80:95], v[120:123], v[224:227], 0
  v_mfma_f32_32x32x16_bf16 v[80:95], v[124:127], v[228:231], v[80:95]
  v_cvt_pk_bf16_f32 v64, v64, v65
  v_cvt_pk_bf16_f32 v65, v66, v67
  v_cvt_pk_bf16_f32 v66, v68, v69
  v_cvt_pk_bf16_f32 v67, v70, v71
  v_cvt_pk_bf16_f32 v68, v72, v73
  v_cvt_pk_bf16_f32 v69, v74, v75
  v_cvt_pk_bf16_f32 v70, v76, v77
  v_cvt_pk_bf16_f32 v71, v78, v79
  v_mfma_f32_32x32x16_bf16 v[80:95], v[248:251], v[232:235], v[80:95]
  buffer_store_dwordx4 v[64:67], v14, s[4:7], s43 offen offset:0 sc1
  buffer_store_dwordx4 v[68:71], v14, s[4:7], s43 offen offset:1024 sc1
  s_nop 9
  v_cvt_pk_bf16_f32 v80, v80, v81
  v_cvt_pk_bf16_f32 v81, v82, v83
  v_cvt_pk_bf16_f32 v82, v84, v85
  v_cvt_pk_bf16_f32 v83, v86, v87
  buffer_store_dwordx4 v[80:83], v14, s[4:7], s43 offen offset:2048 sc1
  v_cvt_pk_bf16_f32 v84, v88, v89
  v_cvt_pk_bf16_f32 v85, v90, v91
  v_cvt_pk_bf16_f32 v86, v92, v93
  v_cvt_pk_bf16_f32 v87, v94, v95
  buffer_store_dwordx4 v[84:87], v14, s[4:7], s43 offen offset:3072 sc1
L_hp2_joined_162:
  s_lshl_b32 s42, s46, 7
  s_add_u32 s42, s42, 0x4004000
  s_waitcnt vmcnt(0)
  buffer_atomic_add v11, v10, s[4:7], s42 offen sc1
  s_add_u32 s46, s46, 12
  s_branch L_hp2_152
L_hp2_done_153:
  s_branch L_end
L_f:
  s_cmp_ge_u32 s20, 224
  s_cbranch_scc1 L_g
  s_cmp_lg_u32 s21, 0
  s_cbranch_scc1 L_mode_ok_163
  s_mov_b32 s15, 200000
  v_and_b32 v25, 63, v0
  v_lshlrev_b32 v25, 2, v25
L_rdy_top_164:
  buffer_load_dword v24, v25, s[8:11], 0 offen sc1
  s_waitcnt vmcnt(0)
  v_readlane_b32 s16, v24, 8
  v_readlane_b32 s17, v24, 36
  s_add_u32 s16, s16, s17
  v_readlane_b32 s17, v24, 37
  s_add_u32 s16, s16, s17
  v_readlane_b32 s17, v24, 38
  s_add_u32 s16, s16, s17
  v_readlane_b32 s17, v24, 39
  s_add_u32 s16, s16, s17
  s_cmp_ge_u32 s16, 256
  s_cbranch_scc1 L_rdy_out_165
  s_sub_u32 s15, s15, 1
  s_cmp_lg_u32 s15, 0
  s_cbranch_scc1 L_rdy_top_164
L_rdy_out_165:
  buffer_load_dword v24, v25, s[8:11], 0 offen sc1
  s_waitcnt vmcnt(0)
  v_cmp_ne_u32 vcc, 32, v24
  s_and_b32 s15, vcc_hi, 0xfe
  s_and_b32 vcc_lo, vcc_lo, 1
  s_or_b32 s15, s15, vcc_lo
  s_cmp_lg_u32 s15, 0
  s_cbranch_scc1 L_fallback
L_mode_ok_163:
  s_and_b32 s30, s20, 7
  s_lshl_b32 s30, s30, 10
  s_add_u32 s30, s30, 0x4002104
  s_cmp_lg_u32 s14, 0
  s_cbranch_scc1 L_w0w_out_167
  s_mov_b32 s15, 20000
L_w0w_top_166:
  buffer_load_dword v20, off, s[4:7], s30 sc1
  s_waitcnt vmcnt(0)
  v_readfirstlane_b32 s16, v20
  s_cmp_ge_u32 s16, 1
  s_cbranch_scc1 L_w0w_out_167
  s_sleep 32
  s_sub_u32 s15, s15, 1
  s_cmp_lg_u32 s15, 0
  s_cbranch_scc1 L_w0w_top_166
L_w0w_out_167:
  s_barrier
  s_sub_u32 s42, s20, 128
  s_lshr_b32 s44, s42, 4
  s_and_b32 s45, s42, 15
  s_load_dwordx2 s[24:25], s[0:1], 64
  s_mov_b32 s26, 0x158000
  s_mov_b32 s27, 0x20000
  s_load_dwordx2 s[28:29], s[0:1], 72
  s_mov_b32 s30, 0x158000
  s_mov_b32 s31, 0x20000
  s_load_dwordx2 s[36:37], s[0:1], 0
  s_mov_b32 s38, 0x200000
  s_mov_b32 s39, 0x20000
  v_mov_b32 v1, 0x0
  v_bfe_u32 v12, v0, 0, 4
  v_mad_i32_i24 v1, v12, 16, v1
  v_bfe_u32 v12, v0, 4, 2
  s_mov_b32 s42, 0xb00
  v_mad_i32_i24 v1, v12, s42, v1
  v_bfe_u32 v12, v0, 2, 1
  v_bfe_u32 v13, v0, 4, 1
  v_and_b32 v12, v12, v13
  s_mov_b32 s42, 0xffffff80
  v_mad_i32_i24 v1, v12, s42, v1
  v_bfe_u32 v12, v0, 3, 1
  v_bfe_u32 v13, v0, 5, 1
  v_and_b32 v12, v12, v13
  s_mov_b32 s42, 0xffffff00
  v_mad_i32_i24 v1, v12, s42, v1
  v_mov_b32 v2, 0x0
  v_bfe_u32 v12, v0, 0, 1
  v_mad_i32_i24 v2, v12, 16, v2
  v_bfe_u32 v12, v0, 1, 1
  v_mad_i32_i24 v2, v12, 8, v2
  v_bfe_u32 v12, v0, 2, 2
  s_mov_b32 s42, 0x140
  v_mad_i32_i24 v2, v12, s42, v2
  v_bfe_u32 v12, v0, 4, 1
  v_mad_i32_i24 v2, v12, 32, v2
  v_bfe_u32 v12, v0, 5, 1
  s_mov_b32 s42, 0x800
  v_mad_i32_i24 v2, v12, s42, v2
  v_bfe_u32 v12, v0, 6, 2
  v_mad_i32_i24 v2, v12, 64, v2
  v_bfe_u32 v12, v0, 2, 1
  v_bfe_u32 v13, v0, 6, 1
  v_and_b32 v12, v12, v13
  s_mov_b32 s42, 0xffffff80
  v_mad_i32_i24 v2, v12, s42, v2
  v_bfe_u32 v12, v0, 3, 1
  v_bfe_u32 v13, v0, 7, 1
  v_and_b32 v12, v12, v13
  s_mov_b32 s42, 0xffffff00
  v_mad_i32_i24 v2, v12, s42, v2
  v_mov_b32 v4, 0x0
  v_bfe_u32 v12, v0, 0, 2
  v_mad_i32_i24 v4, v12, 8, v4
  v_bfe_u32 v12, v0, 2, 2
  s_mov_b32 s42, 0x140
  v_mad_i32_i24 v4, v12, s42, v4
  v_bfe_u32 v12, v0, 4, 1
  v_mad_i32_i24 v4, v12, 32, v4
  v_bfe_u32 v12, v0, 5, 1
  s_mov_b32 s42, 0x800
  v_mad_i32_i24 v4, v12, s42, v4
  v_bfe_u32 v12, v0, 6, 2
  v_mad_i32_i24 v4, v12, 64, v4
  v_bfe_u32 v12, v0, 2, 1
  v_bfe_u32 v13, v0, 6, 1
  v_and_b32 v12, v12, v13
  s_mov_b32 s42, 0xffffff80
  v_mad_i32_i24 v4, v12, s42, v4
  v_bfe_u32 v12, v0, 3, 1
  v_bfe_u32 v13, v0, 7, 1
  v_and_b32 v12, v12, v13
  s_mov_b32 s42, 0xffffff00
  v_mad_i32_i24 v4, v12, s42, v4
  v_add_u32 v3, 0x10000, v2
  v_add_u32 v5, 0x10000, v4
  s_lshl_b32 s41, s14, 13
  v_mov_b32 v6, 0x0
  v_bfe_u32 v12, v0, 0, 6
  v_mad_i32_i24 v6, v12, 16, v6
  v_mov_b32 v7, 0x0
  v_bfe_u32 v12, v0, 0, 5
  s_mov_b32 s42, 0x410
  v_mad_i32_i24 v7, v12, s42, v7
  v_bfe_u32 v12, v0, 5, 1
  v_mad_i32_i24 v7, v12, 16, v7
  v_and_b32 v12, 63, v0
  v_mov_b32 v13, 0x40000000
  v_cmp_ne_u32 vcc, 0, v12
  s_nop 1
  v_cndmask_b32 v10, v12, v13, vcc
  v_mov_b32 v11, 1
  s_mul_i32 s40, s14, 88064
  s_lshl_b32 s42, s45, 8
  s_add_u32 s40, s40, s42
  s_lshl_b32 s47, s44, 15
  s_lshl_b32 s42, s14, 13
  s_add_u32 s47, s47, s42
  s_mul_i32 s48, s14, 8320
  s_add_u32 s48, s48, 99328
  s_waitcnt lgkmcnt(0)
  s_cmp_gt_u32 s45, 10
  s_cbranch_scc1 L_f0w_skip_168
  s_add_u32 s42, s40, 0x0
  s_add_u32 m0, s41, 0
  s_nop 0
  buffer_load_dwordx4 v1, s[24:27], s42 offen lds
  s_add_u32 s42, s40, 0x2b00
  s_add_u32 m0, s41, 1024
  s_nop 0
  buffer_load_dwordx4 v1, s[24:27], s42 offen lds
  s_add_u32 s42, s40, 0x5600
  s_add_u32 m0, s41, 2048
  s_nop 0
  buffer_load_dwordx4 v1, s[24:27], s42 offen lds
  s_add_u32 s42, s40, 0x8100
  s_add_u32 m0, s41, 3072
  s_nop 0
  buffer_load_dwordx4 v1, s[24:27], s42 offen lds
  s_add_u32 s42, s40, 0xac00
  s_add_u32 m0, s41, 4096
  s_nop 0
  buffer_load_dwordx4 v1, s[24:27], s42 offen lds
  s_add_u32 s42, s40, 0xd700
  s_add_u32 m0, s41, 5120
  s_nop 0
  buffer_load_dwordx4 v1, s[24:27], s42 offen lds
  s_add_u32 s42, s40, 0x10200
  s_add_u32 m0, s41, 6144
  s_nop 0
  buffer_load_dwordx4 v1, s[24:27], s42 offen lds
  s_add_u32 s42, s40, 0x12d00
  s_add_u32 m0, s41, 7168
  s_nop 0
  buffer_load_dwordx4 v1, s[24:27], s42 offen lds
  s_add_u32 s42, s40, 0x56000
  s_add_u32 m0, s41, 32768
  s_nop 0
  buffer_load_dwordx4 v1, s[24:27], s42 offen lds
  s_add_u32 s42, s40, 0x58b00
  s_add_u32 m0, s41, 33792
  s_nop 0
  buffer_load_dwordx4 v1, s[24:27], s42 offen lds
  s_add_u32 s42, s40, 0x5b600
  s_add_u32 m0, s41, 34816
  s_nop 0
  buffer_load_dwordx4 v1, s[24:27], s42 offen lds
  s_add_u32 s42, s40, 0x5e100
  s_add_u32 m0, s41, 35840
  s_nop 0
  buffer_load_dwordx4 v1, s[24:27], s42 offen lds
  s_add_u32 s42, s40, 0x60c00
  s_add_u32 m0, s41, 36864
  s_nop 0
  buffer_load_dwordx4 v1, s[24:27], s42 offen lds
  s_add_u32 s42, s40, 0x63700
  s_add_u32 m0, s41, 37888
  s_nop 0
  buffer_load_dwordx4 v1, s[24:27], s42 offen lds
  s_add_u32 s42, s40, 0x66200
  s_add_u32 m0, s41, 38912
  s_nop 0
  buffer_load_dwordx4 v1, s[24:27], s42 offen lds
  s_add_u32 s42, s40, 0x68d00
  s_add_u32 m0, s41, 39936
  s_nop 0
  buffer_load_dwordx4 v1, s[24:27], s42 offen lds
  s_add_u32 m0, s48, 0
  s_nop 0
  buffer_load_dwordx4 v6, s[36:39], s47 offen offset:0 lds
  s_add_u32 m0, s48, 16
  s_nop 0
  buffer_load_dwordx4 v6, s[36:39], s47 offen offset:1024 lds
  s_add_u32 m0, s48, 32
  s_nop 0
  buffer_load_dwordx4 v6, s[36:39], s47 offen offset:2048 lds
  s_add_u32 m0, s48, 48
  s_nop 0
  buffer_load_dwordx4 v6, s[36:39], s47 offen offset:3072 lds
  s_add_u32 s42, s47, 4096
  s_add_u32 m0, s48, 4160
  s_nop 0
  buffer_load_dwordx4 v6, s[36:39], s42 offen offset:0 lds
  s_add_u32 m0, s48, 4176
  s_nop 0
  buffer_load_dwordx4 v6, s[36:39], s42 offen offset:1024 lds
  s_add_u32 m0, s48, 4192
  s_nop 0
  buffer_load_dwordx4 v6, s[36:39], s42 offen offset:2048 lds
  s_add_u32 m0, s48, 4208
  s_nop 0
  buffer_load_dwordx4 v6, s[36:39], s42 offen offset:3072 lds
  s_waitcnt vmcnt(16)
  s_waitcnt lgkmcnt(0)
  s_barrier
  s_add_u32 s42, s40, 0xac000
  s_add_u32 m0, s41, 65536
  s_nop 0
  buffer_load_dwordx4 v1, s[24:27], s42 offen lds
  s_add_u32 s42, s40, 0xaeb00
  s_add_u32 m0, s41, 66560
  s_nop 0
  buffer_load_dwordx4 v1, s[24:27], s42 offen lds
  s_add_u32 s42, s40, 0xb1600
  s_add_u32 m0, s41, 67584
  s_nop 0
  buffer_load_dwordx4 v1, s[24:27], s42 offen lds
  s_add_u32 s42, s40, 0xb4100
  s_add_u32 m0, s41, 68608
  s_nop 0
  buffer_load_dwordx4 v1, s[24:27], s42 offen lds
  s_add_u32 s42, s40, 0xb6c00
  s_add_u32 m0, s41, 69632
  s_nop 0
  buffer_load_dwordx4 v1, s[24:27], s42 offen lds
  s_add_u32 s42, s40, 0xb9700
  s_add_u32 m0, s41, 70656
  s_nop 0
  buffer_load_dwordx4 v1, s[24:27], s42 offen lds
  s_add_u32 s42, s40, 0xbc200
  s_add_u32 m0, s41, 71680
  s_nop 0
  buffer_load_dwordx4 v1, s[24:27], s42 offen lds
  s_add_u32 s42, s40, 0xbed00
  s_add_u32 m0, s41, 72704
  s_nop 0
  buffer_load_dwordx4 v1, s[24:27], s42 offen lds
  ds_read_b64_tr_b16 a[0:1], v2 offset:0
  ds_read_b64_tr_b16 a[2:3], v2 offset:1024
  ds_read_b64_tr_b16 a[4:5], v2 offset:4096
  ds_read_b64_tr_b16 a[6:7], v2 offset:5120
  ds_read_b64_tr_b16 a[8:9], v2 offset:8192
  ds_read_b64_tr_b16 a[10:11], v2 offset:9216
  ds_read_b64_tr_b16 a[12:13], v2 offset:12288
  ds_read_b64_tr_b16 a[14:15], v2 offset:13312
  ds_read_b64_tr_b16 a[16:17], v2 offset:16384
  ds_read_b64_tr_b16 a[18:19], v2 offset:17408
  ds_read_b64_tr_b16 a[20:21], v2 offset:20480
  ds_read_b64_tr_b16 a[22:23], v2 offset:21504
  ds_read_b64_tr_b16 a[24:25], v2 offset:24576
  ds_read_b64_tr_b16 a[26:27], v2 offset:25600
  ds_read_b64_tr_b16 a[28:29], v2 offset:28672
  ds_read_b64_tr_b16 a[30:31], v2 offset:29696
  s_waitcnt vmcnt(16)
  s_waitcnt lgkmcnt(0)
  s_barrier
  s_add_u32 s42, s40, 0x102000
  s_add_u32 m0, s41, 0
  s_nop 0
  buffer_load_dwordx4 v1, s[24:27], s42 offen lds
  s_add_u32 s42, s40, 0x104b00
  s_add_u32 m0, s41, 1024
  s_nop 0
  buffer_load_dwordx4 v1, s[24:27], s42 offen lds
  s_add_u32 s42, s40, 0x107600
  s_add_u32 m0, s41, 2048
  s_nop 0
  buffer_load_dwordx4 v1, s[24:27], s42 offen lds
  s_add_u32 s42, s40, 0x10a100
  s_add_u32 m0, s41, 3072
  s_nop 0
  buffer_load_dwordx4 v1, s[24:27], s42 offen lds
  s_add_u32 s42, s40, 0x10cc00
  s_add_u32 m0, s41, 4096
  s_nop 0
  buffer_load_dwordx4 v1, s[24:27], s42 offen lds
  s_add_u32 s42, s40, 0x10f700
  s_add_u32 m0, s41, 5120
  s_nop 0
  buffer_load_dwordx4 v1, s[24:27], s42 offen lds
  s_add_u32 s42, s40, 0x112200
  s_add_u32 m0, s41, 6144
  s_nop 0
  buffer_load_dwordx4 v1, s[24:27], s42 offen lds
  s_add_u32 s42, s40, 0x114d00
  s_add_u32 m0, s41, 7168
  s_nop 0
  buffer_load_dwordx4 v1, s[24:27], s42 offen lds
  ds_read_b64_tr_b16 a[32:33], v2 offset:32768
  ds_read_b64_tr_b16 a[34:35], v2 offset:33792
  ds_read_b64_tr_b16 a[36:37], v2 offset:36864
  ds_read_b64_tr_b16 a[38:39], v2 offset:37888
  ds_read_b64_tr_b16 a[40:41], v2 offset:40960
  ds_read_b64_tr_b16 a[42:43], v2 offset:41984
  ds_read_b64_tr_b16 a[44:45], v2 offset:45056
  ds_read_b64_tr_b16 a[46:47], v2 offset:46080
  ds_read_b64_tr_b16 a[48:49], v2 offset:49152
  ds_read_b64_tr_b16 a[50:51], v2 offset:50176
  ds_read_b64_tr_b16 a[52:53], v2 offset:53248
  ds_read_b64_tr_b16 a[54:55], v2 offset:54272
  ds_read_b64_tr_b16 a[56:57], v2 offset:57344
  ds_read_b64_tr_b16 a[58:59], v2 offset:58368
  ds_read_b64_tr_b16 a[60:61], v2 offset:61440
  ds_read_b64_tr_b16 a[62:63], v2 offset:62464
  s_waitcnt vmcnt(8)
  s_waitcnt lgkmcnt(0)
  s_barrier
  s_add_u32 s42, s40, 0x0
  s_add_u32 m0, s41, 32768
  s_nop 0
  buffer_load_dwordx4 v1, s[28:31], s42 offen lds
  s_add_u32 s42, s40, 0x2b00
  s_add_u32 m0, s41, 33792
  s_nop 0
  buffer_load_dwordx4 v1, s[28:31], s42 offen lds
  s_add_u32 s42, s40, 0x5600
  s_add_u32 m0, s41, 34816
  s_nop 0
  buffer_load_dwordx4 v1, s[28:31], s42 offen lds
  s_add_u32 s42, s40, 0x8100
  s_add_u32 m0, s41, 35840
  s_nop 0
  buffer_load_dwordx4 v1, s[28:31], s42 offen lds
  s_add_u32 s42, s40, 0xac00
  s_add_u32 m0, s41, 36864
  s_nop 0
  buffer_load_dwordx4 v1, s[28:31], s42 offen lds
  s_add_u32 s42, s40, 0xd700
  s_add_u32 m0, s41, 37888
  s_nop 0
  buffer_load_dwordx4 v1, s[28:31], s42 offen lds
  s_add_u32 s42, s40, 0x10200
  s_add_u32 m0, s41, 38912
  s_nop 0
  buffer_load_dwordx4 v1, s[28:31], s42 offen lds
  s_add_u32 s42, s40, 0x12d00
  s_add_u32 m0, s41, 39936
  s_nop 0
  buffer_load_dwordx4 v1, s[28:31], s42 offen lds
  ds_read_b64_tr_b16 a[64:65], v3 offset:0
  ds_read_b64_tr_b16 a[66:67], v3 offset:1024
  ds_read_b64_tr_b16 a[68:69], v3 offset:4096
  ds_read_b64_tr_b16 a[70:71], v3 offset:5120
  ds_read_b64_tr_b16 a[72:73], v3 offset:8192
  ds_read_b64_tr_b16 a[74:75], v3 offset:9216
  ds_read_b64_tr_b16 a[76:77], v3 offset:12288
  ds_read_b64_tr_b16 a[78:79], v3 offset:13312
  ds_read_b64_tr_b16 a[80:81], v3 offset:16384
  ds_read_b64_tr_b16 a[82:83], v3 offset:17408
  ds_read_b64_tr_b16 a[84:85], v3 offset:20480
  ds_read_b64_tr_b16 a[86:87], v3 offset:21504
  ds_read_b64_tr_b16 a[88:89], v3 offset:24576
  ds_read_b64_tr_b16 a[90:91], v3 offset:25600
  ds_read_b64_tr_b16 a[92:93], v3 offset:28672
  ds_read_b64_tr_b16 a[94:95], v3 offset:29696
  s_waitcnt vmcnt(8)
  s_waitcnt lgkmcnt(0)
  s_barrier
  s_add_u32 s42, s40, 0x56000
  s_add_u32 m0, s41, 65536
  s_nop 0
  buffer_load_dwordx4 v1, s[28:31], s42 offen lds
  s_add_u32 s42, s40, 0x58b00
  s_add_u32 m0, s41, 66560
  s_nop 0
  buffer_load_dwordx4 v1, s[28:31], s42 offen lds
  s_add_u32 s42, s40, 0x5b600
  s_add_u32 m0, s41, 67584
  s_nop 0
  buffer_load_dwordx4 v1, s[28:31], s42 offen lds
  s_add_u32 s42, s40, 0x5e100
  s_add_u32 m0, s41, 68608
  s_nop 0
  buffer_load_dwordx4 v1, s[28:31], s42 offen lds
  s_add_u32 s42, s40, 0x60c00
  s_add_u32 m0, s41, 69632
  s_nop 0
  buffer_load_dwordx4 v1, s[28:31], s42 offen lds
  s_add_u32 s42, s40, 0x63700
  s_add_u32 m0, s41, 70656
  s_nop 0
  buffer_load_dwordx4 v1, s[28:31], s42 offen lds
  s_add_u32 s42, s40, 0x66200
  s_add_u32 m0, s41, 71680
  s_nop 0
  buffer_load_dwordx4 v1, s[28:31], s42 offen lds
  s_add_u32 s42, s40, 0x68d00
  s_add_u32 m0, s41, 72704
  s_nop 0
  buffer_load_dwordx4 v1, s[28:31], s42 offen lds
  ds_read_b64_tr_b16 a[96:97], v2 offset:0
  ds_read_b64_tr_b16 a[98:99], v2 offset:1024
  ds_read_b64_tr_b16 a[100:101], v2 offset:4096
  ds_read_b64_tr_b16 a[102:103], v2 offset:5120
  ds_read_b64_tr_b16 a[104:105], v2 offset:8192
  ds_read_b64_tr_b16 a[106:107], v2 offset:9216
  ds_read_b64_tr_b16 a[108:109], v2 offset:12288
  ds_read_b64_tr_b16 a[110:111], v2 offset:13312
  ds_read_b64_tr_b16 a[112:113], v2 offset:16384
  ds_read_b64_tr_b16 a[114:115], v2 offset:17408
  ds_read_b64_tr_b16 a[116:117], v2 offset:20480
  ds_read_b64_tr_b16 a[118:119], v2 offset:21504
  ds_read_b64_tr_b16 a[120:121], v2 offset:24576
  ds_read_b64_tr_b16 a[122:123], v2 offset:25600
  ds_read_b64_tr_b16 a[124:125], v2 offset:28672
  ds_read_b64_tr_b16 a[126:127], v2 offset:29696
  s_waitcnt vmcnt(8)
  s_waitcnt lgkmcnt(0)
  s_barrier
  s_add_u32 s42, s40, 0xac000
  s_add_u32 m0, s41, 0
  s_nop 0
  buffer_load_dwordx4 v1, s[28:31], s42 offen lds
  s_add_u32 s42, s40, 0xaeb00
  s_add_u32 m0, s41, 1024
  s_nop 0
  buffer_load_dwordx4 v1, s[28:31], s42 offen lds
  s_add_u32 s42, s40, 0xb1600
  s_add_u32 m0, s41, 2048
  s_nop 0
  buffer_load_dwordx4 v1, s[28:31], s42 offen lds
  s_add_u32 s42, s40, 0xb4100
  s_add_u32 m0, s41, 3072
  s_nop 0
  buffer_load_dwordx4 v1, s[28:31], s42 offen lds
  s_add_u32 s42, s40, 0xb6c00
  s_add_u32 m0, s41, 4096
  s_nop 0
  buffer_load_dwordx4 v1, s[28:31], s42 offen lds
  s_add_u32 s42, s40, 0xb9700
  s_add_u32 m0, s41, 5120
  s_nop 0
  buffer_load_dwordx4 v1, s[28:31], s42 offen lds
  s_add_u32 s42, s40, 0xbc200
  s_add_u32 m0, s41, 6144
  s_nop 0
  buffer_load_dwordx4 v1, s[28:31], s42 offen lds
  s_add_u32 s42, s40, 0xbed00
  s_add_u32 m0, s41, 7168
  s_nop 0
  buffer_load_dwordx4 v1, s[28:31], s42 offen lds
  ds_read_b64_tr_b16 a[128:129], v2 offset:32768
  ds_read_b64_tr_b16 a[130:131], v2 offset:33792
  ds_read_b64_tr_b16 a[132:133], v2 offset:36864
  ds_read_b64_tr_b16 a[134:135], v2 offset:37888
  ds_read_b64_tr_b16 a[136:137], v2 offset:40960
  ds_read_b64_tr_b16 a[138:139], v2 offset:41984
  ds_read_b64_tr_b16 a[140:141], v2 offset:45056
  ds_read_b64_tr_b16 a[142:143], v2 offset:46080
  ds_read_b64_tr_b16 a[144:145], v2 offset:49152
  ds_read_b64_tr_b16 a[146:147], v2 offset:50176
  ds_read_b64_tr_b16 a[148:149], v2 offset:53248
  ds_read_b64_tr_b16 a[150:151], v2 offset:54272
  ds_read_b64_tr_b16 a[152:153], v2 offset:57344
  ds_read_b64_tr_b16 a[154:155], v2 offset:58368
  ds_read_b64_tr_b16 a[156:157], v2 offset:61440
  ds_read_b64_tr_b16 a[158:159], v2 offset:62464
  s_waitcnt vmcnt(8)
  s_waitcnt lgkmcnt(0)
  s_barrier
  s_add_u32 s42, s40, 0x102000
  s_add_u32 m0, s41, 32768
  s_nop 0
  buffer_load_dwordx4 v1, s[28:31], s42 offen lds
  s_add_u32 s42, s40, 0x104b00
  s_add_u32 m0, s41, 33792
  s_nop 0
  buffer_load_dwordx4 v1, s[28:31], s42 offen lds
  s_add_u32 s42, s40, 0x107600
  s_add_u32 m0, s41, 34816
  s_nop 0
  buffer_load_dwordx4 v1, s[28:31], s42 offen lds
  s_add_u32 s42, s40, 0x10a100
  s_add_u32 m0, s41, 35840
  s_nop 0
  buffer_load_dwordx4 v1, s[28:31], s42 offen lds
  s_add_u32 s42, s40, 0x10cc00
  s_add_u32 m0, s41, 36864
  s_nop 0
  buffer_load_dwordx4 v1, s[28:31], s42 offen lds
  s_add_u32 s42, s40, 0x10f700
  s_add_u32 m0, s41, 37888
  s_nop 0
  buffer_load_dwordx4 v1, s[28:31], s42 offen lds
  s_add_u32 s42, s40, 0x112200
  s_add_u32 m0, s41, 38912
  s_nop 0
  buffer_load_dwordx4 v1, s[28:31], s42 offen lds
  s_add_u32 s42, s40, 0x114d00
  s_add_u32 m0, s41, 39936
  s_nop 0
  buffer_load_dwordx4 v1, s[28:31], s42 offen lds
  ds_read_b64_tr_b16 a[160:161], v3 offset:0
  ds_read_b64_tr_b16 a[162:163], v3 offset:1024
  ds_read_b64_tr_b16 a[164:165], v3 offset:4096
  ds_read_b64_tr_b16 a[166:167], v3 offset:5120
  ds_read_b64_tr_b16 a[168:169], v3 offset:8192
  ds_read_b64_tr_b16 a[170:171], v3 offset:9216
  ds_read_b64_tr_b16 a[172:173], v3 offset:12288
  ds_read_b64_tr_b16 a[174:175], v3 offset:13312
  ds_read_b64_tr_b16 a[176:177], v3 offset:16384
  ds_read_b64_tr_b16 a[178:179], v3 offset:17408
  ds_read_b64_tr_b16 a[180:181], v3 offset:20480
  ds_read_b64_tr_b16 a[182:183], v3 offset:21504
  ds_read_b64_tr_b16 a[184:185], v3 offset:24576
  ds_read_b64_tr_b16 a[186:187], v3 offset:25600
  ds_read_b64_tr_b16 a[188:189], v3 offset:28672
  ds_read_b64_tr_b16 a[190:191], v3 offset:29696
  s_waitcnt vmcnt(8)
  s_waitcnt lgkmcnt(0)
  s_barrier
  ds_read_b64_tr_b16 a[192:193], v2 offset:0
  ds_read_b64_tr_b16 a[194:195], v2 offset:1024
  ds_read_b64_tr_b16 a[196:197], v2 offset:4096
  ds_read_b64_tr_b16 a[198:199], v2 offset:5120
  ds_read_b64_tr_b16 a[200:201], v2 offset:8192
  ds_read_b64_tr_b16 a[202:203], v2 offset:9216
  ds_read_b64_tr_b16 a[204:205], v2 offset:12288
  ds_read_b64_tr_b16 a[206:207], v2 offset:13312
  ds_read_b64_tr_b16 a[208:209], v2 offset:16384
  ds_read_b64_tr_b16 a[210:211], v2 offset:17408
  ds_read_b64_tr_b16 a[212:213], v2 offset:20480
  ds_read_b64_tr_b16 a[214:215], v2 offset:21504
  ds_read_b64_tr_b16 a[216:217], v2 offset:24576
  ds_read_b64_tr_b16 a[218:219], v2 offset:25600
  ds_read_b64_tr_b16 a[220:221], v2 offset:28672
  ds_read_b64_tr_b16 a[222:223], v2 offset:29696
  s_waitcnt vmcnt(0)
  s_waitcnt lgkmcnt(0)
  s_barrier
  ds_read_b64_tr_b16 a[224:225], v2 offset:32768
  ds_read_b64_tr_b16 a[226:227], v2 offset:33792
  ds_read_b64_tr_b16 a[228:229], v2 offset:36864
  ds_read_b64_tr_b16 a[230:231], v2 offset:37888
  ds_read_b64_tr_b16 a[232:233], v2 offset:40960
  ds_read_b64_tr_b16 a[234:235], v2 offset:41984
  ds_read_b64_tr_b16 a[236:237], v2 offset:45056
  ds_read_b64_tr_b16 a[238:239], v2 offset:46080
  ds_read_b64_tr_b16 a[240:241], v2 offset:49152
  ds_read_b64_tr_b16 a[242:243], v2 offset:50176
  ds_read_b64_tr_b16 a[244:245], v2 offset:53248
  ds_read_b64_tr_b16 a[246:247], v2 offset:54272
  ds_read_b64_tr_b16 a[248:249], v2 offset:57344
  ds_read_b64_tr_b16 a[250:251], v2 offset:58368
  ds_read_b64_tr_b16 a[252:253], v2 offset:61440
  ds_read_b64_tr_b16 a[254:255], v2 offset:62464
  s_waitcnt lgkmcnt(0)
L_f0w_skip_168:
  s_cmp_gt_u32 s45, 10
  s_cbranch_scc1 L_f0_skip_169
  v_mov_b32 v8, 0x0
  v_bfe_u32 v12, v0, 0, 6
  v_mad_i32_i24 v8, v12, 16, v8
  v_bfe_u32 v12, v0, 6, 2
  s_mov_b32 s42, 0x800
  v_mad_i32_i24 v8, v12, s42, v8
  s_lshl_b32 s42, s45, 13
  v_add_u32 v8, s42, v8
  s_lshl_b32 s42, s45, 2
  s_add_u32 s42, s42, s14
  s_cmp_lt_u32 s42, 43
  s_cbranch_scc1 L_f0_nomask_170
  v_mov_b32 v8, 0x40000000
  v_mov_b32 v10, 0x40000000
L_f0_nomask_170:
  s_mov_b32 s46, s44
  s_cmp_lt_u32 s44, 4
  s_cselect_b32 s52, 11, 10
  s_mov_b32 s50, 0x4200000
  v_mov_b32 v23, 0x40000000
  s_mov_b32 s49, -99328
  v_add_u32 v7, 99328, v7
  s_mov_b32 s60, 0xbfb8aa3b
L_f0_171:
  s_waitcnt vmcnt(3)
  s_barrier
  s_add_u32 s48, s48, s49
  s_add_u32 s43, s46, 6
  s_min_u32 s43, s43, 63
  s_lshl_b32 s47, s43, 15
  s_lshl_b32 s43, s14, 13
  s_add_u32 s47, s47, s43
  s_add_u32 m0, s48, 0
  s_nop 0
  buffer_load_dwordx4 v6, s[36:39], s47 offen offset:0 lds
  s_add_u32 m0, s48, 16
  s_nop 0
  buffer_load_dwordx4 v6, s[36:39], s47 offen offset:1024 lds
  s_add_u32 m0, s48, 32
  s_nop 0
  buffer_load_dwordx4 v6, s[36:39], s47 offen offset:2048 lds
  s_add_u32 m0, s48, 48
  s_nop 0
  buffer_load_dwordx4 v6, s[36:39], s47 offen offset:3072 lds
  s_add_u32 s42, s47, 4096
  s_add_u32 m0, s48, 4160
  s_nop 0
  buffer_load_dwordx4 v6, s[36:39], s42 offen offset:0 lds
  s_add_u32 m0, s48, 4176
  s_nop 0
  buffer_load_dwordx4 v6, s[36:39], s42 offen offset:1024 lds
  s_add_u32 m0, s48, 4192
  s_nop 0
  buffer_load_dwordx4 v6, s[36:39], s42 offen offset:2048 lds
  s_add_u32 m0, s48, 4208
  s_nop 0
  buffer_load_dwordx4 v6, s[36:39], s42 offen offset:3072 lds
  ds_read_b128 v[80:83], v7 offset:0
  ds_read_b128 v[84:87], v7 offset:32
  ds_read_b128 v[88:91], v7 offset:64
  ds_read_b128 v[92:95], v7 offset:96
  s_waitcnt lgkmcnt(3)
  v_mfma_f32_32x32x16_bf16 v[32:47], a[0:3], v[80:83], 0
  ds_read_b128 v[96:99], v7 offset:128
  v_mfma_f32_32x32x16_bf16 v[48:63], a[128:131], v[80:83], 0
  s_waitcnt lgkmcnt(3)
  v_mfma_f32_32x32x16_bf16 v[32:47], a[4:7], v[84:87], v[32:47]
  ds_read_b128 v[100:103], v7 offset:160
  v_mfma_f32_32x32x16_bf16 v[48:63], a[132:135], v[84:87], v[48:63]
  s_waitcnt lgkmcnt(3)
  v_mfma_f32_32x32x16_bf16 v[32:47], a[8:11], v[88:91], v[32:47]
  ds_read_b128 v[104:107], v7 offset:192
  v_mfma_f32_32x32x16_bf16 v[48:63], a[136:139], v[88:91], v[48:63]
  s_waitcnt lgkmcnt(3)
  v_mfma_f32_32x32x16_bf16 v[32:47], a[12:15], v[92:95], v[32:47]
  ds_read_b128 v[108:111], v7 offset:224
  v_mfma_f32_32x32x16_bf16 v[48:63], a[140:143], v[92:95], v[48:63]
  s_waitcnt lgkmcnt(3)
  v_mfma_f32_32x32x16_bf16 v[32:47], a[16:19], v[96:99], v[32:47]
  ds_read_b128 v[80:83], v7 offset:256
  v_mfma_f32_32x32x16_bf16 v[48:63], a[144:147], v[96:99], v[48:63]
  s_waitcnt lgkmcnt(3)
  v_mfma_f32_32x32x16_bf16 v[32:47], a[20:23], v[100:103], v[32:47]
  ds_read_b128 v[84:87], v7 offset:288
  v_mfma_f32_32x32x16_bf16 v[48:63], a[148:151], v[100:103], v[48:63]
  s_waitcnt lgkmcnt(3)
  v_mfma_f32_32x32x16_bf16 v[32:47], a[24:27], v[104:107], v[32:47]
  ds_read_b128 v[88:91], v7 offset:320
  v_mfma_f32_32x32x16_bf16 v[48:63], a[152:155], v[104:107], v[48:63]
  s_waitcnt lgkmcnt(3)
  v_mfma_f32_32x32x16_bf16 v[32:47], a[28:31], v[108:111], v[32:47]
  ds_read_b128 v[92:95], v7 offset:352
  v_mfma_f32_32x32x16_bf16 v[48:63], a[156:159], v[108:111], v[48:63]
  s_waitcnt lgkmcnt(3)
  v_mfma_f32_32x32x16_bf16 v[32:47], a[32:35], v[80:83], v[32:47]
  ds_read_b128 v[96:99], v7 offset:384
  v_mfma_f32_32x32x16_bf16 v[48:63], a[160:163], v[80:83], v[48:63]
  s_waitcnt lgkmcnt(3)
  v_mfma_f32_32x32x16_bf16 v[32:47], a[36:39], v[84:87], v[32:47]
  ds_read_b128 v[100:103], v7 offset:416
  v_mfma_f32_32x32x16_bf16 v[48:63], a[164:167], v[84:87], v[48:63]
  s_waitcnt lgkmcnt(3)
  v_mfma_f32_32x32x16_bf16 v[32:47], a[40:43], v[88:91], v[32:47]
  ds_read_b128 v[104:107], v7 offset:448
  v_mfma_f32_32x32x16_bf16 v[48:63], a[168:171], v[88:91], v[48:63]
  s_waitcnt lgkmcnt(3)
  v_mfma_f32_32x32x16_bf16 v[32:47], a[44:47], v[92:95], v[32:47]
  ds_read_b128 v[108:111], v7 offset:480
  v_mfma_f32_32x32x16_bf16 v[48:63], a[172:175], v[92:95], v[48:63]
  s_waitcnt lgkmcnt(3)
  v_mfma_f32_32x32x16_bf16 v[32:47], a[48:51], v[96:99], v[32:47]
  ds_read_b128 v[80:83], v7 offset:512
  v_mfma_f32_32x32x16_bf16 v[48:63], a[176:179], v[96:99], v[48:63]
  s_waitcnt vmcnt(8)
  buffer_atomic_add v11, v23, s[4:7], s50 offen sc1
  v_mov_b32 v23, v10
  s_waitcnt lgkmcnt(3)
  v_mfma_f32_32x32x16_bf16 v[32:47], a[52:55], v[100:103], v[32:47]
  ds_read_b128 v[84:87], v7 offset:544
  v_mfma_f32_32x32x16_bf16 v[48:63], a[180:183], v[100:103], v[48:63]
  s_waitcnt lgkmcnt(3)
  v_mfma_f32_32x32x16_bf16 v[32:47], a[56:59], v[104:107], v[32:47]
  ds_read_b128 v[88:91], v7 offset:576
  v_mfma_f32_32x32x16_bf16 v[48:63], a[184:187], v[104:107], v[48:63]
  s_waitcnt lgkmcnt(3)
  v_mfma_f32_32x32x16_bf16 v[32:47], a[60:63], v[108:111], v[32:47]
  ds_read_b128 v[92:95], v7 offset:608
  v_mfma_f32_32x32x16_bf16 v[48:63], a[188:191], v[108:111], v[48:63]
  s_waitcnt lgkmcnt(3)
  v_mfma_f32_32x32x16_bf16 v[32:47], a[64:67], v[80:83], v[32:47]
  ds_read_b128 v[96:99], v7 offset:640
  v_mfma_f32_32x32x16_bf16 v[48:63], a[192:195], v[80:83], v[48:63]
  s_waitcnt lgkmcnt(3)
  v_mfma_f32_32x32x16_bf16 v[32:47], a[68:71], v[84:87], v[32:47]
  ds_read_b128 v[100:103], v7 offset:672
  v_mfma_f32_32x32x16_bf16 v[48:63], a[196:199], v[84:87], v[48:63]
  s_waitcnt lgkmcnt(3)
  v_mfma_f32_32x32x16_bf16 v[32:47], a[72:75], v[88:91], v[32:47]
  ds_read_b128 v[104:107], v7 offset:704
  v_mfma_f32_32x32x16_bf16 v[48:63], a[200:203], v[88:91], v[48:63]
  s_waitcnt lgkmcnt(3)
  v_mfma_f32_32x32x16_bf16 v[32:47], a[76:79], v[92:95], v[32:47]
  ds_read_b128 v[108:111], v7 offset:736
  v_mfma_f32_32x32x16_bf16 v[48:63], a[204:207], v[92:95], v[48:63]
  s_waitcnt lgkmcnt(3)
  v_mfma_f32_32x32x16_bf16 v[32:47], a[80:83], v[96:99], v[32:47]
  ds_read_b128 v[80:83], v7 offset:768
  v_mfma_f32_32x32x16_bf16 v[48:63], a[208:211], v[96:99], v[48:63]
  s_waitcnt lgkmcnt(3)
  v_mfma_f32_32x32x16_bf16 v[32:47], a[84:87], v[100:103], v[32:47]
  ds_read_b128 v[84:87], v7 offset:800
  v_mfma_f32_32x32x16_bf16 v[48:63], a[212:215], v[100:103], v[48:63]
  s_waitcnt lgkmcnt(3)
  v_mfma_f32_32x32x16_bf16 v[32:47], a[88:91], v[104:107], v[32:47]
  ds_read_b128 v[88:91], v7 offset:832
  v_mfma_f32_32x32x16_bf16 v[48:63], a[216:219], v[104:107], v[48:63]
  s_waitcnt lgkmcnt(3)
  v_mfma_f32_32x32x16_bf16 v[32:47], a[92:95], v[108:111], v[32:47]
  ds_read_b128 v[92:95], v7 offset:864
  v_mfma_f32_32x32x16_bf16 v[48:63], a[220:223], v[108:111], v[48:63]
  s_waitcnt lgkmcnt(3)
  v_mfma_f32_32x32x16_bf16 v[32:47], a[96:99], v[80:83], v[32:47]
  ds_read_b128 v[96:99], v7 offset:896
  v_mfma_f32_32x32x16_bf16 v[48:63], a[224:227], v[80:83], v[48:63]
  s_waitcnt lgkmcnt(3)
  v_mfma_f32_32x32x16_bf16 v[32:47], a[100:103], v[84:87], v[32:47]
  ds_read_b128 v[100:103], v7 offset:928
  v_mfma_f32_32x32x16_bf16 v[48:63], a[228:231], v[84:87], v[48:63]
  s_waitcnt lgkmcnt(3)
  v_mfma_f32_32x32x16_bf16 v[32:47], a[104:107], v[88:91], v[32:47]
  ds_read_b128 v[104:107], v7 offset:960
  v_mfma_f32_32x32x16_bf16 v[48:63], a[232:235], v[88:91], v[48:63]
  s_waitcnt lgkmcnt(3)
  v_mfma_f32_32x32x16_bf16 v[32:47], a[108:111], v[92:95], v[32:47]
  ds_read_b128 v[108:111], v7 offset:992
  v_mfma_f32_32x32x16_bf16 v[48:63], a[236:239], v[92:95], v[48:63]
  s_waitcnt lgkmcnt(3)
  v_mfma_f32_32x32x16_bf16 v[32:47], a[112:115], v[96:99], v[32:47]
  v_mfma_f32_32x32x16_bf16 v[48:63], a[240:243], v[96:99], v[48:63]
  s_waitcnt lgkmcnt(2)
  v_mfma_f32_32x32x16_bf16 v[32:47], a[116:119], v[100:103], v[32:47]
  v_mfma_f32_32x32x16_bf16 v[48:63], a[244:247], v[100:103], v[48:63]
  s_waitcnt lgkmcnt(1)
  v_mfma_f32_32x32x16_bf16 v[32:47], a[120:123], v[104:107], v[32:47]
  v_mfma_f32_32x32x16_bf16 v[48:63], a[248:251], v[104:107], v[48:63]
  s_waitcnt lgkmcnt(0)
  v_mfma_f32_32x32x16_bf16 v[32:47], a[124:127], v[108:111], v[32:47]
  v_mfma_f32_32x32x16_bf16 v[48:63], a[252:255], v[108:111], v[48:63]
  s_mul_i32 s51, s46, 90112
  s_add_u32 s51, s51, 0x3800000
  s_lshl_b32 s42, s46, 7
  s_add_u32 s50, s42, 0x4006000
  s_nop 6
  v_mul_f32 v32, s60, v32
  v_mul_f32 v33, s60, v33
  v_mul_f32 v34, s60, v34
  v_mul_f32 v35, s60, v35
  v_mul_f32 v36, s60, v36
  v_mul_f32 v37, s60, v37
  v_mul_f32 v38, s60, v38
  v_mul_f32 v39, s60, v39
  v_mul_f32 v40, s60, v40
  v_mul_f32 v41, s60, v41
  v_mul_f32 v42, s60, v42
  v_mul_f32 v43, s60, v43
  v_mul_f32 v44, s60, v44
  v_mul_f32 v45, s60, v45
  v_mul_f32 v46, s60, v46
  v_mul_f32 v47, s60, v47
  v_exp_f32 v32, v32
  v_exp_f32 v33, v33
  v_exp_f32 v34, v34
  v_exp_f32 v35, v35
  v_exp_f32 v36, v36
  v_exp_f32 v37, v37
  v_exp_f32 v38, v38
  v_exp_f32 v39, v39
  v_exp_f32 v40, v40
  v_exp_f32 v41, v41
  v_exp_f32 v42, v42
  v_exp_f32 v43, v43
  v_exp_f32 v44, v44
  v_exp_f32 v45, v45
  v_exp_f32 v46, v46
  v_exp_f32 v47, v47
  v_add_f32 v32, 1.0, v32
  v_add_f32 v33, 1.0, v33
  v_add_f32 v34, 1.0, v34
  v_add_f32 v35, 1.0, v35
  v_add_f32 v36, 1.0, v36
  v_add_f32 v37, 1.0, v37
  v_add_f32 v38, 1.0, v38
  v_add_f32 v39, 1.0, v39
  v_add_f32 v40, 1.0, v40
  v_add_f32 v41, 1.0, v41
  v_add_f32 v42, 1.0, v42
  v_add_f32 v43, 1.0, v43
  v_add_f32 v44, 1.0, v44
  v_add_f32 v45, 1.0, v45
  v_add_f32 v46, 1.0, v46
  v_add_f32 v47, 1.0, v47
  v_rcp_f32 v32, v32
  v_rcp_f32 v33, v33
  v_rcp_f32 v34, v34
  v_rcp_f32 v35, v35
  v_rcp_f32 v36, v36
  v_rcp_f32 v37, v37
  v_rcp_f32 v38, v38
  v_rcp_f32 v39, v39
  v_rcp_f32 v40, v40
  v_rcp_f32 v41, v41
  v_rcp_f32 v42, v42
  v_rcp_f32 v43, v43
  v_rcp_f32 v44, v44
  v_rcp_f32 v45, v45
  v_rcp_f32 v46, v46
  v_rcp_f32 v47, v47
  v_mul_f32 v48, v48, v32
  v_mul_f32 v49, v49, v33
  v_mul_f32 v50, v50, v34
  v_mul_f32 v51, v51, v35
  v_mul_f32 v52, v52, v36
  v_mul_f32 v53, v53, v37
  v_mul_f32 v54, v54, v38
  v_mul_f32 v55, v55, v39
  v_mul_f32 v56, v56, v40
  v_mul_f32 v57, v57, v41
  v_mul_f32 v58, v58, v42
  v_mul_f32 v59, v59, v43
  v_mul_f32 v60, v60, v44
  v_mul_f32 v61, v61, v45
  v_mul_f32 v62, v62, v46
  v_mul_f32 v63, v63, v47
  v_cvt_pk_bf16_f32 v48, v48, v49
  v_cvt_pk_bf16_f32 v49, v50, v51
  v_cvt_pk_bf16_f32 v50, v52, v53
  v_cvt_pk_bf16_f32 v51, v54, v55
  v_cvt_pk_bf16_f32 v52, v56, v57
  v_cvt_pk_bf16_f32 v53, v58, v59
  v_cvt_pk_bf16_f32 v54, v60, v61
  v_cvt_pk_bf16_f32 v55, v62, v63
  buffer_store_dwordx4 v[48:51], v8, s[4:7], s51 offen offset:0 sc1
  buffer_store_dwordx4 v[52:55], v8, s[4:7], s51 offen offset:1024 sc1
  v_add_u32 v7, s49, v7
  s_sub_u32 s49, 0, s49
  s_add_u32 s46, s46, 6
  s_sub_u32 s52, s52, 1
  s_cmp_lg_u32 s52, 0
  s_cbranch_scc1 L_f0_171
  s_waitcnt vmcnt(0)
  buffer_atomic_add v11, v10, s[4:7], s50 offen sc1
  s_waitcnt vmcnt(0)
L_f0_skip_169:
  s_barrier
L_fw:
  s_mov_b32 s60, 0x4002080
  s_mov_b32 s15, 0x400000
L_poll_172:
  buffer_load_dword v12, off, s[4:7], s60 sc1
  s_waitcnt vmcnt(0)
  v_readfirstlane_b32 s16, v12
  s_cmp_ge_u32 s16, 32
  s_cbranch_scc1 L_poll_out_173
  s_sub_u32 s15, s15, 1
  s_cmp_lg_u32 s15, 0
  s_cbranch_scc1 L_poll_172
L_poll_out_173:
  s_load_dwordx2 s[24:25], s[0:1], 40
  s_mov_b32 s26, 0x400000
  s_mov_b32 s27, 0x20000
  s_load_dwordx2 s[28:29], s[0:1], 80
  s_mov_b32 s30, 0x158000
  s_mov_b32 s31, 0x20000
  s_load_dwordx2 s[32:33], s[0:1], 96
  s_mov_b32 s34, 0x200000
  s_mov_b32 s35, 0x20000
  v_mov_b32 v1, 0x0
  v_bfe_u32 v12, v0, 0, 2
  v_mad_i32_i24 v1, v12, 16, v1
  v_bfe_u32 v12, v0, 2, 4
  s_mov_b32 s42, 0x400
  v_mad_i32_i24 v1, v12, s42, v1
  v_mov_b32 v20, 0x0
  v_bfe_u32 v12, v0, 0, 1
  v_mad_i32_i24 v20, v12, 32, v20
  v_bfe_u32 v12, v0, 1, 1
  v_mad_i32_i24 v20, v12, 8, v20
  v_bfe_u32 v12, v0, 2, 2
  s_mov_b32 s42, 0x80
  v_mad_i32_i24 v20, v12, s42, v20
  v_bfe_u32 v12, v0, 4, 1
  v_mad_i32_i24 v20, v12, 16, v20
  v_bfe_u32 v12, v0, 5, 1
  s_mov_b32 s42, 0x200
  v_mad_i32_i24 v20, v12, s42, v20
  v_bfe_u32 v12, v0, 6, 2
  s_mov_b32 s42, 0x8000
  v_mad_i32_i24 v20, v12, s42, v20
  v_mov_b32 v21, 0x0
  v_bfe_u32 v12, v0, 0, 1
  v_mad_i32_i24 v21, v12, 32, v21
  v_bfe_u32 v12, v0, 1, 1
  v_mad_i32_i24 v21, v12, 8, v21
  v_bfe_u32 v12, v0, 2, 2
  v_mad_i32_i24 v21, v12, 64, v21
  v_bfe_u32 v12, v0, 4, 1
  v_mad_i32_i24 v21, v12, 16, v21
  v_bfe_u32 v12, v0, 5, 1
  s_mov_b32 s42, 0x200
  v_mad_i32_i24 v21, v12, s42, v21
  v_bfe_u32 v12, v0, 6, 2
  s_mov_b32 s42, 0x8000
  v_mad_i32_i24 v21, v12, s42, v21
  s_lshl_b32 s42, s45, 6
  s_lshl_b32 s61, s14, 20
  s_add_u32 s61, s61, s42
  s_mul_i32 s62, s14, 360448
  s_add_u32 s62, s62, s42
  s_lshl_b32 s63, s14, 15
  s_add_u32 s42, s62, 0x0
  s_add_u32 m0, s63, 0
  s_waitcnt lgkmcnt(0)
  buffer_load_dwordx4 v1, s[28:31], s42 offen lds
  s_add_u32 s42, s62, 0x4000
  s_add_u32 m0, s63, 1024
  s_nop 0
  buffer_load_dwordx4 v1, s[28:31], s42 offen lds
  s_add_u32 s42, s62, 0x8000
  s_add_u32 m0, s63, 2048
  s_nop 0
  buffer_load_dwordx4 v1, s[28:31], s42 offen lds
  s_add_u32 s42, s62, 0xc000
  s_add_u32 m0, s63, 3072
  s_nop 0
  buffer_load_dwordx4 v1, s[28:31], s42 offen lds
  s_add_u32 s42, s62, 0x10000
  s_add_u32 m0, s63, 4096
  s_nop 0
  buffer_load_dwordx4 v1, s[28:31], s42 offen lds
  s_add_u32 s42, s62, 0x14000
  s_add_u32 m0, s63, 5120
  s_nop 0
  buffer_load_dwordx4 v1, s[28:31], s42 offen lds
  s_add_u32 s42, s62, 0x18000
  s_add_u32 m0, s63, 6144
  s_nop 0
  buffer_load_dwordx4 v1, s[28:31], s42 offen lds
  s_add_u32 s42, s62, 0x1c000
  s_add_u32 m0, s63, 7168
  s_nop 0
  buffer_load_dwordx4 v1, s[28:31], s42 offen lds
  s_add_u32 s42, s62, 0x20000
  s_add_u32 m0, s63, 8192
  s_nop 0
  buffer_load_dwordx4 v1, s[28:31], s42 offen lds
  s_add_u32 s42, s62, 0x24000
  s_add_u32 m0, s63, 9216
  s_nop 0
  buffer_load_dwordx4 v1, s[28:31], s42 offen lds
  s_add_u32 s42, s62, 0x28000
  s_add_u32 m0, s63, 10240
  s_nop 0
  buffer_load_dwordx4 v1, s[28:31], s42 offen lds
  s_add_u32 s42, s62, 0x2c000
  s_add_u32 m0, s63, 11264
  s_nop 0
  buffer_load_dwordx4 v1, s[28:31], s42 offen lds
  s_add_u32 s42, s62, 0x30000
  s_add_u32 m0, s63, 12288
  s_nop 0
  buffer_load_dwordx4 v1, s[28:31], s42 offen lds
  s_add_u32 s42, s62, 0x34000
  s_add_u32 m0, s63, 13312
  s_nop 0
  buffer_load_dwordx4 v1, s[28:31], s42 offen lds
  s_add_u32 s42, s62, 0x38000
  s_add_u32 m0, s63, 14336
  s_nop 0
  buffer_load_dwordx4 v1, s[28:31], s42 offen lds
  s_add_u32 s42, s62, 0x3c000
  s_add_u32 m0, s63, 15360
  s_nop 0
  buffer_load_dwordx4 v1, s[28:31], s42 offen lds
  s_add_u32 s42, s62, 0x40000
  s_add_u32 m0, s63, 16384
  s_nop 0
  buffer_load_dwordx4 v1, s[28:31], s42 offen lds
  s_add_u32 s42, s62, 0x44000
  s_add_u32 m0, s63, 17408
  s_nop 0
  buffer_load_dwordx4 v1, s[28:31], s42 offen lds
  s_add_u32 s42, s62, 0x48000
  s_add_u32 m0, s63, 18432
  s_nop 0
  buffer_load_dwordx4 v1, s[28:31], s42 offen lds
  s_add_u32 s42, s62, 0x4c000
  s_add_u32 m0, s63, 19456
  s_nop 0
  buffer_load_dwordx4 v1, s[28:31], s42 offen lds
  s_add_u32 s42, s62, 0x50000
  s_add_u32 m0, s63, 20480
  s_nop 0
  buffer_load_dwordx4 v1, s[28:31], s42 offen lds
  s_add_u32 s42, s62, 0x54000
  s_add_u32 m0, s63, 21504
  s_nop 0
  buffer_load_dwordx4 v1, s[28:31], s42 offen lds
  s_add_u32 s42, s61, 0x0
  s_add_u32 m0, s63, 24576
  s_nop 0
  buffer_load_dwordx4 v1, s[24:27], s42 offen lds
  s_add_u32 s42, s61, 0x4000
  s_add_u32 m0, s63, 25600
  s_nop 0
  buffer_load_dwordx4 v1, s[24:27], s42 offen lds
  s_add_u32 s42, s61, 0x8000
  s_add_u32 m0, s63, 26624
  s_nop 0
  buffer_load_dwordx4 v1, s[24:27], s42 offen lds
  s_add_u32 s42, s61, 0xc000
  s_add_u32 m0, s63, 27648
  s_nop 0
  buffer_load_dwordx4 v1, s[24:27], s42 offen lds
  s_add_u32 s42, s61, 0x10000
  s_add_u32 m0, s63, 28672
  s_nop 0
  buffer_load_dwordx4 v1, s[24:27], s42 offen lds
  s_add_u32 s42, s61, 0x14000
  s_add_u32 m0, s63, 29696
  s_nop 0
  buffer_load_dwordx4 v1, s[24:27], s42 offen lds
  s_add_u32 s42, s61, 0x18000
  s_add_u32 m0, s63, 30720
  s_nop 0
  buffer_load_dwordx4 v1, s[24:27], s42 offen lds
  s_add_u32 s42, s61, 0x1c000
  s_add_u32 m0, s63, 31744
  s_nop 0
  buffer_load_dwordx4 v1, s[24:27], s42 offen lds
  s_waitcnt vmcnt(22)
  ds_read_b64_tr_b16 v[168:169], v21 offset:0
  ds_read_b64_tr_b16 v[170:171], v21 offset:256
  ds_read_b64_tr_b16 v[172:173], v21 offset:1024
  ds_read_b64_tr_b16 v[174:175], v21 offset:1280
  ds_read_b64_tr_b16 v[176:177], v21 offset:2048
  ds_read_b64_tr_b16 v[178:179], v21 offset:2304
  ds_read_b64_tr_b16 v[180:181], v21 offset:3072
  ds_read_b64_tr_b16 v[182:183], v21 offset:3328
  ds_read_b64_tr_b16 v[184:185], v21 offset:4096
  ds_read_b64_tr_b16 v[186:187], v21 offset:4352
  ds_read_b64_tr_b16 v[188:189], v21 offset:5120
  ds_read_b64_tr_b16 v[190:191], v21 offset:5376
  ds_read_b64_tr_b16 v[192:193], v21 offset:6144
  ds_read_b64_tr_b16 v[194:195], v21 offset:6400
  ds_read_b64_tr_b16 v[196:197], v21 offset:7168
  ds_read_b64_tr_b16 v[198:199], v21 offset:7424
  s_waitcnt lgkmcnt(0)
  s_add_u32 s42, s61, 0x20000
  s_add_u32 m0, s63, 0
  s_nop 0
  buffer_load_dwordx4 v1, s[24:27], s42 offen lds
  s_add_u32 s42, s61, 0x24000
  s_add_u32 m0, s63, 1024
  s_nop 0
  buffer_load_dwordx4 v1, s[24:27], s42 offen lds
  s_add_u32 s42, s61, 0x28000
  s_add_u32 m0, s63, 2048
  s_nop 0
  buffer_load_dwordx4 v1, s[24:27], s42 offen lds
  s_add_u32 s42, s61, 0x2c000
  s_add_u32 m0, s63, 3072
  s_nop 0
  buffer_load_dwordx4 v1, s[24:27], s42 offen lds
  s_add_u32 s42, s61, 0x30000
  s_add_u32 m0, s63, 4096
  s_nop 0
  buffer_load_dwordx4 v1, s[24:27], s42 offen lds
  s_add_u32 s42, s61, 0x34000
  s_add_u32 m0, s63, 5120
  s_nop 0
  buffer_load_dwordx4 v1, s[24:27], s42 offen lds
  s_add_u32 s42, s61, 0x38000
  s_add_u32 m0, s63, 6144
  s_nop 0
  buffer_load_dwordx4 v1, s[24:27], s42 offen lds
  s_add_u32 s42, s61, 0x3c000
  s_add_u32 m0, s63, 7168
  s_nop 0
  buffer_load_dwordx4 v1, s[24:27], s42 offen lds
  s_waitcnt vmcnt(22)
  ds_read_b64_tr_b16 v[200:201], v21 offset:8192
  ds_read_b64_tr_b16 v[202:203], v21 offset:8448
  ds_read_b64_tr_b16 v[204:205], v21 offset:9216
  ds_read_b64_tr_b16 v[206:207], v21 offset:9472
  ds_read_b64_tr_b16 v[208:209], v21 offset:10240
  ds_read_b64_tr_b16 v[210:211], v21 offset:10496
  ds_read_b64_tr_b16 v[212:213], v21 offset:11264
  ds_read_b64_tr_b16 v[214:215], v21 offset:11520
  ds_read_b64_tr_b16 v[216:217], v21 offset:12288
  ds_read_b64_tr_b16 v[218:219], v21 offset:12544
  ds_read_b64_tr_b16 v[220:221], v21 offset:13312
  ds_read_b64_tr_b16 v[222:223], v21 offset:13568
  ds_read_b64_tr_b16 v[224:225], v21 offset:14336
  ds_read_b64_tr_b16 v[226:227], v21 offset:14592
  ds_read_b64_tr_b16 v[228:229], v21 offset:15360
  ds_read_b64_tr_b16 v[230:231], v21 offset:15616
  s_waitcnt lgkmcnt(0)
  s_add_u32 s42, s61, 0x40000
  s_add_u32 m0, s63, 8192
  s_nop 0
  buffer_load_dwordx4 v1, s[24:27], s42 offen lds
  s_add_u32 s42, s61, 0x44000
  s_add_u32 m0, s63, 9216
  s_nop 0
  buffer_load_dwordx4 v1, s[24:27], s42 offen lds
  s_add_u32 s42, s61, 0x48000
  s_add_u32 m0, s63, 10240
  s_nop 0
  buffer_load_dwordx4 v1, s[24:27], s42 offen lds
  s_add_u32 s42, s61, 0x4c000
  s_add_u32 m0, s63, 11264
  s_nop 0
  buffer_load_dwordx4 v1, s[24:27], s42 offen lds
  s_add_u32 s42, s61, 0x50000
  s_add_u32 m0, s63, 12288
  s_nop 0
  buffer_load_dwordx4 v1, s[24:27], s42 offen lds
  s_add_u32 s42, s61, 0x54000
  s_add_u32 m0, s63, 13312
  s_nop 0
  buffer_load_dwordx4 v1, s[24:27], s42 offen lds
  s_add_u32 s42, s61, 0x58000
  s_add_u32 m0, s63, 14336
  s_nop 0
  buffer_load_dwordx4 v1, s[24:27], s42 offen lds
  s_add_u32 s42, s61, 0x5c000
  s_add_u32 m0, s63, 15360
  s_nop 0
  buffer_load_dwordx4 v1, s[24:27], s42 offen lds
  s_waitcnt vmcnt(24)
  ds_read_b64_tr_b16 v[232:233], v21 offset:16384
  ds_read_b64_tr_b16 v[234:235], v21 offset:16640
  ds_read_b64_tr_b16 v[236:237], v21 offset:17408
  ds_read_b64_tr_b16 v[238:239], v21 offset:17664
  ds_read_b64_tr_b16 v[240:241], v21 offset:18432
  ds_read_b64_tr_b16 v[242:243], v21 offset:18688
  ds_read_b64_tr_b16 v[244:245], v21 offset:19456
  ds_read_b64_tr_b16 v[246:247], v21 offset:19712
  ds_read_b64_tr_b16 v[248:249], v21 offset:20480
  ds_read_b64_tr_b16 v[250:251], v21 offset:20736
  ds_read_b64_tr_b16 v[252:253], v21 offset:21504
  ds_read_b64_tr_b16 v[254:255], v21 offset:21760
  s_waitcnt lgkmcnt(0)
  s_add_u32 s42, s61, 0x60000
  s_add_u32 m0, s63, 16384
  s_nop 0
  buffer_load_dwordx4 v1, s[24:27], s42 offen lds
  s_add_u32 s42, s61, 0x64000
  s_add_u32 m0, s63, 17408
  s_nop 0
  buffer_load_dwordx4 v1, s[24:27], s42 offen lds
  s_add_u32 s42, s61, 0x68000
  s_add_u32 m0, s63, 18432
  s_nop 0
  buffer_load_dwordx4 v1, s[24:27], s42 offen lds
  s_add_u32 s42, s61, 0x6c000
  s_add_u32 m0, s63, 19456
  s_nop 0
  buffer_load_dwordx4 v1, s[24:27], s42 offen lds
  s_add_u32 s42, s61, 0x70000
  s_add_u32 m0, s63, 20480
  s_nop 0
  buffer_load_dwordx4 v1, s[24:27], s42 offen lds
  s_add_u32 s42, s61, 0x74000
  s_add_u32 m0, s63, 21504
  s_nop 0
  buffer_load_dwordx4 v1, s[24:27], s42 offen lds
  s_add_u32 s42, s61, 0x78000
  s_add_u32 m0, s63, 22528
  s_nop 0
  buffer_load_dwordx4 v1, s[24:27], s42 offen lds
  s_add_u32 s42, s61, 0x7c000
  s_add_u32 m0, s63, 23552
  s_nop 0
  buffer_load_dwordx4 v1, s[24:27], s42 offen lds
  s_waitcnt vmcnt(24)
  ds_read_b64_tr_b16 a[0:1], v20 offset:24576
  ds_read_b64_tr_b16 a[2:3], v20 offset:25600
  ds_read_b64_tr_b16 a[4:5], v20 offset:26624
  ds_read_b64_tr_b16 a[6:7], v20 offset:27648
  ds_read_b64_tr_b16 a[8:9], v20 offset:24640
  ds_read_b64_tr_b16 a[10:11], v20 offset:25664
  ds_read_b64_tr_b16 a[12:13], v20 offset:26688
  ds_read_b64_tr_b16 a[14:15], v20 offset:27712
  ds_read_b64_tr_b16 a[16:17], v20 offset:28672
  ds_read_b64_tr_b16 a[18:19], v20 offset:29696
  ds_read_b64_tr_b16 a[20:21], v20 offset:30720
  ds_read_b64_tr_b16 a[22:23], v20 offset:31744
  ds_read_b64_tr_b16 a[24:25], v20 offset:28736
  ds_read_b64_tr_b16 a[26:27], v20 offset:29760
  ds_read_b64_tr_b16 a[28:29], v20 offset:30784
  ds_read_b64_tr_b16 a[30:31], v20 offset:31808
  s_waitcnt lgkmcnt(0)
  s_add_u32 s42, s61, 0x80000
  s_add_u32 m0, s63, 24576
  s_nop 0
  buffer_load_dwordx4 v1, s[24:27], s42 offen lds
  s_add_u32 s42, s61, 0x84000
  s_add_u32 m0, s63, 25600
  s_nop 0
  buffer_load_dwordx4 v1, s[24:27], s42 offen lds
  s_add_u32 s42, s61, 0x88000
  s_add_u32 m0, s63, 26624
  s_nop 0
  buffer_load_dwordx4 v1, s[24:27], s42 offen lds
  s_add_u32 s42, s61, 0x8c000
  s_add_u32 m0, s63, 27648
  s_nop 0
  buffer_load_dwordx4 v1, s[24:27], s42 offen lds
  s_add_u32 s42, s61, 0x90000
  s_add_u32 m0, s63, 28672
  s_nop 0
  buffer_load_dwordx4 v1, s[24:27], s42 offen lds
  s_add_u32 s42, s61, 0x94000
  s_add_u32 m0, s63, 29696
  s_nop 0
  buffer_load_dwordx4 v1, s[24:27], s42 offen lds
  s_add_u32 s42, s61, 0x98000
  s_add_u32 m0, s63, 30720
  s_nop 0
  buffer_load_dwordx4 v1, s[24:27], s42 offen lds
  s_add_u32 s42, s61, 0x9c000
  s_add_u32 m0, s63, 31744
  s_nop 0
  buffer_load_dwordx4 v1, s[24:27], s42 offen lds
  s_waitcnt vmcnt(24)
  ds_read_b64_tr_b16 a[32:33], v20 offset:0
  ds_read_b64_tr_b16 a[34:35], v20 offset:1024
  ds_read_b64_tr_b16 a[36:37], v20 offset:2048
  ds_read_b64_tr_b16 a[38:39], v20 offset:3072
  ds_read_b64_tr_b16 a[40:41], v20 offset:64
  ds_read_b64_tr_b16 a[42:43], v20 offset:1088
  ds_read_b64_tr_b16 a[44:45], v20 offset:2112
  ds_read_b64_tr_b16 a[46:47], v20 offset:3136
  ds_read_b64_tr_b16 a[48:49], v20 offset:4096
  ds_read_b64_tr_b16 a[50:51], v20 offset:5120
  ds_read_b64_tr_b16 a[52:53], v20 offset:6144
  ds_read_b64_tr_b16 a[54:55], v20 offset:7168
  ds_read_b64_tr_b16 a[56:57], v20 offset:4160
  ds_read_b64_tr_b16 a[58:59], v20 offset:5184
  ds_read_b64_tr_b16 a[60:61], v20 offset:6208
  ds_read_b64_tr_b16 a[62:63], v20 offset:7232
  s_waitcnt lgkmcnt(0)
  s_add_u32 s42, s61, 0xa0000
  s_add_u32 m0, s63, 0
  s_nop 0
  buffer_load_dwordx4 v1, s[24:27], s42 offen lds
  s_add_u32 s42, s61, 0xa4000
  s_add_u32 m0, s63, 1024
  s_nop 0
  buffer_load_dwordx4 v1, s[24:27], s42 offen lds
  s_add_u32 s42, s61, 0xa8000
  s_add_u32 m0, s63, 2048
  s_nop 0
  buffer_load_dwordx4 v1, s[24:27], s42 offen lds
  s_add_u32 s42, s61, 0xac000
  s_add_u32 m0, s63, 3072
  s_nop 0
  buffer_load_dwordx4 v1, s[24:27], s42 offen lds
  s_add_u32 s42, s61, 0xb0000
  s_add_u32 m0, s63, 4096
  s_nop 0
  buffer_load_dwordx4 v1, s[24:27], s42 offen lds
  s_add_u32 s42, s61, 0xb4000
  s_add_u32 m0, s63, 5120
  s_nop 0
  buffer_load_dwordx4 v1, s[24:27], s42 offen lds
  s_add_u32 s42, s61, 0xb8000
  s_add_u32 m0, s63, 6144
  s_nop 0
  buffer_load_dwordx4 v1, s[24:27], s42 offen lds
  s_add_u32 s42, s61, 0xbc000
  s_add_u32 m0, s63, 7168
  s_nop 0
  buffer_load_dwordx4 v1, s[24:27], s42 offen lds
  s_waitcnt vmcnt(24)
  ds_read_b64_tr_b16 a[64:65], v20 offset:8192
  ds_read_b64_tr_b16 a[66:67], v20 offset:9216
  ds_read_b64_tr_b16 a[68:69], v20 offset:10240
  ds_read_b64_tr_b16 a[70:71], v20 offset:11264
  ds_read_b64_tr_b16 a[72:73], v20 offset:8256
  ds_read_b64_tr_b16 a[74:75], v20 offset:9280
  ds_read_b64_tr_b16 a[76:77], v20 offset:10304
  ds_read_b64_tr_b16 a[78:79], v20 offset:11328
  ds_read_b64_tr_b16 a[80:81], v20 offset:12288
  ds_read_b64_tr_b16 a[82:83], v20 offset:13312
  ds_read_b64_tr_b16 a[84:85], v20 offset:14336
  ds_read_b64_tr_b16 a[86:87], v20 offset:15360
  ds_read_b64_tr_b16 a[88:89], v20 offset:12352
  ds_read_b64_tr_b16 a[90:91], v20 offset:13376
  ds_read_b64_tr_b16 a[92:93], v20 offset:14400
  ds_read_b64_tr_b16 a[94:95], v20 offset:15424
  s_waitcnt lgkmcnt(0)
  s_add_u32 s42, s61, 0xc0000
  s_add_u32 m0, s63, 8192
  s_nop 0
  buffer_load_dwordx4 v1, s[24:27], s42 offen lds
  s_add_u32 s42, s61, 0xc4000
  s_add_u32 m0, s63, 9216
  s_nop 0
  buffer_load_dwordx4 v1, s[24:27], s42 offen lds
  s_add_u32 s42, s61, 0xc8000
  s_add_u32 m0, s63, 10240
  s_nop 0
  buffer_load_dwordx4 v1, s[24:27], s42 offen lds
  s_add_u32 s42, s61, 0xcc000
  s_add_u32 m0, s63, 11264
  s_nop 0
  buffer_load_dwordx4 v1, s[24:27], s42 offen lds
  s_add_u32 s42, s61, 0xd0000
  s_add_u32 m0, s63, 12288
  s_nop 0
  buffer_load_dwordx4 v1, s[24:27], s42 offen lds
  s_add_u32 s42, s61, 0xd4000
  s_add_u32 m0, s63, 13312
  s_nop 0
  buffer_load_dwordx4 v1, s[24:27], s42 offen lds
  s_add_u32 s42, s61, 0xd8000
  s_add_u32 m0, s63, 14336
  s_nop 0
  buffer_load_dwordx4 v1, s[24:27], s42 offen lds
  s_add_u32 s42, s61, 0xdc000
  s_add_u32 m0, s63, 15360
  s_nop 0
  buffer_load_dwordx4 v1, s[24:27], s42 offen lds
  s_waitcnt vmcnt(24)
  ds_read_b64_tr_b16 a[96:97], v20 offset:16384
  ds_read_b64_tr_b16 a[98:99], v20 offset:17408
  ds_read_b64_tr_b16 a[100:101], v20 offset:18432
  ds_read_b64_tr_b16 a[102:103], v20 offset:19456
  ds_read_b64_tr_b16 a[104:105], v20 offset:16448
  ds_read_b64_tr_b16 a[106:107], v20 offset:17472
  ds_read_b64_tr_b16 a[108:109], v20 offset:18496
  ds_read_b64_tr_b16 a[110:111], v20 offset:19520
  ds_read_b64_tr_b16 a[112:113], v20 offset:20480
  ds_read_b64_tr_b16 a[114:115], v20 offset:21504
  ds_read_b64_tr_b16 a[116:117], v20 offset:22528
  ds_read_b64_tr_b16 a[118:119], v20 offset:23552
  ds_read_b64_tr_b16 a[120:121], v20 offset:20544
  ds_read_b64_tr_b16 a[122:123], v20 offset:21568
  ds_read_b64_tr_b16 a[124:125], v20 offset:22592
  ds_read_b64_tr_b16 a[126:127], v20 offset:23616
  s_waitcnt lgkmcnt(0)
  s_add_u32 s42, s61, 0xe0000
  s_add_u32 m0, s63, 16384
  s_nop 0
  buffer_load_dwordx4 v1, s[24:27], s42 offen lds
  s_add_u32 s42, s61, 0xe4000
  s_add_u32 m0, s63, 17408
  s_nop 0
  buffer_load_dwordx4 v1, s[24:27], s42 offen lds
  s_add_u32 s42, s61, 0xe8000
  s_add_u32 m0, s63, 18432
  s_nop 0
  buffer_load_dwordx4 v1, s[24:27], s42 offen lds
  s_add_u32 s42, s61, 0xec000
  s_add_u32 m0, s63, 19456
  s_nop 0
  buffer_load_dwordx4 v1, s[24:27], s42 offen lds
  s_add_u32 s42, s61, 0xf0000
  s_add_u32 m0, s63, 20480
  s_nop 0
  buffer_load_dwordx4 v1, s[24:27], s42 offen lds
  s_add_u32 s42, s61, 0xf4000
  s_add_u32 m0, s63, 21504
  s_nop 0
  buffer_load_dwordx4 v1, s[24:27], s42 offen lds
  s_add_u32 s42, s61, 0xf8000
  s_add_u32 m0, s63, 22528
  s_nop 0
  buffer_load_dwordx4 v1, s[24:27], s42 offen lds
  s_add_u32 s42, s61, 0xfc000
  s_add_u32 m0, s63, 23552
  s_nop 0
  buffer_load_dwordx4 v1, s[24:27], s42 offen lds
  s_waitcnt vmcnt(24)
  ds_read_b64_tr_b16 a[128:129], v20 offset:24576
  ds_read_b64_tr_b16 a[130:131], v20 offset:25600
  ds_read_b64_tr_b16 a[132:133], v20 offset:26624
  ds_read_b64_tr_b16 a[134:135], v20 offset:27648
  ds_read_b64_tr_b16 a[136:137], v20 offset:24640
  ds_read_b64_tr_b16 a[138:139], v20 offset:25664
  ds_read_b64_tr_b16 a[140:141], v20 offset:26688
  ds_read_b64_tr_b16 a[142:143], v20 offset:27712
  ds_read_b64_tr_b16 a[144:145], v20 offset:28672
  ds_read_b64_tr_b16 a[146:147], v20 offset:29696
  ds_read_b64_tr_b16 a[148:149], v20 offset:30720
  ds_read_b64_tr_b16 a[150:151], v20 offset:31744
  ds_read_b64_tr_b16 a[152:153], v20 offset:28736
  ds_read_b64_tr_b16 a[154:155], v20 offset:29760
  ds_read_b64_tr_b16 a[156:157], v20 offset:30784
  ds_read_b64_tr_b16 a[158:159], v20 offset:31808
  s_waitcnt lgkmcnt(0)
  s_waitcnt vmcnt(16)
  ds_read_b64_tr_b16 a[160:161], v20 offset:0
  ds_read_b64_tr_b16 a[162:163], v20 offset:1024
  ds_read_b64_tr_b16 a[164:165], v20 offset:2048
  ds_read_b64_tr_b16 a[166:167], v20 offset:3072
  ds_read_b64_tr_b16 a[168:169], v20 offset:64
  ds_read_b64_tr_b16 a[170:171], v20 offset:1088
  ds_read_b64_tr_b16 a[172:173], v20 offset:2112
  ds_read_b64_tr_b16 a[174:175], v20 offset:3136
  ds_read_b64_tr_b16 a[176:177], v20 offset:4096
  ds_read_b64_tr_b16 a[178:179], v20 offset:5120
  ds_read_b64_tr_b16 a[180:181], v20 offset:6144
  ds_read_b64_tr_b16 a[182:183], v20 offset:7168
  ds_read_b64_tr_b16 a[184:185], v20 offset:4160
  ds_read_b64_tr_b16 a[186:187], v20 offset:5184
  ds_read_b64_tr_b16 a[188:189], v20 offset:6208
  ds_read_b64_tr_b16 a[190:191], v20 offset:7232
  s_waitcnt lgkmcnt(0)
  s_waitcnt vmcnt(8)
  ds_read_b64_tr_b16 a[192:193], v20 offset:8192
  ds_read_b64_tr_b16 a[194:195], v20 offset:9216
  ds_read_b64_tr_b16 a[196:197], v20 offset:10240
  ds_read_b64_tr_b16 a[198:199], v20 offset:11264
  ds_read_b64_tr_b16 a[200:201], v20 offset:8256
  ds_read_b64_tr_b16 a[202:203], v20 offset:9280
  ds_read_b64_tr_b16 a[204:205], v20 offset:10304
  ds_read_b64_tr_b16 a[206:207], v20 offset:11328
  ds_read_b64_tr_b16 a[208:209], v20 offset:12288
  ds_read_b64_tr_b16 a[210:211], v20 offset:13312
  ds_read_b64_tr_b16 a[212:213], v20 offset:14336
  ds_read_b64_tr_b16 a[214:215], v20 offset:15360
  ds_read_b64_tr_b16 a[216:217], v20 offset:12352
  ds_read_b64_tr_b16 a[218:219], v20 offset:13376
  ds_read_b64_tr_b16 a[220:221], v20 offset:14400
  ds_read_b64_tr_b16 a[222:223], v20 offset:15424
  s_waitcnt lgkmcnt(0)
  s_waitcnt vmcnt(0)
  ds_read_b64_tr_b16 a[224:225], v20 offset:16384
  ds_read_b64_tr_b16 a[226:227], v20 offset:17408
  ds_read_b64_tr_b16 a[228:229], v20 offset:18432
  ds_read_b64_tr_b16 a[230:231], v20 offset:19456
  ds_read_b64_tr_b16 a[232:233], v20 offset:16448
  ds_read_b64_tr_b16 a[234:235], v20 offset:17472
  ds_read_b64_tr_b16 a[236:237], v20 offset:18496
  ds_read_b64_tr_b16 a[238:239], v20 offset:19520
  ds_read_b64_tr_b16 a[240:241], v20 offset:20480
  ds_read_b64_tr_b16 a[242:243], v20 offset:21504
  ds_read_b64_tr_b16 a[244:245], v20 offset:22528
  ds_read_b64_tr_b16 a[246:247], v20 offset:23552
  ds_read_b64_tr_b16 a[248:249], v20 offset:20544
  ds_read_b64_tr_b16 a[250:251], v20 offset:21568
  ds_read_b64_tr_b16 a[252:253], v20 offset:22592
  ds_read_b64_tr_b16 a[254:255], v20 offset:23616
  s_waitcnt lgkmcnt(0)
  s_cmp_ge_u32 s20, 224
  s_cbranch_scc1 L_glast
  v_mov_b32 v14, 0x0
  v_bfe_u32 v12, v0, 0, 6
  v_mad_i32_i24 v14, v12, 16, v14
  v_mov_b32 v15, 0x0
  v_bfe_u32 v12, v0, 0, 6
  v_mad_i32_i24 v15, v12, 16, v15
  v_bfe_u32 v12, v0, 6, 1
  v_bfe_u32 v13, v0, 7, 1
  v_and_b32 v12, v12, v13
  s_mov_b32 s42, 0x40000000
  v_mul_lo_u32 v13, v12, s42
  v_add_u32 v15, v15, v13
  v_bfe_u32 v12, v0, 0, 1
  v_bfe_u32 v13, v0, 6, 1
  v_and_b32 v12, v12, v13
  v_bfe_u32 v13, v0, 7, 1
  v_and_b32 v12, v12, v13
  v_mad_i32_i24 v15, v12, -16, v15
  v_bfe_u32 v12, v0, 1, 1
  v_bfe_u32 v13, v0, 6, 1
  v_and_b32 v12, v12, v13
  v_bfe_u32 v13, v0, 7, 1
  v_and_b32 v12, v12, v13
  s_mov_b32 s42, 0xffffffe0
  v_mad_i32_i24 v15, v12, s42, v15
  v_bfe_u32 v12, v0, 2, 1
  v_bfe_u32 v13, v0, 6, 1
  v_and_b32 v12, v12, v13
  v_bfe_u32 v13, v0, 7, 1
  v_and_b32 v12, v12, v13
  s_mov_b32 s42, 0xffffffc0
  v_mad_i32_i24 v15, v12, s42, v15
  v_bfe_u32 v12, v0, 3, 1
  v_bfe_u32 v13, v0, 6, 1
  v_and_b32 v12, v12, v13
  v_bfe_u32 v13, v0, 7, 1
  v_and_b32 v12, v12, v13
  s_mov_b32 s42, 0xffffff80
  v_mad_i32_i24 v15, v12, s42, v15
  v_bfe_u32 v12, v0, 4, 1
  v_bfe_u32 v13, v0, 6, 1
  v_and_b32 v12, v12, v13
  v_bfe_u32 v13, v0, 7, 1
  v_and_b32 v12, v12, v13
  s_mov_b32 s42, 0xffffff00
  v_mad_i32_i24 v15, v12, s42, v15
  v_bfe_u32 v12, v0, 5, 1
  v_bfe_u32 v13, v0, 6, 1
  v_and_b32 v12, v12, v13
  v_bfe_u32 v13, v0, 7, 1
  v_and_b32 v12, v12, v13
  s_mov_b32 s42, 0xfffffe00
  v_mad_i32_i24 v15, v12, s42, v15
  v_mov_b32 v16, 0x0
  v_bfe_u32 v12, v0, 0, 6
  v_mad_i32_i24 v16, v12, 16, v16
  v_bfe_u32 v12, v0, 6, 2
  s_mov_b32 s42, 0x1000
  v_mad_i32_i24 v16, v12, s42, v16
  v_mov_b32 v17, 0x0
  v_bfe_u32 v12, v0, 0, 2
  s_mov_b32 s42, 0x400
  v_mad_i32_i24 v17, v12, s42, v17
  v_bfe_u32 v12, v0, 2, 1
  s_mov_b32 s42, 0x200
  v_mad_i32_i24 v17, v12, s42, v17
  v_bfe_u32 v12, v0, 3, 5
  v_mad_i32_i24 v17, v12, 16, v17
  v_mov_b32 v18, 0x0
  v_bfe_u32 v12, v0, 0, 3
  v_mad_i32_i24 v18, v12, 8, v18
  v_bfe_u32 v12, v0, 3, 5
  s_mov_b32 s42, 0x400
  v_mad_i32_i24 v18, v12, s42, v18
  v_mov_b32 v19, 0x0
  v_bfe_u32 v12, v0, 0, 5
  v_mad_i32_i24 v19, v12, 4, v19
  s_lshl_b32 s42, s45, 6
  v_add_u32 v18, s42, v18
  s_mov_b32 s53, 0
  s_mov_b32 s49, 32768
  s_barrier
L_fm_174:
  s_mul_i32 s46, s53, 6
  s_add_u32 s46, s46, s44
  s_lshl_b32 s42, s46, 7
  s_add_u32 s60, s42, 0x4006000
  s_mul_i32 s61, s46, 90112
  s_mul_i32 s42, s14, 22528
  s_add_u32 s61, s61, s42
  s_add_u32 s61, s61, 0x3800000
  s_lshl_b32 s62, s46, 18
  s_lshl_b32 s42, s14, 16
  s_add_u32 s62, s62, s42
  s_add_u32 s62, s62, 0x2800000
  s_lshl_b32 s64, s46, 15
  s_lshl_b32 s42, s46, 7
  s_add_u32 s42, s42, 0x3e00000
  buffer_load_dword v22, v19, s[4:7], s42 offen sc1
  s_mov_b32 s15, 0x400000
L_poll_175:
  buffer_load_dword v12, off, s[4:7], s60 sc1
  s_waitcnt vmcnt(0)
  v_readfirstlane_b32 s16, v12
  s_cmp_ge_u32 s16, 43
  s_cbranch_scc1 L_poll_out_176
  s_sub_u32 s15, s15, 1
  s_cmp_lg_u32 s15, 0
  s_cbranch_scc1 L_poll_175
L_poll_out_176:
  s_add_u32 s63, s61, 0x0
  buffer_load_dwordx4 v[64:67], v14, s[4:7], s63 offen offset:0
  buffer_load_dwordx4 v[68:71], v14, s[4:7], s63 offen offset:1024
  buffer_load_dwordx4 v[72:75], v14, s[4:7], s63 offen offset:2048
  buffer_load_dwordx4 v[76:79], v14, s[4:7], s63 offen offset:3072
  s_add_u32 s63, s61, 0x1000
  buffer_load_dwordx4 v[80:83], v14, s[4:7], s63 offen offset:0
  buffer_load_dwordx4 v[84:87], v14, s[4:7], s63 offen offset:1024
  buffer_load_dwordx4 v[88:91], v14, s[4:7], s63 offen offset:2048
  buffer_load_dwordx4 v[92:95], v14, s[4:7], s63 offen offset:3072
  s_add_u32 s63, s61, 0x2000
  buffer_load_dwordx4 v[96:99], v14, s[4:7], s63 offen offset:0
  buffer_load_dwordx4 v[100:103], v14, s[4:7], s63 offen offset:1024
  buffer_load_dwordx4 v[104:107], v14, s[4:7], s63 offen offset:2048
  buffer_load_dwordx4 v[108:111], v14, s[4:7], s63 offen offset:3072
  s_add_u32 s63, s61, 0x3000
  buffer_load_dwordx4 v[112:115], v14, s[4:7], s63 offen offset:0
  buffer_load_dwordx4 v[116:119], v14, s[4:7], s63 offen offset:1024
  buffer_load_dwordx4 v[120:123], v14, s[4:7], s63 offen offset:2048
  buffer_load_dwordx4 v[124:127], v14, s[4:7], s63 offen offset:3072
  s_add_u32 s63, s61, 0x4000
  buffer_load_dwordx4 v[128:131], v14, s[4:7], s63 offen offset:0
  buffer_load_dwordx4 v[132:135], v14, s[4:7], s63 offen offset:1024
  buffer_load_dwordx4 v[136:139], v14, s[4:7], s63 offen offset:2048
  buffer_load_dwordx4 v[140:143], v14, s[4:7], s63 offen offset:3072
  s_add_u32 s63, s61, 0x5000
  buffer_load_dwordx4 v[144:147], v15, s[4:7], s63 offen offset:0
  buffer_load_dwordx4 v[148:151], v15, s[4:7], s63 offen offset:1024
  s_waitcnt vmcnt(21)
  v_mfma_f32_32x32x16_bf16 v[48:63], v[168:171], v[64:67], 0
  s_waitcnt vmcnt(20)
  v_mfma_f32_32x32x16_bf16 v[48:63], v[172:175], v[68:71], v[48:63]
  s_waitcnt vmcnt(19)
  v_mfma_f32_32x32x16_bf16 v[48:63], v[176:179], v[72:75], v[48:63]
  s_waitcnt vmcnt(18)
  v_mfma_f32_32x32x16_bf16 v[48:63], v[180:183], v[76:79], v[48:63]
  s_waitcnt vmcnt(17)
  v_mfma_f32_32x32x16_bf16 v[48:63], v[184:187], v[80:83], v[48:63]
  s_waitcnt vmcnt(16)
  v_mfma_f32_32x32x16_bf16 v[48:63], v[188:191], v[84:87], v[48:63]
  s_waitcnt vmcnt(15)
  v_mfma_f32_32x32x16_bf16 v[48:63], v[192:195], v[88:91], v[48:63]
  s_waitcnt vmcnt(14)
  v_mfma_f32_32x32x16_bf16 v[48:63], v[196:199], v[92:95], v[48:63]
  s_waitcnt vmcnt(13)
  v_mfma_f32_32x32x16_bf16 v[48:63], v[200:203], v[96:99], v[48:63]
  s_waitcnt vmcnt(12)
  v_mfma_f32_32x32x16_bf16 v[48:63], v[204:207], v[100:103], v[48:63]
  s_waitcnt vmcnt(11)
  v_mfma_f32_32x32x16_bf16 v[48:63], v[208:211], v[104:107], v[48:63]
  s_waitcnt vmcnt(10)
  v_mfma_f32_32x32x16_bf16 v[48:63], v[212:215], v[108:111], v[48:63]
  s_waitcnt vmcnt(9)
  v_mfma_f32_32x32x16_bf16 v[48:63], v[216:219], v[112:115], v[48:63]
  s_waitcnt vmcnt(8)
  v_mfma_f32_32x32x16_bf16 v[48:63], v[220:223], v[116:119], v[48:63]
  s_waitcnt vmcnt(7)
  v_mfma_f32_32x32x16_bf16 v[48:63], v[224:227], v[120:123], v[48:63]
  s_waitcnt vmcnt(6)
  v_mfma_f32_32x32x16_bf16 v[48:63], v[228:231], v[124:127], v[48:63]
  s_waitcnt vmcnt(5)
  v_mfma_f32_32x32x16_bf16 v[48:63], v[232:235], v[128:131], v[48:63]
  s_waitcnt vmcnt(4)
  v_mfma_f32_32x32x16_bf16 v[48:63], v[236:239], v[132:135], v[48:63]
  s_waitcnt vmcnt(3)
  v_mfma_f32_32x32x16_bf16 v[48:63], v[240:243], v[136:139], v[48:63]
  s_waitcnt vmcnt(2)
  v_mfma_f32_32x32x16_bf16 v[48:63], v[244:247], v[140:143], v[48:63]
  s_waitcnt vmcnt(1)
  v_mfma_f32_32x32x16_bf16 v[48:63], v[248:251], v[144:147], v[48:63]
  s_waitcnt vmcnt(0)
  v_mfma_f32_32x32x16_bf16 v[48:63], v[252:255], v[148:151], v[48:63]
  s_lshl_b32 s42, s46, 7
  s_add_u32 s60, s42, 0x4004000
  s_mov_b32 s15, 0x400000
L_poll_177:
  buffer_load_dword v12, off, s[4:7], s60 sc1
  s_waitcnt vmcnt(0)
  v_readfirstlane_b32 s16, v12
  s_cmp_ge_u32 s16, 32
  s_cbranch_scc1 L_poll_out_178
  s_sub_u32 s15, s15, 1
  s_cmp_lg_u32 s15, 0
  s_cbranch_scc1 L_poll_177
L_poll_out_178:
  s_add_u32 s63, s62, 0x0
  buffer_load_dwordx4 v[64:67], v14, s[4:7], s63 offen offset:0
  buffer_load_dwordx4 v[68:71], v14, s[4:7], s63 offen offset:1024
  buffer_load_dwordx4 v[72:75], v14, s[4:7], s63 offen offset:2048
  buffer_load_dwordx4 v[76:79], v14, s[4:7], s63 offen offset:3072
  s_add_u32 s63, s62, 0x1000
  buffer_load_dwordx4 v[80:83], v14, s[4:7], s63 offen offset:0
  buffer_load_dwordx4 v[84:87], v14, s[4:7], s63 offen offset:1024
  buffer_load_dwordx4 v[88:91], v14, s[4:7], s63 offen offset:2048
  buffer_load_dwordx4 v[92:95], v14, s[4:7], s63 offen offset:3072
  s_add_u32 s63, s62, 0x2000
  buffer_load_dwordx4 v[96:99], v14, s[4:7], s63 offen offset:0
  buffer_load_dwordx4 v[100:103], v14, s[4:7], s63 offen offset:1024
  buffer_load_dwordx4 v[104:107], v14, s[4:7], s63 offen offset:2048
  buffer_load_dwordx4 v[108:111], v14, s[4:7], s63 offen offset:3072
  s_add_u32 s63, s62, 0x3000
  buffer_load_dwordx4 v[112:115], v14, s[4:7], s63 offen offset:0
  buffer_load_dwordx4 v[116:119], v14, s[4:7], s63 offen offset:1024
  buffer_load_dwordx4 v[120:123], v14, s[4:7], s63 offen offset:2048
  buffer_load_dwordx4 v[124:127], v14, s[4:7], s63 offen offset:3072
  s_add_u32 s63, s62, 0x4000
  buffer_load_dwordx4 v[128:131], v14, s[4:7], s63 offen offset:0
  buffer_load_dwordx4 v[132:135], v14, s[4:7], s63 offen offset:1024
  buffer_load_dwordx4 v[136:139], v14, s[4:7], s63 offen offset:2048
  buffer_load_dwordx4 v[140:143], v14, s[4:7], s63 offen offset:3072
  s_add_u32 s63, s62, 0x5000
  buffer_load_dwordx4 v[144:147], v14, s[4:7], s63 offen offset:0
  buffer_load_dwordx4 v[148:151], v14, s[4:7], s63 offen offset:1024
  buffer_load_dwordx4 v[152:155], v14, s[4:7], s63 offen offset:2048
  buffer_load_dwordx4 v[156:159], v14, s[4:7], s63 offen offset:3072
  s_waitcnt vmcnt(23)
  v_mfma_f32_32x32x16_bf16 v[32:47], a[0:3], v[64:67], 0
  s_add_u32 s63, s62, 0x6000
  buffer_load_dwordx4 v[64:67], v14, s[4:7], s63 offen offset:0
  s_waitcnt vmcnt(23)
  v_mfma_f32_32x32x16_bf16 v[32:47], a[4:7], v[68:71], v[32:47]
  buffer_load_dwordx4 v[68:71], v14, s[4:7], s63 offen offset:1024
  s_waitcnt vmcnt(23)
  v_mfma_f32_32x32x16_bf16 v[32:47], a[8:11], v[72:75], v[32:47]
  buffer_load_dwordx4 v[72:75], v14, s[4:7], s63 offen offset:2048
  s_waitcnt vmcnt(23)
  v_mfma_f32_32x32x16_bf16 v[32:47], a[12:15], v[76:79], v[32:47]
  buffer_load_dwordx4 v[76:79], v14, s[4:7], s63 offen offset:3072
  s_waitcnt vmcnt(23)
  v_mfma_f32_32x32x16_bf16 v[32:47], a[16:19], v[80:83], v[32:47]
  s_add_u32 s63, s62, 0x7000
  buffer_load_dwordx4 v[80:83], v14, s[4:7], s63 offen offset:0
  s_waitcnt vmcnt(23)
  v_mfma_f32_32x32x16_bf16 v[32:47], a[20:23], v[84:87], v[32:47]
  buffer_load_dwordx4 v[84:87], v14, s[4:7], s63 offen offset:1024
  s_waitcnt vmcnt(23)
  v_mfma_f32_32x32x16_bf16 v[32:47], a[24:27], v[88:91], v[32:47]
  buffer_load_dwordx4 v[88:91], v14, s[4:7], s63 offen offset:2048
  s_waitcnt vmcnt(23)
  v_mfma_f32_32x32x16_bf16 v[32:47], a[28:31], v[92:95], v[32:47]
  buffer_load_dwordx4 v[92:95], v14, s[4:7], s63 offen offset:3072
  s_waitcnt vmcnt(23)
  v_mfma_f32_32x32x16_bf16 v[32:47], a[32:35], v[96:99], v[32:47]
  s_add_u32 s63, s62, 0x8000
  buffer_load_dwordx4 v[96:99], v14, s[4:7], s63 offen offset:0
  s_waitcnt vmcnt(23)
  v_mfma_f32_32x32x16_bf16 v[32:47], a[36:39], v[100:103], v[32:47]
  buffer_load_dwordx4 v[100:103], v14, s[4:7], s63 offen offset:1024
  s_waitcnt vmcnt(23)
  v_mfma_f32_32x32x16_bf16 v[32:47], a[40:43], v[104:107], v[32:47]
  buffer_load_dwordx4 v[104:107], v14, s[4:7], s63 offen offset:2048
  s_waitcnt vmcnt(23)
  v_mfma_f32_32x32x16_bf16 v[32:47], a[44:47], v[108:111], v[32:47]
  buffer_load_dwordx4 v[108:111], v14, s[4:7], s63 offen offset:3072
  s_waitcnt vmcnt(23)
  v_mfma_f32_32x32x16_bf16 v[32:47], a[48:51], v[112:115], v[32:47]
  s_add_u32 s63, s62, 0x9000
  buffer_load_dwordx4 v[112:115], v14, s[4:7], s63 offen offset:0
  s_waitcnt vmcnt(23)
  v_mfma_f32_32x32x16_bf16 v[32:47], a[52:55], v[116:119], v[32:47]
  buffer_load_dwordx4 v[116:119], v14, s[4:7], s63 offen offset:1024
  s_waitcnt vmcnt(23)
  v_mfma_f32_32x32x16_bf16 v[32:47], a[56:59], v[120:123], v[32:47]
  buffer_load_dwordx4 v[120:123], v14, s[4:7], s63 offen offset:2048
  s_waitcnt vmcnt(23)
  v_mfma_f32_32x32x16_bf16 v[32:47], a[60:63], v[124:127], v[32:47]
  buffer_load_dwordx4 v[124:127], v14, s[4:7], s63 offen offset:3072
  s_waitcnt vmcnt(23)
  v_mfma_f32_32x32x16_bf16 v[32:47], a[64:67], v[128:131], v[32:47]
  s_add_u32 s63, s62, 0xa000
  buffer_load_dwordx4 v[128:131], v14, s[4:7], s63 offen offset:0
  s_waitcnt vmcnt(23)
  v_mfma_f32_32x32x16_bf16 v[32:47], a[68:71], v[132:135], v[32:47]
  buffer_load_dwordx4 v[132:135], v14, s[4:7], s63 offen offset:1024
  s_waitcnt vmcnt(23)
  v_mfma_f32_32x32x16_bf16 v[32:47], a[72:75], v[136:139], v[32:47]
  buffer_load_dwordx4 v[136:139], v14, s[4:7], s63 offen offset:2048
  s_waitcnt vmcnt(23)
  v_mfma_f32_32x32x16_bf16 v[32:47], a[76:79], v[140:143], v[32:47]
  buffer_load_dwordx4 v[140:143], v14, s[4:7], s63 offen offset:3072
  s_waitcnt vmcnt(23)
  v_mfma_f32_32x32x16_bf16 v[32:47], a[80:83], v[144:147], v[32:47]
  s_add_u32 s63, s62, 0xb000
  buffer_load_dwordx4 v[144:147], v14, s[4:7], s63 offen offset:0
  s_waitcnt vmcnt(23)
  v_mfma_f32_32x32x16_bf16 v[32:47], a[84:87], v[148:151], v[32:47]
  buffer_load_dwordx4 v[148:151], v14, s[4:7], s63 offen offset:1024
  s_waitcnt vmcnt(23)
  v_mfma_f32_32x32x16_bf16 v[32:47], a[88:91], v[152:155], v[32:47]
  buffer_load_dwordx4 v[152:155], v14, s[4:7], s63 offen offset:2048
  s_waitcnt vmcnt(23)
  v_mfma_f32_32x32x16_bf16 v[32:47], a[92:95], v[156:159], v[32:47]
  buffer_load_dwordx4 v[156:159], v14, s[4:7], s63 offen offset:3072
  s_waitcnt vmcnt(23)
  v_mfma_f32_32x32x16_bf16 v[32:47], a[96:99], v[64:67], v[32:47]
  s_add_u32 s63, s62, 0xc000
  buffer_load_dwordx4 v[64:67], v14, s[4:7], s63 offen offset:0
  s_waitcnt vmcnt(23)
  v_mfma_f32_32x32x16_bf16 v[32:47], a[100:103], v[68:71], v[32:47]
  buffer_load_dwordx4 v[68:71], v14, s[4:7], s63 offen offset:1024
  s_waitcnt vmcnt(23)
  v_mfma_f32_32x32x16_bf16 v[32:47], a[104:107], v[72:75], v[32:47]
  buffer_load_dwordx4 v[72:75], v14, s[4:7], s63 offen offset:2048
  s_waitcnt vmcnt(23)
  v_mfma_f32_32x32x16_bf16 v[32:47], a[108:111], v[76:79], v[32:47]
  buffer_load_dwordx4 v[76:79], v14, s[4:7], s63 offen offset:3072
  s_waitcnt vmcnt(23)
  v_mfma_f32_32x32x16_bf16 v[32:47], a[112:115], v[80:83], v[32:47]
  s_add_u32 s63, s62, 0xd000
  buffer_load_dwordx4 v[80:83], v14, s[4:7], s63 offen offset:0
  s_waitcnt vmcnt(23)
  v_mfma_f32_32x32x16_bf16 v[32:47], a[116:119], v[84:87], v[32:47]
  buffer_load_dwordx4 v[84:87], v14, s[4:7], s63 offen offset:1024
  s_waitcnt vmcnt(23)
  v_mfma_f32_32x32x16_bf16 v[32:47], a[120:123], v[88:91], v[32:47]
  buffer_load_dwordx4 v[88:91], v14, s[4:7], s63 offen offset:2048
  s_waitcnt vmcnt(23)
  v_mfma_f32_32x32x16_bf16 v[32:47], a[124:127], v[92:95], v[32:47]
  buffer_load_dwordx4 v[92:95], v14, s[4:7], s63 offen offset:3072
  s_waitcnt vmcnt(23)
  v_mfma_f32_32x32x16_bf16 v[32:47], a[128:131], v[96:99], v[32:47]
  s_add_u32 s63, s62, 0xe000
  buffer_load_dwordx4 v[96:99], v14, s[4:7], s63 offen offset:0
  s_waitcnt vmcnt(23)
  v_mfma_f32_32x32x16_bf16 v[32:47], a[132:135], v[100:103], v[32:47]
  buffer_load_dwordx4 v[100:103], v14, s[4:7], s63 offen offset:1024
  s_waitcnt vmcnt(23)
  v_mfma_f32_32x32x16_bf16 v[32:47], a[136:139], v[104:107], v[32:47]
  buffer_load_dwordx4 v[104:107], v14, s[4:7], s63 offen offset:2048
  s_waitcnt vmcnt(23)
  v_mfma_f32_32x32x16_bf16 v[32:47], a[140:143], v[108:111], v[32:47]
  buffer_load_dwordx4 v[108:111], v14, s[4:7], s63 offen offset:3072
  s_waitcnt vmcnt(23)
  v_mfma_f32_32x32x16_bf16 v[32:47], a[144:147], v[112:115], v[32:47]
  s_add_u32 s63, s62, 0xf000
  buffer_load_dwordx4 v[112:115], v14, s[4:7], s63 offen offset:0
  s_waitcnt vmcnt(23)
  v_mfma_f32_32x32x16_bf16 v[32:47], a[148:151], v[116:119], v[32:47]
  buffer_load_dwordx4 v[116:119], v14, s[4:7], s63 offen offset:1024
  s_waitcnt vmcnt(23)
  v_mfma_f32_32x32x16_bf16 v[32:47], a[152:155], v[120:123], v[32:47]
  buffer_load_dwordx4 v[120:123], v14, s[4:7], s63 offen offset:2048
  s_waitcnt vmcnt(23)
  v_mfma_f32_32x32x16_bf16 v[32:47], a[156:159], v[124:127], v[32:47]
  buffer_load_dwordx4 v[124:127], v14, s[4:7], s63 offen offset:3072
  s_waitcnt vmcnt(23)
  v_mfma_f32_32x32x16_bf16 v[32:47], a[160:163], v[128:131], v[32:47]
  s_waitcnt vmcnt(22)
  v_mfma_f32_32x32x16_bf16 v[32:47], a[164:167], v[132:135], v[32:47]
  s_waitcnt vmcnt(21)
  v_mfma_f32_32x32x16_bf16 v[32:47], a[168:171], v[136:139], v[32:47]
  s_waitcnt vmcnt(20)
  v_mfma_f32_32x32x16_bf16 v[32:47], a[172:175], v[140:143], v[32:47]
  s_waitcnt vmcnt(19)
  v_mfma_f32_32x32x16_bf16 v[32:47], a[176:179], v[144:147], v[32:47]
  s_waitcnt vmcnt(18)
  v_mfma_f32_32x32x16_bf16 v[32:47], a[180:183], v[148:151], v[32:47]
  s_waitcnt vmcnt(17)
  v_mfma_f32_32x32x16_bf16 v[32:47], a[184:187], v[152:155], v[32:47]
  s_waitcnt vmcnt(16)
  v_mfma_f32_32x32x16_bf16 v[32:47], a[188:191], v[156:159], v[32:47]
  s_waitcnt vmcnt(15)
  v_mfma_f32_32x32x16_bf16 v[32:47], a[192:195], v[64:67], v[32:47]
  s_waitcnt vmcnt(14)
  v_mfma_f32_32x32x16_bf16 v[32:47], a[196:199], v[68:71], v[32:47]
  s_waitcnt vmcnt(13)
  v_mfma_f32_32x32x16_bf16 v[32:47], a[200:203], v[72:75], v[32:47]
  s_waitcnt vmcnt(12)
  v_mfma_f32_32x32x16_bf16 v[32:47], a[204:207], v[76:79], v[32:47]
  s_waitcnt vmcnt(11)
  v_mfma_f32_32x32x16_bf16 v[32:47], a[208:211], v[80:83], v[32:47]
  s_waitcnt vmcnt(10)
  v_mfma_f32_32x32x16_bf16 v[32:47], a[212:215], v[84:87], v[32:47]
  s_waitcnt vmcnt(9)
  v_mfma_f32_32x32x16_bf16 v[32:47], a[216:219], v[88:91], v[32:47]
  s_waitcnt vmcnt(8)
  v_mfma_f32_32x32x16_bf16 v[32:47], a[220:223], v[92:95], v[32:47]
  s_waitcnt vmcnt(7)
  v_mfma_f32_32x32x16_bf16 v[32:47], a[224:227], v[96:99], v[32:47]
  s_waitcnt vmcnt(6)
  v_mfma_f32_32x32x16_bf16 v[32:47], a[228:231], v[100:103], v[32:47]
  s_waitcnt vmcnt(5)
  v_mfma_f32_32x32x16_bf16 v[32:47], a[232:235], v[104:107], v[32:47]
  s_waitcnt vmcnt(4)
  v_mfma_f32_32x32x16_bf16 v[32:47], a[236:239], v[108:111], v[32:47]
  s_waitcnt vmcnt(3)
  v_mfma_f32_32x32x16_bf16 v[32:47], a[240:243], v[112:115], v[32:47]
  s_waitcnt vmcnt(2)
  v_mfma_f32_32x32x16_bf16 v[32:47], a[244:247], v[116:119], v[32:47]
  s_waitcnt vmcnt(1)
  v_mfma_f32_32x32x16_bf16 v[32:47], a[248:251], v[120:123], v[32:47]
  s_waitcnt vmcnt(0)
  v_mfma_f32_32x32x16_bf16 v[32:47], a[252:255], v[124:127], v[32:47]
  s_nop 11
  v_sub_f32 v32, v32, v48
  v_sub_f32 v33, v33, v49
  v_sub_f32 v34, v34, v50
  v_sub_f32 v35, v35, v51
  v_sub_f32 v36, v36, v52
  v_sub_f32 v37, v37, v53
  v_sub_f32 v38, v38, v54
  v_sub_f32 v39, v39, v55
  v_sub_f32 v40, v40, v56
  v_sub_f32 v41, v41, v57
  v_sub_f32 v42, v42, v58
  v_sub_f32 v43, v43, v59
  v_sub_f32 v44, v44, v60
  v_sub_f32 v45, v45, v61
  v_sub_f32 v46, v46, v62
  v_sub_f32 v47, v47, v63
  v_fma_f32 v32, v22, v32, v48
  v_fma_f32 v33, v22, v33, v49
  v_fma_f32 v34, v22, v34, v50
  v_fma_f32 v35, v22, v35, v51
  v_fma_f32 v36, v22, v36, v52
  v_fma_f32 v37, v22, v37, v53
  v_fma_f32 v38, v22, v38, v54
  v_fma_f32 v39, v22, v39, v55
  v_fma_f32 v40, v22, v40, v56
  v_fma_f32 v41, v22, v41, v57
  v_fma_f32 v42, v22, v42, v58
  v_fma_f32 v43, v22, v43, v59
  v_fma_f32 v44, v22, v44, v60
  v_fma_f32 v45, v22, v45, v61
  v_fma_f32 v46, v22, v46, v62
  v_fma_f32 v47, v22, v47, v63
  ds_write_b128 v16, v[32:35] offset:0
  ds_write_b128 v16, v[36:39] offset:1024
  ds_write_b128 v16, v[40:43] offset:2048
  ds_write_b128 v16, v[44:47] offset:3072
  s_waitcnt lgkmcnt(0)
  s_barrier
  ds_read_b128 v[64:67], v17 offset:0
  ds_read_b128 v[68:71], v17 offset:4096
  ds_read_b128 v[72:75], v17 offset:8192
  ds_read_b128 v[76:79], v17 offset:12288
  s_waitcnt lgkmcnt(2)
  v_add_f32 v64, v64, v68
  s_waitcnt lgkmcnt(0)
  v_add_f32 v72, v72, v76
  v_add_f32 v65, v65, v69
  v_add_f32 v73, v73, v77
  v_add_f32 v66, v66, v70
  v_add_f32 v74, v74, v78
  v_add_f32 v67, v67, v71
  v_add_f32 v75, v75, v79
  v_add_f32 v64, v64, v72
  v_add_f32 v65, v65, v73
  v_add_f32 v66, v66, v74
  v_add_f32 v67, v67, v75
  v_cvt_pk_bf16_f32 v64, v64, v65
  v_cvt_pk_bf16_f32 v65, v66, v67
  buffer_store_dwordx2 v[64:65], v18, s[32:35], s64 offen sc1
  v_xor_b32 v16, 16384, v16
  v_xor_b32 v17, 16384, v17
  s_add_u32 s53, s53, 1
  s_add_u32 s42, s46, 6
  s_cmp_lt_u32 s42, 54
  s_cbranch_scc1 L_fm_174
  s_branch L_f2
L_glast:
  s_mov_b32 s60, 0x4005d00
  s_cmp_lg_u32 s14, 0
  s_cbranch_scc1 L_w0w_out_180
  s_mov_b32 s15, 262144
L_w0w_top_179:
  buffer_load_dword v12, off, s[4:7], s60 sc1
  s_waitcnt vmcnt(0)
  v_readfirstlane_b32 s16, v12
  s_cmp_ge_u32 s16, 32
  s_cbranch_scc1 L_w0w_out_180
  s_sleep 64
  s_sub_u32 s15, s15, 1
  s_cmp_lg_u32 s15, 0
  s_cbranch_scc1 L_w0w_top_179
L_w0w_out_180:
  s_barrier
L_f2:
  s_lshr_b32 s54, s44, 1
  s_and_b32 s55, s44, 1
  v_mov_b32 v14, 0x0
  v_bfe_u32 v12, v0, 0, 4
  v_mad_i32_i24 v14, v12, 16, v14
  v_bfe_u32 v12, v0, 4, 1
  s_mov_b32 s42, 0x400
  v_mad_i32_i24 v14, v12, s42, v14
  v_bfe_u32 v12, v0, 5, 1
  s_mov_b32 s42, 0x200
  v_mad_i32_i24 v14, v12, s42, v14
  s_lshl_b32 s42, s55, 8
  v_add_u32 v14, s42, v14
  v_mov_b32 v15, v14
  v_mov_b32 v12, 0x40000000
  s_cmp_eq_u32 s14, 3
  s_cselect_b64 vcc, -1, 0
  v_cndmask_b32 v15, v15, v12, vcc
  v_mov_b32 v16, 0x0
  v_bfe_u32 v12, v0, 0, 5
  v_mad_i32_i24 v16, v12, 16, v16
  v_bfe_u32 v12, v0, 5, 1
  s_mov_b32 s42, 0x280
  v_mad_i32_i24 v16, v12, s42, v16
  v_bfe_u32 v12, v0, 6, 2
  s_mov_b32 s42, 0x1480
  v_mad_i32_i24 v16, v12, s42, v16
  v_mov_b32 v17, 0x0
  v_bfe_u32 v12, v0, 0, 1
  v_mad_i32_i24 v17, v12, 8, v17
  v_bfe_u32 v12, v0, 1, 2
  s_mov_b32 s42, 0x520
  v_mad_i32_i24 v17, v12, s42, v17
  v_bfe_u32 v12, v0, 3, 1
  s_mov_b32 s42, 0x280
  v_mad_i32_i24 v17, v12, s42, v17
  v_bfe_u32 v12, v0, 4, 4
  v_mad_i32_i24 v17, v12, 16, v17
  v_mov_b32 v18, 0x0
  v_bfe_u32 v12, v0, 0, 4
  v_mad_i32_i24 v18, v12, 4, v18
  v_bfe_u32 v12, v0, 4, 4
  s_mov_b32 s42, 0x400
  v_mad_i32_i24 v18, v12, s42, v18
  s_lshl_b32 s42, s45, 6
  s_lshl_b32 s43, s55, 14
  s_add_u32 s42, s42, s43
  v_add_u32 v18, s42, v18
  v_mov_b32 v19, 0x0
  v_bfe_u32 v12, v0, 0, 4
  v_mad_i32_i24 v19, v12, 4, v19
  s_lshl_b32 s42, s55, 6
  v_add_u32 v19, s42, v19
  s_mov_b32 s53, 11
  s_add_u32 s46, s54, 54
  s_barrier
L_fm_181:
  s_lshl_b32 s42, s46, 7
  s_add_u32 s60, s42, 0x4006000
  s_mul_i32 s61, s46, 90112
  s_mul_i32 s42, s14, 22528
  s_add_u32 s61, s61, s42
  s_add_u32 s61, s61, 0x3800000
  s_lshl_b32 s62, s46, 18
  s_lshl_b32 s42, s14, 16
  s_add_u32 s62, s62, s42
  s_add_u32 s62, s62, 0x2800000
  s_lshl_b32 s64, s46, 15
  s_lshl_b32 s42, s46, 7
  s_add_u32 s42, s42, 0x3e00000
  buffer_load_dword v22, v19, s[4:7], s42 offen sc1
  s_mov_b32 s15, 0x400000
L_poll_182:
  buffer_load_dword v12, off, s[4:7], s60 sc1
  s_waitcnt vmcnt(0)
  v_readfirstlane_b32 s16, v12
  s_cmp_ge_u32 s16, 43
  s_cbranch_scc1 L_poll_out_183
  s_sub_u32 s15, s15, 1
  s_cmp_lg_u32 s15, 0
  s_cbranch_scc1 L_poll_182
L_poll_out_183:
  s_add_u32 s63, s61, 0x0
  buffer_load_dwordx4 v[64:67], v14, s[4:7], s63 offen offset:0
  buffer_load_dwordx4 v[68:71], v14, s[4:7], s63 offen offset:2048
  s_add_u32 s63, s61, 0x1000
  buffer_load_dwordx4 v[72:75], v14, s[4:7], s63 offen offset:0
  buffer_load_dwordx4 v[76:79], v14, s[4:7], s63 offen offset:2048
  s_add_u32 s63, s61, 0x2000
  buffer_load_dwordx4 v[80:83], v14, s[4:7], s63 offen offset:0
  buffer_load_dwordx4 v[84:87], v14, s[4:7], s63 offen offset:2048
  s_add_u32 s63, s61, 0x3000
  buffer_load_dwordx4 v[88:91], v14, s[4:7], s63 offen offset:0
  buffer_load_dwordx4 v[92:95], v14, s[4:7], s63 offen offset:2048
  s_add_u32 s63, s61, 0x4000
  buffer_load_dwordx4 v[96:99], v14, s[4:7], s63 offen offset:0
  buffer_load_dwordx4 v[100:103], v14, s[4:7], s63 offen offset:2048
  s_add_u32 s63, s61, 0x5000
  buffer_load_dwordx4 v[104:107], v15, s[4:7], s63 offen offset:0
  s_waitcnt vmcnt(10)
  v_mfma_f32_32x32x16_bf16 v[48:63], v[168:171], v[64:67], 0
  v_mfma_f32_32x32x16_bf16 v[128:143], v[172:175], v[64:67], 0
  s_waitcnt vmcnt(9)
  v_mfma_f32_32x32x16_bf16 v[48:63], v[176:179], v[68:71], v[48:63]
  v_mfma_f32_32x32x16_bf16 v[128:143], v[180:183], v[68:71], v[128:143]
  s_waitcnt vmcnt(8)
  v_mfma_f32_32x32x16_bf16 v[48:63], v[184:187], v[72:75], v[48:63]
  v_mfma_f32_32x32x16_bf16 v[128:143], v[188:191], v[72:75], v[128:143]
  s_waitcnt vmcnt(7)
  v_mfma_f32_32x32x16_bf16 v[48:63], v[192:195], v[76:79], v[48:63]
  v_mfma_f32_32x32x16_bf16 v[128:143], v[196:199], v[76:79], v[128:143]
  s_waitcnt vmcnt(6)
  v_mfma_f32_32x32x16_bf16 v[48:63], v[200:203], v[80:83], v[48:63]
  v_mfma_f32_32x32x16_bf16 v[128:143], v[204:207], v[80:83], v[128:143]
  s_waitcnt vmcnt(5)
  v_mfma_f32_32x32x16_bf16 v[48:63], v[208:211], v[84:87], v[48:63]
  v_mfma_f32_32x32x16_bf16 v[128:143], v[212:215], v[84:87], v[128:143]
  s_waitcnt vmcnt(4)
  v_mfma_f32_32x32x16_bf16 v[48:63], v[216:219], v[88:91], v[48:63]
  v_mfma_f32_32x32x16_bf16 v[128:143], v[220:223], v[88:91], v[128:143]
  s_waitcnt vmcnt(3)
  v_mfma_f32_32x32x16_bf16 v[48:63], v[224:227], v[92:95], v[48:63]
  v_mfma_f32_32x32x16_bf16 v[128:143], v[228:231], v[92:95], v[128:143]
  s_waitcnt vmcnt(2)
  v_mfma_f32_32x32x16_bf16 v[48:63], v[232:235], v[96:99], v[48:63]
  v_mfma_f32_32x32x16_bf16 v[128:143], v[236:239], v[96:99], v[128:143]
  s_waitcnt vmcnt(1)
  v_mfma_f32_32x32x16_bf16 v[48:63], v[240:243], v[100:103], v[48:63]
  v_mfma_f32_32x32x16_bf16 v[128:143], v[244:247], v[100:103], v[128:143]
  s_waitcnt vmcnt(0)
  v_mfma_f32_32x32x16_bf16 v[48:63], v[248:251], v[104:107], v[48:63]
  v_mfma_f32_32x32x16_bf16 v[128:143], v[252:255], v[104:107], v[128:143]
  s_mov_b32 exec_lo, 0xffff0000
  s_mov_b32 exec_hi, 0xffff0000
  s_nop 9
  v_mov_b64 v[48:49], v[128:129]
  v_mov_b64 v[50:51], v[130:131]
  v_mov_b64 v[52:53], v[132:133]
  v_mov_b64 v[54:55], v[134:135]
  v_mov_b64 v[56:57], v[136:137]
  v_mov_b64 v[58:59], v[138:139]
  v_mov_b64 v[60:61], v[140:141]
  v_mov_b64 v[62:63], v[142:143]
  s_mov_b64 exec, -1
  v_fma_f32 v48, -v22, v48, v48
  v_fma_f32 v49, -v22, v49, v49
  v_fma_f32 v50, -v22, v50, v50
  v_fma_f32 v51, -v22, v51, v51
  v_fma_f32 v52, -v22, v52, v52
  v_fma_f32 v53, -v22, v53, v53
  v_fma_f32 v54, -v22, v54, v54
  v_fma_f32 v55, -v22, v55, v55
  v_fma_f32 v56, -v22, v56, v56
  v_fma_f32 v57, -v22, v57, v57
  v_fma_f32 v58, -v22, v58, v58
  v_fma_f32 v59, -v22, v59, v59
  v_fma_f32 v60, -v22, v60, v60
  v_fma_f32 v61, -v22, v61, v61
  v_fma_f32 v62, -v22, v62, v62
  v_fma_f32 v63, -v22, v63, v63
  s_lshl_b32 s42, s46, 7
  s_add_u32 s60, s42, 0x4004000
  s_mov_b32 s15, 0x400000
L_poll_184:
  buffer_load_dword v12, off, s[4:7], s60 sc1
  s_waitcnt vmcnt(0)
  v_readfirstlane_b32 s16, v12
  s_cmp_ge_u32 s16, 32
  s_cbranch_scc1 L_poll_out_185
  s_sub_u32 s15, s15, 1
  s_cmp_lg_u32 s15, 0
  s_cbranch_scc1 L_poll_184
L_poll_out_185:
  s_add_u32 s63, s62, 0x0
  buffer_load_dwordx4 v[64:67], v14, s[4:7], s63 offen offset:0
  buffer_load_dwordx4 v[68:71], v14, s[4:7], s63 offen offset:2048
  s_add_u32 s63, s62, 0x1000
  buffer_load_dwordx4 v[72:75], v14, s[4:7], s63 offen offset:0
  buffer_load_dwordx4 v[76:79], v14, s[4:7], s63 offen offset:2048
  s_add_u32 s63, s62, 0x2000
  buffer_load_dwordx4 v[80:83], v14, s[4:7], s63 offen offset:0
  buffer_load_dwordx4 v[84:87], v14, s[4:7], s63 offen offset:2048
  s_add_u32 s63, s62, 0x3000
  buffer_load_dwordx4 v[88:91], v14, s[4:7], s63 offen offset:0
  buffer_load_dwordx4 v[92:95], v14, s[4:7], s63 offen offset:2048
  s_add_u32 s63, s62, 0x4000
  buffer_load_dwordx4 v[96:99], v14, s[4:7], s63 offen offset:0
  buffer_load_dwordx4 v[100:103], v14, s[4:7], s63 offen offset:2048
  s_add_u32 s63, s62, 0x5000
  buffer_load_dwordx4 v[104:107], v14, s[4:7], s63 offen offset:0
  buffer_load_dwordx4 v[108:111], v14, s[4:7], s63 offen offset:2048
  s_add_u32 s63, s62, 0x6000
  buffer_load_dwordx4 v[112:115], v14, s[4:7], s63 offen offset:0
  buffer_load_dwordx4 v[116:119], v14, s[4:7], s63 offen offset:2048
  s_add_u32 s63, s62, 0x7000
  buffer_load_dwordx4 v[120:123], v14, s[4:7], s63 offen offset:0
  buffer_load_dwordx4 v[124:127], v14, s[4:7], s63 offen offset:2048
  s_waitcnt vmcnt(15)
  v_mfma_f32_32x32x16_bf16 v[32:47], a[0:3], v[64:67], 0
  v_mfma_f32_32x32x16_bf16 v[144:159], a[4:7], v[64:67], 0
  s_add_u32 s63, s62, 0x8000
  buffer_load_dwordx4 v[64:67], v14, s[4:7], s63 offen offset:0
  s_waitcnt vmcnt(15)
  v_mfma_f32_32x32x16_bf16 v[32:47], a[8:11], v[68:71], v[32:47]
  v_mfma_f32_32x32x16_bf16 v[144:159], a[12:15], v[68:71], v[144:159]
  buffer_load_dwordx4 v[68:71], v14, s[4:7], s63 offen offset:2048
  s_waitcnt vmcnt(15)
  v_mfma_f32_32x32x16_bf16 v[32:47], a[16:19], v[72:75], v[32:47]
  v_mfma_f32_32x32x16_bf16 v[144:159], a[20:23], v[72:75], v[144:159]
  s_add_u32 s63, s62, 0x9000
  buffer_load_dwordx4 v[72:75], v14, s[4:7], s63 offen offset:0
  s_waitcnt vmcnt(15)
  v_mfma_f32_32x32x16_bf16 v[32:47], a[24:27], v[76:79], v[32:47]
  v_mfma_f32_32x32x16_bf16 v[144:159], a[28:31], v[76:79], v[144:159]
  buffer_load_dwordx4 v[76:79], v14, s[4:7], s63 offen offset:2048
  s_waitcnt vmcnt(15)
  v_mfma_f32_32x32x16_bf16 v[32:47], a[32:35], v[80:83], v[32:47]
  v_mfma_f32_32x32x16_bf16 v[144:159], a[36:39], v[80:83], v[144:159]
  s_add_u32 s63, s62, 0xa000
  buffer_load_dwordx4 v[80:83], v14, s[4:7], s63 offen offset:0
  s_waitcnt vmcnt(15)
  v_mfma_f32_32x32x16_bf16 v[32:47], a[40:43], v[84:87], v[32:47]
  v_mfma_f32_32x32x16_bf16 v[144:159], a[44:47], v[84:87], v[144:159]
  buffer_load_dwordx4 v[84:87], v14, s[4:7], s63 offen offset:2048
  s_waitcnt vmcnt(15)
  v_mfma_f32_32x32x16_bf16 v[32:47], a[48:51], v[88:91], v[32:47]
  v_mfma_f32_32x32x16_bf16 v[144:159], a[52:55], v[88:91], v[144:159]
  s_add_u32 s63, s62, 0xb000
  buffer_load_dwordx4 v[88:91], v14, s[4:7], s63 offen offset:0
  s_waitcnt vmcnt(15)
  v_mfma_f32_32x32x16_bf16 v[32:47], a[56:59], v[92:95], v[32:47]
  v_mfma_f32_32x32x16_bf16 v[144:159], a[60:63], v[92:95], v[144:159]
  buffer_load_dwordx4 v[92:95], v14, s[4:7], s63 offen offset:2048
  s_waitcnt vmcnt(15)
  v_mfma_f32_32x32x16_bf16 v[32:47], a[64:67], v[96:99], v[32:47]
  v_mfma_f32_32x32x16_bf16 v[144:159], a[68:71], v[96:99], v[144:159]
  s_add_u32 s63, s62, 0xc000
  buffer_load_dwordx4 v[96:99], v14, s[4:7], s63 offen offset:0
  s_waitcnt vmcnt(15)
  v_mfma_f32_32x32x16_bf16 v[32:47], a[72:75], v[100:103], v[32:47]
  v_mfma_f32_32x32x16_bf16 v[144:159], a[76:79], v[100:103], v[144:159]
  buffer_load_dwordx4 v[100:103], v14, s[4:7], s63 offen offset:2048
  s_waitcnt vmcnt(15)
  v_mfma_f32_32x32x16_bf16 v[32:47], a[80:83], v[104:107], v[32:47]
  v_mfma_f32_32x32x16_bf16 v[144:159], a[84:87], v[104:107], v[144:159]
  s_add_u32 s63, s62, 0xd000
  buffer_load_dwordx4 v[104:107], v14, s[4:7], s63 offen offset:0
  s_waitcnt vmcnt(15)
  v_mfma_f32_32x32x16_bf16 v[32:47], a[88:91], v[108:111], v[32:47]
  v_mfma_f32_32x32x16_bf16 v[144:159], a[92:95], v[108:111], v[144:159]
  buffer_load_dwordx4 v[108:111], v14, s[4:7], s63 offen offset:2048
  s_waitcnt vmcnt(15)
  v_mfma_f32_32x32x16_bf16 v[32:47], a[96:99], v[112:115], v[32:47]
  v_mfma_f32_32x32x16_bf16 v[144:159], a[100:103], v[112:115], v[144:159]
  s_add_u32 s63, s62, 0xe000
  buffer_load_dwordx4 v[112:115], v14, s[4:7], s63 offen offset:0
  s_waitcnt vmcnt(15)
  v_mfma_f32_32x32x16_bf16 v[32:47], a[104:107], v[116:119], v[32:47]
  v_mfma_f32_32x32x16_bf16 v[144:159], a[108:111], v[116:119], v[144:159]
  buffer_load_dwordx4 v[116:119], v14, s[4:7], s63 offen offset:2048
  s_waitcnt vmcnt(15)
  v_mfma_f32_32x32x16_bf16 v[32:47], a[112:115], v[120:123], v[32:47]
  v_mfma_f32_32x32x16_bf16 v[144:159], a[116:119], v[120:123], v[144:159]
  s_add_u32 s63, s62, 0xf000
  buffer_load_dwordx4 v[120:123], v14, s[4:7], s63 offen offset:0
  s_waitcnt vmcnt(15)
  v_mfma_f32_32x32x16_bf16 v[32:47], a[120:123], v[124:127], v[32:47]
  v_mfma_f32_32x32x16_bf16 v[144:159], a[124:127], v[124:127], v[144:159]
  buffer_load_dwordx4 v[124:127], v14, s[4:7], s63 offen offset:2048
  s_waitcnt vmcnt(15)
  v_mfma_f32_32x32x16_bf16 v[32:47], a[128:131], v[64:67], v[32:47]
  v_mfma_f32_32x32x16_bf16 v[144:159], a[132:135], v[64:67], v[144:159]
  s_waitcnt vmcnt(14)
  v_mfma_f32_32x32x16_bf16 v[32:47], a[136:139], v[68:71], v[32:47]
  v_mfma_f32_32x32x16_bf16 v[144:159], a[140:143], v[68:71], v[144:159]
  s_waitcnt vmcnt(13)
  v_mfma_f32_32x32x16_bf16 v[32:47], a[144:147], v[72:75], v[32:47]
  v_mfma_f32_32x32x16_bf16 v[144:159], a[148:151], v[72:75], v[144:159]
  s_waitcnt vmcnt(12)
  v_mfma_f32_32x32x16_bf16 v[32:47], a[152:155], v[76:79], v[32:47]
  v_mfma_f32_32x32x16_bf16 v[144:159], a[156:159], v[76:79], v[144:159]
  s_waitcnt vmcnt(11)
  v_mfma_f32_32x32x16_bf16 v[32:47], a[160:163], v[80:83], v[32:47]
  v_mfma_f32_32x32x16_bf16 v[144:159], a[164:167], v[80:83], v[144:159]
  s_waitcnt vmcnt(10)
  v_mfma_f32_32x32x16_bf16 v[32:47], a[168:171], v[84:87], v[32:47]
  v_mfma_f32_32x32x16_bf16 v[144:159], a[172:175], v[84:87], v[144:159]
  s_waitcnt vmcnt(9)
  v_mfma_f32_32x32x16_bf16 v[32:47], a[176:179], v[88:91], v[32:47]
  v_mfma_f32_32x32x16_bf16 v[144:159], a[180:183], v[88:91], v[144:159]
  s_waitcnt vmcnt(8)
  v_mfma_f32_32x32x16_bf16 v[32:47], a[184:187], v[92:95], v[32:47]
  v_mfma_f32_32x32x16_bf16 v[144:159], a[188:191], v[92:95], v[144:159]
  s_waitcnt vmcnt(7)
  v_mfma_f32_32x32x16_bf16 v[32:47], a[192:195], v[96:99], v[32:47]
  v_mfma_f32_32x32x16_bf16 v[144:159], a[196:199], v[96:99], v[144:159]
  s_waitcnt vmcnt(6)
  v_mfma_f32_32x32x16_bf16 v[32:47], a[200:203], v[100:103], v[32:47]
  v_mfma_f32_32x32x16_bf16 v[144:159], a[204:207], v[100:103], v[144:159]
  s_waitcnt vmcnt(5)
  v_mfma_f32_32x32x16_bf16 v[32:47], a[208:211], v[104:107], v[32:47]
  v_mfma_f32_32x32x16_bf16 v[144:159], a[212:215], v[104:107], v[144:159]
  s_waitcnt vmcnt(4)
  v_mfma_f32_32x32x16_bf16 v[32:47], a[216:219], v[108:111], v[32:47]
  v_mfma_f32_32x32x16_bf16 v[144:159], a[220:223], v[108:111], v[144:159]
  s_waitcnt vmcnt(3)
  v_mfma_f32_32x32x16_bf16 v[32:47], a[224:227], v[112:115], v[32:47]
  v_mfma_f32_32x32x16_bf16 v[144:159], a[228:231], v[112:115], v[144:159]
  s_waitcnt vmcnt(2)
  v_mfma_f32_32x32x16_bf16 v[32:47], a[232:235], v[116:119], v[32:47]
  v_mfma_f32_32x32x16_bf16 v[144:159], a[236:239], v[116:119], v[144:159]
  s_waitcnt vmcnt(1)
  v_mfma_f32_32x32x16_bf16 v[32:47], a[240:243], v[120:123], v[32:47]
  v_mfma_f32_32x32x16_bf16 v[144:159], a[244:247], v[120:123], v[144:159]
  s_waitcnt vmcnt(0)
  v_mfma_f32_32x32x16_bf16 v[32:47], a[248:251], v[124:127], v[32:47]
  v_mfma_f32_32x32x16_bf16 v[144:159], a[252:255], v[124:127], v[144:159]
  s_mov_b32 exec_lo, 0xffff0000
  s_mov_b32 exec_hi, 0xffff0000
  s_nop 9
  v_mov_b64 v[32:33], v[144:145]
  v_mov_b64 v[34:35], v[146:147]
  v_mov_b64 v[36:37], v[148:149]
  v_mov_b64 v[38:39], v[150:151]
  v_mov_b64 v[40:41], v[152:153]
  v_mov_b64 v[42:43], v[154:155]
  v_mov_b64 v[44:45], v[156:157]
  v_mov_b64 v[46:47], v[158:159]
  s_mov_b64 exec, -1
  v_fma_f32 v32, v22, v32, v48
  v_fma_f32 v33, v22, v33, v49
  v_fma_f32 v34, v22, v34, v50
  v_fma_f32 v35, v22, v35, v51
  ds_write_b128 v16, v[32:35] offset:0
  v_fma_f32 v36, v22, v36, v52
  v_fma_f32 v37, v22, v37, v53
  v_fma_f32 v38, v22, v38, v54
  v_fma_f32 v39, v22, v39, v55
  ds_write_b128 v16, v[36:39] offset:1312
  v_fma_f32 v40, v22, v40, v56
  v_fma_f32 v41, v22, v41, v57
  v_fma_f32 v42, v22, v42, v58
  v_fma_f32 v43, v22, v43, v59
  ds_write_b128 v16, v[40:43] offset:2624
  v_fma_f32 v44, v22, v44, v60
  v_fma_f32 v45, v22, v45, v61
  v_fma_f32 v46, v22, v46, v62
  v_fma_f32 v47, v22, v47, v63
  ds_write_b128 v16, v[44:47] offset:3936
  s_waitcnt lgkmcnt(0)
  s_barrier
  ds_read_b64 v[64:65], v17 offset:0
  ds_read_b64 v[66:67], v17 offset:256
  ds_read_b64 v[68:69], v17 offset:5248
  ds_read_b64 v[70:71], v17 offset:5504
  ds_read_b64 v[72:73], v17 offset:10496
  ds_read_b64 v[74:75], v17 offset:10752
  ds_read_b64 v[76:77], v17 offset:15744
  ds_read_b64 v[78:79], v17 offset:16000
  s_waitcnt lgkmcnt(6)
  v_pk_add_f32 v[64:65], v[64:65], v[66:67]
  s_waitcnt lgkmcnt(4)
  v_pk_add_f32 v[68:69], v[68:69], v[70:71]
  s_waitcnt lgkmcnt(2)
  v_pk_add_f32 v[72:73], v[72:73], v[74:75]
  s_waitcnt lgkmcnt(0)
  v_pk_add_f32 v[76:77], v[76:77], v[78:79]
  v_pk_add_f32 v[64:65], v[64:65], v[68:69]
  v_pk_add_f32 v[72:73], v[72:73], v[76:77]
  v_pk_add_f32 v[64:65], v[64:65], v[72:73]
  v_cvt_pk_bf16_f32 v64, v64, v65
  buffer_store_dword v64, v18, s[32:35], s64 offen sc1
  v_xor_b32 v16, 32768, v16
  v_xor_b32 v17, 32768, v17
  s_add_u32 s53, s53, 1
  s_min_u32 s53, s53, 15
  s_add_u32 s46, s46, 3
  s_cmp_lt_u32 s46, 63
  s_cbranch_scc1 L_fm_181
  s_branch L_end
L_g:
  s_cmp_lg_u32 s21, 0
  s_cbranch_scc1 L_mode_ok_186
  s_mov_b32 s15, 200000
  v_and_b32 v25, 63, v0
  v_lshlrev_b32 v25, 2, v25
L_rdy_top_187:
  buffer_load_dword v24, v25, s[8:11], 0 offen sc1
  s_waitcnt vmcnt(0)
  v_readlane_b32 s16, v24, 8
  v_readlane_b32 s17, v24, 36
  s_add_u32 s16, s16, s17
  v_readlane_b32 s17, v24, 37
  s_add_u32 s16, s16, s17
  v_readlane_b32 s17, v24, 38
  s_add_u32 s16, s16, s17
  v_readlane_b32 s17, v24, 39
  s_add_u32 s16, s16, s17
  s_cmp_ge_u32 s16, 256
  s_cbranch_scc1 L_rdy_out_188
  s_sub_u32 s15, s15, 1
  s_cmp_lg_u32 s15, 0
  s_cbranch_scc1 L_rdy_top_187
L_rdy_out_188:
  buffer_load_dword v24, v25, s[8:11], 0 offen sc1
  s_waitcnt vmcnt(0)
  v_cmp_ne_u32 vcc, 32, v24
  s_and_b32 s15, vcc_hi, 0xfe
  s_and_b32 vcc_lo, vcc_lo, 1
  s_or_b32 s15, s15, vcc_lo
  s_cmp_lg_u32 s15, 0
  s_cbranch_scc1 L_fallback
L_mode_ok_186:
  s_load_dwordx2 s[36:37], s[0:1], 0
  s_mov_b32 s38, 0x200000
  s_mov_b32 s39, 0x20000
  s_load_dwordx2 s[56:57], s[0:1], 88
  s_mov_b32 s58, 0x400
  s_mov_b32 s59, 0x20000
  v_mov_b32 v14, 0x0
  v_bfe_u32 v12, v0, 5, 1
  v_mad_i32_i24 v14, v12, 16, v14
  v_mov_b32 v15, 0x0
  v_bfe_u32 v12, v0, 0, 5
  s_mov_b32 s42, 0x400
  v_mad_i32_i24 v15, v12, s42, v15
  v_bfe_u32 v12, v0, 5, 1
  v_mad_i32_i24 v15, v12, 16, v15
  v_mov_b32 v16, 0x0
  v_bfe_u32 v12, v0, 0, 5
  v_mad_i32_i24 v16, v12, 4, v16
  v_bfe_u32 v12, v0, 5, 1
  s_mov_b32 s42, 0x40000000
  v_mul_lo_u32 v13, v12, s42
  v_add_u32 v16, v16, v13
  v_bfe_u32 v12, v0, 0, 1
  v_bfe_u32 v13, v0, 5, 1
  v_and_b32 v12, v12, v13
  v_mad_i32_i24 v16, v12, -4, v16
  v_bfe_u32 v12, v0, 1, 1
  v_bfe_u32 v13, v0, 5, 1
  v_and_b32 v12, v12, v13
  v_mad_i32_i24 v16, v12, -8, v16
  v_bfe_u32 v12, v0, 2, 1
  v_bfe_u32 v13, v0, 5, 1
  v_and_b32 v12, v12, v13
  v_mad_i32_i24 v16, v12, -16, v16
  v_bfe_u32 v12, v0, 3, 1
  v_bfe_u32 v13, v0, 5, 1
  v_and_b32 v12, v12, v13
  s_mov_b32 s42, 0xffffffe0
  v_mad_i32_i24 v16, v12, s42, v16
  v_bfe_u32 v12, v0, 4, 1
  v_bfe_u32 v13, v0, 5, 1
  v_and_b32 v12, v12, v13
  s_mov_b32 s42, 0xffffffc0
  v_mad_i32_i24 v16, v12, s42, v16
  v_and_b32 v12, 63, v0
  v_mov_b32 v13, 0x40000000
  v_cmp_ne_u32 vcc, 0, v12
  s_nop 1
  v_cndmask_b32 v10, v12, v13, vcc
  v_mov_b32 v11, 1
  s_mov_b32 s60, 0xbfb8aa3b
  s_sub_u32 s46, s20, 224
  s_lshl_b32 s46, s46, 1
  s_add_u32 s46, s46, s14
  s_lshl_b32 s47, s46, 15
  s_lshl_b32 s51, s46, 7
  s_add_u32 s51, s51, 0x3e00000
  s_mov_b32 s50, 0x4002080
  s_waitcnt lgkmcnt(0)
  s_cmp_ge_u32 s14, 2
  s_cbranch_scc1 L_g_idle_189
  buffer_load_dwordx4 v[128:131], v14, s[56:59], 0 offen offset:0
  buffer_load_dwordx4 a[0:3], v15, s[36:39], s47 offen offset:0
  buffer_load_dwordx4 v[132:135], v14, s[56:59], 0 offen offset:32
  buffer_load_dwordx4 a[4:7], v15, s[36:39], s47 offen offset:32
  buffer_load_dwordx4 v[136:139], v14, s[56:59], 0 offen offset:64
  buffer_load_dwordx4 a[8:11], v15, s[36:39], s47 offen offset:64
  buffer_load_dwordx4 v[140:143], v14, s[56:59], 0 offen offset:96
  buffer_load_dwordx4 a[12:15], v15, s[36:39], s47 offen offset:96
  buffer_load_dwordx4 v[144:147], v14, s[56:59], 0 offen offset:128
  buffer_load_dwordx4 a[16:19], v15, s[36:39], s47 offen offset:128
  buffer_load_dwordx4 v[148:151], v14, s[56:59], 0 offen offset:160
  buffer_load_dwordx4 a[20:23], v15, s[36:39], s47 offen offset:160
  buffer_load_dwordx4 v[152:155], v14, s[56:59], 0 offen offset:192
  buffer_load_dwordx4 a[24:27], v15, s[36:39], s47 offen offset:192
  buffer_load_dwordx4 v[156:159], v14, s[56:59], 0 offen offset:224
  buffer_load_dwordx4 a[28:31], v15, s[36:39], s47 offen offset:224
  buffer_load_dwordx4 v[160:163], v14, s[56:59], 0 offen offset:256
  buffer_load_dwordx4 a[32:35], v15, s[36:39], s47 offen offset:256
  buffer_load_dwordx4 v[164:167], v14, s[56:59], 0 offen offset:288
  buffer_load_dwordx4 a[36:39], v15, s[36:39], s47 offen offset:288
  buffer_load_dwordx4 v[168:171], v14, s[56:59], 0 offen offset:320
  buffer_load_dwordx4 a[40:43], v15, s[36:39], s47 offen offset:320
  buffer_load_dwordx4 v[172:175], v14, s[56:59], 0 offen offset:352
  buffer_load_dwordx4 a[44:47], v15, s[36:39], s47 offen offset:352
  buffer_load_dwordx4 v[176:179], v14, s[56:59], 0 offen offset:384
  buffer_load_dwordx4 a[48:51], v15, s[36:39], s47 offen offset:384
  buffer_load_dwordx4 v[180:183], v14, s[56:59], 0 offen offset:416
  buffer_load_dwordx4 a[52:55], v15, s[36:39], s47 offen offset:416
  buffer_load_dwordx4 v[184:187], v14, s[56:59], 0 offen offset:448
  buffer_load_dwordx4 a[56:59], v15, s[36:39], s47 offen offset:448
  buffer_load_dwordx4 v[188:191], v14, s[56:59], 0 offen offset:480
  buffer_load_dwordx4 a[60:63], v15, s[36:39], s47 offen offset:480
  buffer_load_dwordx4 v[192:195], v14, s[56:59], 0 offen offset:512
  buffer_load_dwordx4 a[64:67], v15, s[36:39], s47 offen offset:512
  buffer_load_dwordx4 v[196:199], v14, s[56:59], 0 offen offset:544
  buffer_load_dwordx4 a[68:71], v15, s[36:39], s47 offen offset:544
  buffer_load_dwordx4 v[200:203], v14, s[56:59], 0 offen offset:576
  buffer_load_dwordx4 a[72:75], v15, s[36:39], s47 offen offset:576
  buffer_load_dwordx4 v[204:207], v14, s[56:59], 0 offen offset:608
  buffer_load_dwordx4 a[76:79], v15, s[36:39], s47 offen offset:608
  buffer_load_dwordx4 v[208:211], v14, s[56:59], 0 offen offset:640
  buffer_load_dwordx4 a[80:83], v15, s[36:39], s47 offen offset:640
  buffer_load_dwordx4 v[212:215], v14, s[56:59], 0 offen offset:672
  buffer_load_dwordx4 a[84:87], v15, s[36:39], s47 offen offset:672
  buffer_load_dwordx4 v[216:219], v14, s[56:59], 0 offen offset:704
  buffer_load_dwordx4 a[88:91], v15, s[36:39], s47 offen offset:704
  buffer_load_dwordx4 v[220:223], v14, s[56:59], 0 offen offset:736
  buffer_load_dwordx4 a[92:95], v15, s[36:39], s47 offen offset:736
  buffer_load_dwordx4 v[224:227], v14, s[56:59], 0 offen offset:768
  buffer_load_dwordx4 a[96:99], v15, s[36:39], s47 offen offset:768
  buffer_load_dwordx4 v[228:231], v14, s[56:59], 0 offen offset:800
  buffer_load_dwordx4 a[100:103], v15, s[36:39], s47 offen offset:800
  buffer_load_dwordx4 v[232:235], v14, s[56:59], 0 offen offset:832
  buffer_load_dwordx4 a[104:107], v15, s[36:39], s47 offen offset:832
  buffer_load_dwordx4 v[236:239], v14, s[56:59], 0 offen offset:864
  buffer_load_dwordx4 a[108:111], v15, s[36:39], s47 offen offset:864
  buffer_load_dwordx4 v[240:243], v14, s[56:59], 0 offen offset:896
  buffer_load_dwordx4 a[112:115], v15, s[36:39], s47 offen offset:896
  buffer_load_dwordx4 v[244:247], v14, s[56:59], 0 offen offset:928
  buffer_load_dwordx4 a[116:119], v15, s[36:39], s47 offen offset:928
  buffer_load_dwordx4 v[248:251], v14, s[56:59], 0 offen offset:960
  buffer_load_dwordx4 a[120:123], v15, s[36:39], s47 offen offset:960
  buffer_load_dwordx4 v[252:255], v14, s[56:59], 0 offen offset:992
  buffer_load_dwordx4 a[124:127], v15, s[36:39], s47 offen offset:992
  s_waitcnt vmcnt(62)
  v_mfma_f32_32x32x16_bf16 v[32:47], v[128:131], a[0:3], 0
  s_waitcnt vmcnt(60)
  v_mfma_f32_32x32x16_bf16 v[32:47], v[132:135], a[4:7], v[32:47]
  s_waitcnt vmcnt(58)
  v_mfma_f32_32x32x16_bf16 v[32:47], v[136:139], a[8:11], v[32:47]
  s_waitcnt vmcnt(56)
  v_mfma_f32_32x32x16_bf16 v[32:47], v[140:143], a[12:15], v[32:47]
  s_waitcnt vmcnt(54)
  v_mfma_f32_32x32x16_bf16 v[32:47], v[144:147], a[16:19], v[32:47]
  s_waitcnt vmcnt(52)
  v_mfma_f32_32x32x16_bf16 v[32:47], v[148:151], a[20:23], v[32:47]
  s_waitcnt vmcnt(50)
  v_mfma_f32_32x32x16_bf16 v[32:47], v[152:155], a[24:27], v[32:47]
  s_waitcnt vmcnt(48)
  v_mfma_f32_32x32x16_bf16 v[32:47], v[156:159], a[28:31], v[32:47]
  s_waitcnt vmcnt(46)
  v_mfma_f32_32x32x16_bf16 v[32:47], v[160:163], a[32:35], v[32:47]
  s_waitcnt vmcnt(44)
  v_mfma_f32_32x32x16_bf16 v[32:47], v[164:167], a[36:39], v[32:47]
  s_waitcnt vmcnt(42)
  v_mfma_f32_32x32x16_bf16 v[32:47], v[168:171], a[40:43], v[32:47]
  s_waitcnt vmcnt(40)
  v_mfma_f32_32x32x16_bf16 v[32:47], v[172:175], a[44:47], v[32:47]
  s_waitcnt vmcnt(38)
  v_mfma_f32_32x32x16_bf16 v[32:47], v[176:179], a[48:51], v[32:47]
  s_waitcnt vmcnt(36)
  v_mfma_f32_32x32x16_bf16 v[32:47], v[180:183], a[52:55], v[32:47]
  s_waitcnt vmcnt(34)
  v_mfma_f32_32x32x16_bf16 v[32:47], v[184:187], a[56:59], v[32:47]
  s_waitcnt vmcnt(32)
  v_mfma_f32_32x32x16_bf16 v[32:47], v[188:191], a[60:63], v[32:47]
  s_waitcnt vmcnt(30)
  v_mfma_f32_32x32x16_bf16 v[32:47], v[192:195], a[64:67], v[32:47]
  s_waitcnt vmcnt(28)
  v_mfma_f32_32x32x16_bf16 v[32:47], v[196:199], a[68:71], v[32:47]
  s_waitcnt vmcnt(26)
  v_mfma_f32_32x32x16_bf16 v[32:47], v[200:203], a[72:75], v[32:47]
  s_waitcnt vmcnt(24)
  v_mfma_f32_32x32x16_bf16 v[32:47], v[204:207], a[76:79], v[32:47]
  s_waitcnt vmcnt(22)
  v_mfma_f32_32x32x16_bf16 v[32:47], v[208:211], a[80:83], v[32:47]
  s_waitcnt vmcnt(20)
  v_mfma_f32_32x32x16_bf16 v[32:47], v[212:215], a[84:87], v[32:47]
  s_waitcnt vmcnt(18)
  v_mfma_f32_32x32x16_bf16 v[32:47], v[216:219], a[88:91], v[32:47]
  s_waitcnt vmcnt(16)
  v_mfma_f32_32x32x16_bf16 v[32:47], v[220:223], a[92:95], v[32:47]
  s_waitcnt vmcnt(14)
  v_mfma_f32_32x32x16_bf16 v[32:47], v[224:227], a[96:99], v[32:47]
  s_waitcnt vmcnt(12)
  v_mfma_f32_32x32x16_bf16 v[32:47], v[228:231], a[100:103], v[32:47]
  s_waitcnt vmcnt(10)
  v_mfma_f32_32x32x16_bf16 v[32:47], v[232:235], a[104:107], v[32:47]
  s_waitcnt vmcnt(8)
  v_mfma_f32_32x32x16_bf16 v[32:47], v[236:239], a[108:111], v[32:47]
  s_waitcnt vmcnt(6)
  v_mfma_f32_32x32x16_bf16 v[32:47], v[240:243], a[112:115], v[32:47]
  s_waitcnt vmcnt(4)
  v_mfma_f32_32x32x16_bf16 v[32:47], v[244:247], a[116:119], v[32:47]
  s_waitcnt vmcnt(2)
  v_mfma_f32_32x32x16_bf16 v[32:47], v[248:251], a[120:123], v[32:47]
  s_waitcnt vmcnt(0)
  v_mfma_f32_32x32x16_bf16 v[32:47], v[252:255], a[124:127], v[32:47]
  s_nop 11
  v_mul_f32 v32, s60, v32
  v_exp_f32 v32, v32
  s_nop 0
  v_add_f32 v32, 1.0, v32
  v_rcp_f32 v32, v32
  buffer_store_dword v32, v16, s[4:7], s51 offen sc1
  s_waitcnt vmcnt(0)
L_g_idle_189:
  s_barrier
  s_cmp_lg_u32 s14, 0
  s_cbranch_scc1 L_g_report_190
  buffer_atomic_add v11, v10, s[4:7], s50 offen sc1
L_g_report_190:
  s_and_b32 s30, s20, 7
  s_lshl_b32 s30, s30, 10
  s_add_u32 s30, s30, 0x4002104
  s_cmp_lg_u32 s14, 0
  s_cbranch_scc1 L_w0w_out_192
  s_mov_b32 s15, 20000
L_w0w_top_191:
  buffer_load_dword v20, off, s[4:7], s30 sc1
  s_waitcnt vmcnt(0)
  v_readfirstlane_b32 s16, v20
  s_cmp_ge_u32 s16, 1
  s_cbranch_scc1 L_w0w_out_192
  s_sleep 32
  s_sub_u32 s15, s15, 1
  s_cmp_lg_u32 s15, 0
  s_cbranch_scc1 L_w0w_top_191
L_w0w_out_192:
  s_barrier
  s_and_b32 s45, s20, 15
  s_bfe_u32 s44, s20, 0x10004
  s_add_u32 s44, s44, 18
  s_branch L_fw
L_end:
  s_waitcnt vmcnt(0)
L_exit:
  s_endpgm
.section .rodata,"a"
.p2align 6
.amdhsa_kernel gated_mix__memory_aug_recurrent_mem_tr__glu_gated_glu__prompt_kernel
  .amdhsa_next_free_vgpr 512
  .amdhsa_next_free_sgpr 102
  .amdhsa_accum_offset 256
  .amdhsa_group_segment_fixed_size 0
  .amdhsa_kernarg_size 120
  .amdhsa_user_sgpr_count 2
  .amdhsa_user_sgpr_kernarg_segment_ptr 1
  .amdhsa_system_sgpr_workgroup_id_x 1
.end_amdhsa_kernel
```
